```python
import torch

def _softmax(x, axis=-1):
    return torch.softmax(x, dim=axis)

def _gelu(x):
    return torch.nn.functional.gelu(x, approximate='tanh')

def _silu(x):
    return torch.nn.functional.silu(x)

def _sigmoid(x):
    return torch.sigmoid(x)

def _layernorm(x, axis=-1, eps=1e-05):
    m = x.mean(dim=axis, keepdim=True)
    v = x.var(dim=axis, keepdim=True, unbiased=False)
    return (x - m) / torch.sqrt(v + eps)

def _scatter_add(tgt, idx, src, axis=0):
    return tgt.clone().index_add_(axis, idx, src)

def _segment_sum(src, seg, n):
    out = torch.zeros((n,) + src.shape[1:], dtype=src.dtype)
    return out.index_add_(0, seg, src)

def _pad(x, pw):
    flat = tuple((v for pair in reversed(pw) for v in pair))
    return torch.nn.functional.pad(x, flat)
kernel_name = 'parallel_sum__mha_block__mixer_gmlp__prompt'

def setup_inputs():

    _w = lambda a: (lambda t: t.to(torch.bfloat16) if t.is_floating_point() else t)(torch.as_tensor(a))

    def _A_setup():
        B, S, D, H = (1, 2048, 448, 16)
        return {'x': _w((lambda *s: torch.randn(*s, dtype=torch.bfloat16) * 0.05)(B, S, D)), 'wqkv': _w((lambda *s: torch.randn(*s, dtype=torch.bfloat16) * 0.2)(D, 3 * D)), 'wo': _w((lambda *s: torch.randn(*s, dtype=torch.bfloat16) * 0.1)(D, D))}
    _A_in = _A_setup()

    def _B_setup():
        B, S, D, F = (1, 2048, 448, 1792)
        Fh = F // 2
        return {'x': _w((lambda *s: torch.randn(*s, dtype=torch.bfloat16) * 0.05)(B, S, D)), 'w_in': _w((lambda *s: torch.randn(*s, dtype=torch.bfloat16) * 0.4)(D, 2 * Fh)), 'w_sp': _w(0.01 * (lambda *s: torch.randn(*s, dtype=torch.bfloat16) * 0.4)(S, S)), 'b_sp': _w(1.0 + 0.01 * (lambda *s: torch.randn(*s, dtype=torch.bfloat16) * 0.2)(S)), 'w_out': _w((lambda *s: torch.randn(*s, dtype=torch.bfloat16) * 0.2)(Fh, D))}
    _B_in = _B_setup()
    return {'A_x': _A_in['x'], 'A_wqkv': _A_in['wqkv'], 'A_wo': _A_in['wo'], 'B_x': _B_in['x'], 'B_w_in': _B_in['w_in'], 'B_w_sp': _B_in['w_sp'], 'B_b_sp': _B_in['b_sp'], 'B_w_out': _B_in['w_out']}

def reference(A_x, A_wqkv, A_wo, B_x, B_w_in, B_w_sp, B_b_sp, B_w_out):

    def _A_ref(x, wqkv, wo):
        B, S, D = x.shape
        H = 16
        Dh = D // H
        qkv = (lambda x, *d: x.permute(*d))((x @ wqkv).reshape(B, S, 3, H, Dh), 2, 0, 3, 1, 4)
        q, k, v = (qkv[0], qkv[1], qkv[2])
        scores = torch.einsum('bhqd,bhkd->bhqk', q, k) * Dh ** (-0.5)
        p = _softmax(scores, axis=-1)
        o = torch.einsum('bhqk,bhkd->bhqd', p, v)
        return (lambda x, *d: x.permute(*d))(o, 0, 2, 1, 3).reshape(B, S, D) @ wo

    def _B_ref(x, w_in, w_sp, b_sp, w_out):
        B, S, D = x.shape
        F = w_in.shape[-1]
        Fh = F // 2
        z = _gelu(torch.einsum('bsd,df->bsf', x, w_in))
        z1 = z[..., :Fh].clone()
        z2 = _layernorm(z[..., Fh:], axis=-1)
        g = torch.einsum('ts,bsf->btf', w_sp, z2) + b_sp[None, :, None]
        return torch.einsum('bsf,fd->bsd', z1 * g, w_out)
    x = A_x
    xn = _layernorm(x, axis=-1)
    return x + _A_ref(xn, A_wqkv, A_wo) + _B_ref(xn, B_w_in, B_w_sp, B_b_sp, B_w_out)
```

```asm
; @launch kernel=k1_kernel grid=(256,1,1) block=(512,1,1) lds=163840
; @launch kernel=k2_kernel grid=(256,1,1) block=(512,1,1) lds=151616
.amdgcn_target "amdgcn-amd-amdhsa--gfx950"
.text
.globl k1_kernel
.p2align 8
.type k1_kernel,@function
k1_kernel:
    s_cmp_ge_u32 s2, 256
    s_cbranch_scc1 K1_END
    s_load_dwordx2 s[4:5], s[0:1], 80
    s_load_dwordx2 s[6:7], s[0:1], 0
    s_load_dwordx2 s[8:9], s[0:1], 32
    s_load_dwordx2 s[10:11], s[0:1], 8
    s_load_dwordx2 s[12:13], s[0:1], 72
    s_load_dwordx2 s[92:93], s[0:1], 40
    v_lshrrev_b32 v1, 6, v0
    v_and_b32 v0, 63, v0
    v_readfirstlane_b32 s16, v1
    s_and_b32 s14, s2, 7
    s_lshr_b32 s15, s2, 3
    s_and_b32 s51, s14, 1
    s_lshl_b32 s51, s51, 3
    s_and_b32 s52, s15, 7
    s_add_u32 s19, s51, s52
    s_lshr_b32 s51, s14, 1
    s_lshl_b32 s51, s51, 2
    s_lshr_b32 s52, s15, 3
    s_add_u32 s20, s51, s52
    s_and_b32 s64, s15, 7
    s_lshr_b32 s65, s15, 3
    s_lshl_b32 s65, s65, 1
    s_add_u32 s64, s64, s65
    s_sub_u32 s65, s64, 7
    s_cmp_ge_u32 s64, 7
    s_cselect_b32 s64, s65, s64
    s_mov_b32 s64, 0
    s_and_b32 s17, s16, 3
    s_lshr_b32 s18, s16, 2
    s_lshl_b32 s22, s19, 2
    s_add_u32 s22, s22, s17
    v_lshlrev_b32 v1, 4, v0
    v_lshrrev_b32 v18, 3, v0
    v_mul_u32_u24 v19, 896, v18
    v_lshrrev_b32 v20, 4, v0
    v_and_b32 v21, 7, v0
    v_xor_b32 v22, v21, v20
    v_lshl_add_u32 v2, v22, 4, v19
    v_xor_b32 v22, 4, v22
    v_lshl_add_u32 v3, v22, 4, v19
    v_mul_u32_u24 v19, 3584, v18
    v_and_b32 v20, 1, v20
    v_lshlrev_b32 v20, 2, v20
    v_xor_b32 v22, v21, v20
    v_lshl_add_u32 v4, v22, 4, v19
    s_lshl_b32 s51, s19, 7
    s_lshl_b32 s52, s17, 5
    s_add_u32 s51, s51, s52
    s_mul_i32 s47, s51, 896
    s_lshl_b32 s51, s19, 7
    s_lshl_b32 s52, s16, 4
    s_add_u32 s51, s51, s52
    s_mul_i32 s94, s51, 896
    s_lshl_b32 s51, s20, 7
    s_add_u32 s52, s51, 1792
    s_sub_u32 s53, s51, 256
    s_cmp_lt_u32 s20, 14
    s_cselect_b32 s44, s52, s53
    s_lshl_b32 s95, s16, 3
    s_mul_i32 s95, s95, 3584
    s_add_u32 s95, s95, s44
    s_sub_u32 s54, s20, 2
    s_cmp_lt_u32 s54, 12
    s_cselect_b32 s45, s53, 0
    s_lshl_b32 s51, s17, 4
    s_mul_i32 s51, s51, 3584
    s_add_u32 s44, s44, s51
    s_add_u32 s45, s45, s51
    s_waitcnt lgkmcnt(0)
    s_mov_b32 s24, s4
    s_mov_b32 s25, s5
    s_mov_b32 s26, 25165824
    s_mov_b32 s27, 0x00020000
    s_mov_b32 s28, s6
    s_mov_b32 s29, s7
    s_mov_b32 s30, 1835008
    s_mov_b32 s31, 0x00020000
    s_mov_b32 s32, s8
    s_mov_b32 s33, s9
    s_mov_b32 s34, 1605632
    s_mov_b32 s35, 0x00020000
    s_mov_b32 s36, s10
    s_mov_b32 s37, s11
    s_mov_b32 s38, 1204224
    s_mov_b32 s39, 0x00020000
    s_mov_b32 s40, s12
    s_mov_b32 s41, s13
    s_mov_b32 s42, 256
    s_mov_b32 s43, 0x00020000
    s_mov_b32 s56, 0xbdd2d3e8
    s_mov_b32 s58, 0
    s_mov_b32 s59, -1
    s_mov_b32 s60, 0xffff0000
    v_mov_b32 v248, 0
    s_cmp_ge_u32 s16, 4
    s_cbranch_scc1 K1_GROUPB
    s_add_u32 s65, s64, 0
    s_sub_u32 s83, s65, 7
    s_cmp_ge_u32 s65, 7
    s_cselect_b32 s65, s83, s65
    s_lshl_b32 s49, s65, 7
    s_add_u32 s49, s49, s94
    s_lshl_b32 m0, s16, 11
    s_add_u32 m0, m0, 0
    s_add_u32 s48, s49, 0
    buffer_load_dwordx4 v2, s[28:31], s48 offen lds
    s_lshl_b32 m0, s16, 11
    s_add_u32 m0, m0, 1024
    s_add_u32 s48, s49, 7168
    buffer_load_dwordx4 v3, s[28:31], s48 offen lds
    s_lshl_b32 m0, s16, 10
    s_add_u32 m0, m0, 114688
    s_mul_i32 s48, s65, 229376
    s_add_u32 s48, s48, s95
    buffer_load_dwordx4 v4, s[32:35], s48 offen lds
    s_add_u32 s65, s64, 1
    s_sub_u32 s83, s65, 7
    s_cmp_ge_u32 s65, 7
    s_cselect_b32 s65, s83, s65
    s_lshl_b32 s49, s65, 7
    s_add_u32 s49, s49, s94
    s_lshl_b32 m0, s16, 11
    s_add_u32 m0, m0, 16384
    s_add_u32 s48, s49, 0
    buffer_load_dwordx4 v2, s[28:31], s48 offen lds
    s_lshl_b32 m0, s16, 11
    s_add_u32 m0, m0, 17408
    s_add_u32 s48, s49, 7168
    buffer_load_dwordx4 v3, s[28:31], s48 offen lds
    s_lshl_b32 m0, s16, 10
    s_add_u32 m0, m0, 122880
    s_mul_i32 s48, s65, 229376
    s_add_u32 s48, s48, s95
    buffer_load_dwordx4 v4, s[32:35], s48 offen lds
    s_add_u32 s65, s64, 2
    s_sub_u32 s83, s65, 7
    s_cmp_ge_u32 s65, 7
    s_cselect_b32 s65, s83, s65
    s_lshl_b32 s49, s65, 7
    s_add_u32 s49, s49, s94
    s_lshl_b32 m0, s16, 11
    s_add_u32 m0, m0, 32768
    s_add_u32 s48, s49, 0
    buffer_load_dwordx4 v2, s[28:31], s48 offen lds
    s_lshl_b32 m0, s16, 11
    s_add_u32 m0, m0, 33792
    s_add_u32 s48, s49, 7168
    buffer_load_dwordx4 v3, s[28:31], s48 offen lds
    s_lshl_b32 m0, s16, 10
    s_add_u32 m0, m0, 131072
    s_mul_i32 s48, s65, 229376
    s_add_u32 s48, s48, s95
    buffer_load_dwordx4 v4, s[32:35], s48 offen lds
    v_and_b32 v18, 31, v0
    v_lshrrev_b32 v19, 5, v0
    v_lshrrev_b32 v20, 1, v18
    v_and_b32 v20, 7, v20
    v_xor_b32 v20, v20, v19
    v_lshlrev_b32 v18, 7, v18
    s_lshl_b32 s51, s17, 12
    v_add_u32 v18, s51, v18
    v_xor_b32 v21, 0, v20
    v_lshl_add_u32 v5, v21, 4, v18
    v_xor_b32 v21, 2, v20
    v_lshl_add_u32 v6, v21, 4, v18
    v_xor_b32 v21, 4, v20
    v_lshl_add_u32 v7, v21, 4, v18
    v_xor_b32 v21, 6, v20
    v_lshl_add_u32 v8, v21, 4, v18
    v_lshrrev_b32 v18, 4, v0
    v_and_b32 v19, 1, v18
    v_lshrrev_b32 v18, 1, v18
    v_lshrrev_b32 v20, 2, v0
    v_and_b32 v20, 3, v20
    v_and_b32 v21, 3, v0
    v_lshl_add_u32 v22, v18, 3, v20
    v_lshlrev_b32 v23, 7, v22
    v_lshrrev_b32 v24, 1, v21
    v_lshl_add_u32 v24, v19, 1, v24
    s_lshl_b32 s51, s18, 2
    v_add_u32 v24, s51, v24
    v_lshrrev_b32 v25, 1, v20
    v_lshlrev_b32 v25, 2, v25
    v_xor_b32 v24, v24, v25
    v_lshl_add_u32 v23, v24, 4, v23
    v_and_b32 v24, 1, v21
    v_lshl_add_u32 v9, v24, 3, v23
    s_lshl_b32 s51, s17, 11
    v_add_u32 v10, s51, v9
    v_add_u32 v252, 114688, v9
    v_add_u32 v253, 114688, v10
    v_add_u32 v23, 0, v0
    v_mul_u32_u24 v24, 43691, v23
    v_lshrrev_b32 v24, 19, v24
    v_mul_u32_u24 v25, 12, v24
    v_sub_u32 v25, v23, v25
    v_mul_u32_u24 v24, 2688, v24
    v_lshl_add_u32 v12, v25, 4, v24
    v_add_u32 v23, 64, v0
    v_mul_u32_u24 v24, 43691, v23
    v_lshrrev_b32 v24, 19, v24
    v_mul_u32_u24 v25, 12, v24
    v_sub_u32 v25, v23, v25
    v_mul_u32_u24 v24, 2688, v24
    v_lshl_add_u32 v13, v25, 4, v24
    v_add_u32 v23, 128, v0
    v_mul_u32_u24 v24, 43691, v23
    v_lshrrev_b32 v24, 19, v24
    v_mul_u32_u24 v25, 12, v24
    v_sub_u32 v25, v23, v25
    v_mul_u32_u24 v24, 2688, v24
    v_lshl_add_u32 v14, v25, 4, v24
    v_mul_u32_u24 v23, 192, v22
    v_lshl_add_u32 v23, v19, 5, v23
    v_lshl_add_u32 v15, v21, 3, v23
    v_add_u32 v15, 73728, v15
    v_and_b32 v23, 31, v0
    v_mul_u32_u24 v23, 72, v23
    v_lshrrev_b32 v24, 5, v0
    v_lshl_add_u32 v23, v24, 3, v23
    s_mul_i32 s51, s16, 2304
    s_add_u32 s51, s51, 0
    v_add_u32 v241, s51, v23
    v_lshl_add_u32 v23, v18, 2, v20
    v_mul_u32_u24 v23, 72, v23
    v_lshl_add_u32 v23, v19, 5, v23
    v_lshl_add_u32 v23, v21, 3, v23
    v_add_u32 v242, s51, v23
    v_mul_u32_u24 v23, 72, v22
    v_lshl_add_u32 v23, v19, 5, v23
    v_lshl_add_u32 v23, v21, 3, v23
    v_add_u32 v243, s51, v23
    v_and_b32 v23, 31, v0
    v_lshlrev_b32 v23, 2, v23
    s_lshl_b32 s51, s18, 9
    s_add_u32 s51, s51, 159744
    v_add_u32 v23, s51, v23
    s_lshl_b32 s52, s17, 7
    v_add_u32 v249, s52, v23
    v_lshrrev_b32 v24, 5, v0
    v_lshl_add_u32 v247, v24, 8, v23
    v_mov_b32 v244, 0x3f803f80
    v_mov_b32 v245, 0x3f803f80
    v_and_b32 v23, 31, v0
    s_lshl_b32 s51, s17, 5
    v_add_u32 v23, s51, v23
    v_lshlrev_b32 v246, 3, v23
    v_mov_b32 v47, 0xc0135761
    s_mul_i32 s63, s20, 168
    v_mov_b32 v40, 0
    v_mov_b32 v41, 0
    v_mov_b32 v42, 0
    v_mov_b32 v43, 0
    v_mov_b32 v124, 0
    v_mov_b32 v125, 0
    v_mov_b32 v126, 0
    v_mov_b32 v127, 0
    s_waitcnt vmcnt(6)
    s_barrier
    ds_read_b128 v[128:131], v5 offset:0
    ds_read_b128 v[132:135], v6 offset:0
    ds_read_b128 v[136:139], v7 offset:0
    ds_read_b128 v[140:143], v8 offset:0
    ds_read_b64_tr_b16 v[48:49], v252 offset:0
    ds_read_b64_tr_b16 v[50:51], v252 offset:512
    ds_read_b64_tr_b16 v[52:53], v252 offset:2048
    ds_read_b64_tr_b16 v[54:55], v252 offset:2560
    ds_read_b64_tr_b16 v[56:57], v252 offset:4096
    ds_read_b64_tr_b16 v[58:59], v252 offset:4608
    ds_read_b64_tr_b16 v[60:61], v252 offset:6144
    ds_read_b64_tr_b16 v[62:63], v252 offset:6656
    ds_read_b64_tr_b16 v[28:29], v253 offset:0
    ds_read_b64_tr_b16 v[30:31], v253 offset:512
    s_waitcnt lgkmcnt(0)
    s_waitcnt vmcnt(3)
    s_barrier
    v_mfma_f32_32x32x16_bf16 v[96:111], v[48:51], v[128:131], 0
    ds_read_b128 v[144:147], v5 offset:16384
    ds_read_b128 v[148:151], v6 offset:16384
    ds_read_b128 v[152:155], v7 offset:16384
    ds_read_b128 v[156:159], v8 offset:16384
    v_mfma_f32_32x32x16_bf16 v[96:111], v[52:55], v[132:135], v[96:111]
    ds_read_b64_tr_b16 v[64:65], v252 offset:8192
    ds_read_b64_tr_b16 v[66:67], v252 offset:8704
    ds_read_b64_tr_b16 v[68:69], v252 offset:10240
    ds_read_b64_tr_b16 v[70:71], v252 offset:10752
    v_mfma_f32_32x32x16_bf16 v[96:111], v[56:59], v[136:139], v[96:111]
    ds_read_b64_tr_b16 v[72:73], v252 offset:12288
    ds_read_b64_tr_b16 v[74:75], v252 offset:12800
    ds_read_b64_tr_b16 v[76:77], v252 offset:14336
    ds_read_b64_tr_b16 v[78:79], v252 offset:14848
    v_mfma_f32_32x32x16_bf16 v[96:111], v[60:63], v[140:143], v[96:111]
    ds_read_b64_tr_b16 v[120:121], v253 offset:8192
    ds_read_b64_tr_b16 v[122:123], v253 offset:8704
    v_mfma_f32_4x4x4_16b_bf16 v[124:127], v[244:245], v[28:29], v[124:127]
    s_nop 1
    v_mfma_f32_4x4x4_16b_bf16 v[124:127], v[244:245], v[30:31], v[124:127]
    v_dot2c_f32_bf16 v40, v128, v244
    v_dot2c_f32_bf16 v42, v128, v128
    v_dot2c_f32_bf16 v41, v129, v244
    v_dot2c_f32_bf16 v43, v129, v129
    v_dot2c_f32_bf16 v40, v130, v244
    v_dot2c_f32_bf16 v42, v130, v130
    v_dot2c_f32_bf16 v41, v131, v244
    v_dot2c_f32_bf16 v43, v131, v131
    v_dot2c_f32_bf16 v40, v132, v244
    v_dot2c_f32_bf16 v42, v132, v132
    v_dot2c_f32_bf16 v41, v133, v244
    v_dot2c_f32_bf16 v43, v133, v133
    v_dot2c_f32_bf16 v40, v134, v244
    v_dot2c_f32_bf16 v42, v134, v134
    v_dot2c_f32_bf16 v41, v135, v244
    v_dot2c_f32_bf16 v43, v135, v135
    v_dot2c_f32_bf16 v40, v136, v244
    v_dot2c_f32_bf16 v42, v136, v136
    v_dot2c_f32_bf16 v41, v137, v244
    v_dot2c_f32_bf16 v43, v137, v137
    v_dot2c_f32_bf16 v40, v138, v244
    v_dot2c_f32_bf16 v42, v138, v138
    v_dot2c_f32_bf16 v41, v139, v244
    v_dot2c_f32_bf16 v43, v139, v139
    v_dot2c_f32_bf16 v40, v140, v244
    v_dot2c_f32_bf16 v42, v140, v140
    v_dot2c_f32_bf16 v41, v141, v244
    v_dot2c_f32_bf16 v43, v141, v141
    v_dot2c_f32_bf16 v40, v142, v244
    v_dot2c_f32_bf16 v42, v142, v142
    v_dot2c_f32_bf16 v41, v143, v244
    v_dot2c_f32_bf16 v43, v143, v143
    s_waitcnt lgkmcnt(0)
    s_waitcnt vmcnt(0)
    s_barrier
    v_mfma_f32_32x32x16_bf16 v[96:111], v[64:67], v[144:147], v[96:111]
    ds_read_b128 v[160:163], v5 offset:32768
    ds_read_b128 v[164:167], v6 offset:32768
    ds_read_b128 v[168:171], v7 offset:32768
    ds_read_b128 v[172:175], v8 offset:32768
    v_mfma_f32_32x32x16_bf16 v[96:111], v[68:71], v[148:151], v[96:111]
    ds_read_b64_tr_b16 v[48:49], v252 offset:16384
    ds_read_b64_tr_b16 v[50:51], v252 offset:16896
    ds_read_b64_tr_b16 v[52:53], v252 offset:18432
    ds_read_b64_tr_b16 v[54:55], v252 offset:18944
    v_mfma_f32_32x32x16_bf16 v[96:111], v[72:75], v[152:155], v[96:111]
    ds_read_b64_tr_b16 v[56:57], v252 offset:20480
    ds_read_b64_tr_b16 v[58:59], v252 offset:20992
    ds_read_b64_tr_b16 v[60:61], v252 offset:22528
    ds_read_b64_tr_b16 v[62:63], v252 offset:23040
    v_mfma_f32_32x32x16_bf16 v[96:111], v[76:79], v[156:159], v[96:111]
    ds_read_b64_tr_b16 v[28:29], v253 offset:16384
    ds_read_b64_tr_b16 v[30:31], v253 offset:16896
    v_mfma_f32_4x4x4_16b_bf16 v[124:127], v[244:245], v[120:121], v[124:127]
    s_nop 1
    v_mfma_f32_4x4x4_16b_bf16 v[124:127], v[244:245], v[122:123], v[124:127]
    v_dot2c_f32_bf16 v40, v144, v244
    v_dot2c_f32_bf16 v42, v144, v144
    v_dot2c_f32_bf16 v41, v145, v244
    v_dot2c_f32_bf16 v43, v145, v145
    v_dot2c_f32_bf16 v40, v146, v244
    v_dot2c_f32_bf16 v42, v146, v146
    v_dot2c_f32_bf16 v41, v147, v244
    v_dot2c_f32_bf16 v43, v147, v147
    v_dot2c_f32_bf16 v40, v148, v244
    v_dot2c_f32_bf16 v42, v148, v148
    v_dot2c_f32_bf16 v41, v149, v244
    v_dot2c_f32_bf16 v43, v149, v149
    v_dot2c_f32_bf16 v40, v150, v244
    v_dot2c_f32_bf16 v42, v150, v150
    v_dot2c_f32_bf16 v41, v151, v244
    v_dot2c_f32_bf16 v43, v151, v151
    v_dot2c_f32_bf16 v40, v152, v244
    v_dot2c_f32_bf16 v42, v152, v152
    v_dot2c_f32_bf16 v41, v153, v244
    v_dot2c_f32_bf16 v43, v153, v153
    v_dot2c_f32_bf16 v40, v154, v244
    v_dot2c_f32_bf16 v42, v154, v154
    v_dot2c_f32_bf16 v41, v155, v244
    v_dot2c_f32_bf16 v43, v155, v155
    v_dot2c_f32_bf16 v40, v156, v244
    v_dot2c_f32_bf16 v42, v156, v156
    v_dot2c_f32_bf16 v41, v157, v244
    v_dot2c_f32_bf16 v43, v157, v157
    v_dot2c_f32_bf16 v40, v158, v244
    v_dot2c_f32_bf16 v42, v158, v158
    v_dot2c_f32_bf16 v41, v159, v244
    v_dot2c_f32_bf16 v43, v159, v159
    s_waitcnt lgkmcnt(0)
    s_barrier
    v_mfma_f32_32x32x16_bf16 v[96:111], v[48:51], v[160:163], v[96:111]
    ds_read_b128 v[176:179], v5 offset:49152
    ds_read_b128 v[180:183], v6 offset:49152
    ds_read_b128 v[184:187], v7 offset:49152
    ds_read_b128 v[188:191], v8 offset:49152
    v_mfma_f32_32x32x16_bf16 v[96:111], v[52:55], v[164:167], v[96:111]
    ds_read_b64_tr_b16 v[64:65], v252 offset:24576
    ds_read_b64_tr_b16 v[66:67], v252 offset:25088
    ds_read_b64_tr_b16 v[68:69], v252 offset:26624
    ds_read_b64_tr_b16 v[70:71], v252 offset:27136
    v_mfma_f32_32x32x16_bf16 v[96:111], v[56:59], v[168:171], v[96:111]
    ds_read_b64_tr_b16 v[72:73], v252 offset:28672
    ds_read_b64_tr_b16 v[74:75], v252 offset:29184
    ds_read_b64_tr_b16 v[76:77], v252 offset:30720
    ds_read_b64_tr_b16 v[78:79], v252 offset:31232
    v_mfma_f32_32x32x16_bf16 v[96:111], v[60:63], v[172:175], v[96:111]
    ds_read_b64_tr_b16 v[120:121], v253 offset:24576
    ds_read_b64_tr_b16 v[122:123], v253 offset:25088
    v_mfma_f32_4x4x4_16b_bf16 v[124:127], v[244:245], v[28:29], v[124:127]
    s_nop 1
    v_mfma_f32_4x4x4_16b_bf16 v[124:127], v[244:245], v[30:31], v[124:127]
    v_dot2c_f32_bf16 v40, v160, v244
    v_dot2c_f32_bf16 v42, v160, v160
    v_dot2c_f32_bf16 v41, v161, v244
    v_dot2c_f32_bf16 v43, v161, v161
    v_dot2c_f32_bf16 v40, v162, v244
    v_dot2c_f32_bf16 v42, v162, v162
    v_dot2c_f32_bf16 v41, v163, v244
    v_dot2c_f32_bf16 v43, v163, v163
    v_dot2c_f32_bf16 v40, v164, v244
    v_dot2c_f32_bf16 v42, v164, v164
    v_dot2c_f32_bf16 v41, v165, v244
    v_dot2c_f32_bf16 v43, v165, v165
    v_dot2c_f32_bf16 v40, v166, v244
    v_dot2c_f32_bf16 v42, v166, v166
    v_dot2c_f32_bf16 v41, v167, v244
    v_dot2c_f32_bf16 v43, v167, v167
    v_dot2c_f32_bf16 v40, v168, v244
    v_dot2c_f32_bf16 v42, v168, v168
    v_dot2c_f32_bf16 v41, v169, v244
    v_dot2c_f32_bf16 v43, v169, v169
    v_dot2c_f32_bf16 v40, v170, v244
    v_dot2c_f32_bf16 v42, v170, v170
    v_dot2c_f32_bf16 v41, v171, v244
    v_dot2c_f32_bf16 v43, v171, v171
    v_dot2c_f32_bf16 v40, v172, v244
    v_dot2c_f32_bf16 v42, v172, v172
    v_dot2c_f32_bf16 v41, v173, v244
    v_dot2c_f32_bf16 v43, v173, v173
    v_dot2c_f32_bf16 v40, v174, v244
    v_dot2c_f32_bf16 v42, v174, v174
    v_dot2c_f32_bf16 v41, v175, v244
    v_dot2c_f32_bf16 v43, v175, v175
    s_waitcnt lgkmcnt(0)
    s_barrier
    v_mfma_f32_32x32x16_bf16 v[96:111], v[64:67], v[176:179], v[96:111]
    v_add_u32 v5, 0x10000, v5
    v_add_u32 v6, 0x10000, v6
    v_add_u32 v7, 0x10000, v7
    v_add_u32 v8, 0x10000, v8
    ds_read_b128 v[192:195], v5 offset:0
    ds_read_b128 v[196:199], v6 offset:0
    ds_read_b128 v[200:203], v7 offset:0
    ds_read_b128 v[204:207], v8 offset:0
    v_mfma_f32_32x32x16_bf16 v[96:111], v[68:71], v[180:183], v[96:111]
    ds_read_b64_tr_b16 v[48:49], v252 offset:32768
    ds_read_b64_tr_b16 v[50:51], v252 offset:33280
    ds_read_b64_tr_b16 v[52:53], v252 offset:34816
    ds_read_b64_tr_b16 v[54:55], v252 offset:35328
    v_mfma_f32_32x32x16_bf16 v[96:111], v[72:75], v[184:187], v[96:111]
    ds_read_b64_tr_b16 v[56:57], v252 offset:36864
    ds_read_b64_tr_b16 v[58:59], v252 offset:37376
    ds_read_b64_tr_b16 v[60:61], v252 offset:38912
    ds_read_b64_tr_b16 v[62:63], v252 offset:39424
    v_mfma_f32_32x32x16_bf16 v[96:111], v[76:79], v[188:191], v[96:111]
    ds_read_b64_tr_b16 v[28:29], v253 offset:32768
    ds_read_b64_tr_b16 v[30:31], v253 offset:33280
    v_mfma_f32_4x4x4_16b_bf16 v[124:127], v[244:245], v[120:121], v[124:127]
    s_nop 1
    v_mfma_f32_4x4x4_16b_bf16 v[124:127], v[244:245], v[122:123], v[124:127]
    v_dot2c_f32_bf16 v40, v176, v244
    v_dot2c_f32_bf16 v42, v176, v176
    v_dot2c_f32_bf16 v41, v177, v244
    v_dot2c_f32_bf16 v43, v177, v177
    v_dot2c_f32_bf16 v40, v178, v244
    v_dot2c_f32_bf16 v42, v178, v178
    v_dot2c_f32_bf16 v41, v179, v244
    v_dot2c_f32_bf16 v43, v179, v179
    v_dot2c_f32_bf16 v40, v180, v244
    v_dot2c_f32_bf16 v42, v180, v180
    v_dot2c_f32_bf16 v41, v181, v244
    v_dot2c_f32_bf16 v43, v181, v181
    v_dot2c_f32_bf16 v40, v182, v244
    v_dot2c_f32_bf16 v42, v182, v182
    v_dot2c_f32_bf16 v41, v183, v244
    v_dot2c_f32_bf16 v43, v183, v183
    v_dot2c_f32_bf16 v40, v184, v244
    v_dot2c_f32_bf16 v42, v184, v184
    v_dot2c_f32_bf16 v41, v185, v244
    v_dot2c_f32_bf16 v43, v185, v185
    v_dot2c_f32_bf16 v40, v186, v244
    v_dot2c_f32_bf16 v42, v186, v186
    v_dot2c_f32_bf16 v41, v187, v244
    v_dot2c_f32_bf16 v43, v187, v187
    v_dot2c_f32_bf16 v40, v188, v244
    v_dot2c_f32_bf16 v42, v188, v188
    v_dot2c_f32_bf16 v41, v189, v244
    v_dot2c_f32_bf16 v43, v189, v189
    v_dot2c_f32_bf16 v40, v190, v244
    v_dot2c_f32_bf16 v42, v190, v190
    v_dot2c_f32_bf16 v41, v191, v244
    v_dot2c_f32_bf16 v43, v191, v191
    s_waitcnt lgkmcnt(0)
    s_barrier
    v_mfma_f32_32x32x16_bf16 v[96:111], v[48:51], v[192:195], v[96:111]
    ds_read_b128 v[208:211], v5 offset:16384
    ds_read_b128 v[212:215], v6 offset:16384
    ds_read_b128 v[216:219], v7 offset:16384
    ds_read_b128 v[220:223], v8 offset:16384
    v_mfma_f32_32x32x16_bf16 v[96:111], v[52:55], v[196:199], v[96:111]
    ds_read_b64_tr_b16 v[64:65], v9 offset:0
    ds_read_b64_tr_b16 v[66:67], v9 offset:512
    ds_read_b64_tr_b16 v[68:69], v9 offset:2048
    ds_read_b64_tr_b16 v[70:71], v9 offset:2560
    v_mfma_f32_32x32x16_bf16 v[96:111], v[56:59], v[200:203], v[96:111]
    ds_read_b64_tr_b16 v[72:73], v9 offset:4096
    ds_read_b64_tr_b16 v[74:75], v9 offset:4608
    ds_read_b64_tr_b16 v[76:77], v9 offset:6144
    ds_read_b64_tr_b16 v[78:79], v9 offset:6656
    v_mfma_f32_32x32x16_bf16 v[96:111], v[60:63], v[204:207], v[96:111]
    ds_read_b64_tr_b16 v[120:121], v10 offset:0
    ds_read_b64_tr_b16 v[122:123], v10 offset:512
    v_mfma_f32_4x4x4_16b_bf16 v[124:127], v[244:245], v[28:29], v[124:127]
    s_nop 1
    v_mfma_f32_4x4x4_16b_bf16 v[124:127], v[244:245], v[30:31], v[124:127]
    v_dot2c_f32_bf16 v40, v192, v244
    v_dot2c_f32_bf16 v42, v192, v192
    v_dot2c_f32_bf16 v41, v193, v244
    v_dot2c_f32_bf16 v43, v193, v193
    v_dot2c_f32_bf16 v40, v194, v244
    v_dot2c_f32_bf16 v42, v194, v194
    v_dot2c_f32_bf16 v41, v195, v244
    v_dot2c_f32_bf16 v43, v195, v195
    v_dot2c_f32_bf16 v40, v196, v244
    v_dot2c_f32_bf16 v42, v196, v196
    v_dot2c_f32_bf16 v41, v197, v244
    v_dot2c_f32_bf16 v43, v197, v197
    v_dot2c_f32_bf16 v40, v198, v244
    v_dot2c_f32_bf16 v42, v198, v198
    v_dot2c_f32_bf16 v41, v199, v244
    v_dot2c_f32_bf16 v43, v199, v199
    v_dot2c_f32_bf16 v40, v200, v244
    v_dot2c_f32_bf16 v42, v200, v200
    v_dot2c_f32_bf16 v41, v201, v244
    v_dot2c_f32_bf16 v43, v201, v201
    v_dot2c_f32_bf16 v40, v202, v244
    v_dot2c_f32_bf16 v42, v202, v202
    v_dot2c_f32_bf16 v41, v203, v244
    v_dot2c_f32_bf16 v43, v203, v203
    v_dot2c_f32_bf16 v40, v204, v244
    v_dot2c_f32_bf16 v42, v204, v204
    v_dot2c_f32_bf16 v41, v205, v244
    v_dot2c_f32_bf16 v43, v205, v205
    v_dot2c_f32_bf16 v40, v206, v244
    v_dot2c_f32_bf16 v42, v206, v206
    v_dot2c_f32_bf16 v41, v207, v244
    v_dot2c_f32_bf16 v43, v207, v207
    s_waitcnt lgkmcnt(0)
    s_barrier
    v_mfma_f32_32x32x16_bf16 v[96:111], v[64:67], v[208:211], v[96:111]
    ds_read_b128 v[224:227], v5 offset:32768
    ds_read_b128 v[228:231], v6 offset:32768
    ds_read_b128 v[232:235], v7 offset:32768
    ds_read_b128 v[236:239], v8 offset:32768
    v_mfma_f32_32x32x16_bf16 v[96:111], v[68:71], v[212:215], v[96:111]
    ds_read_b64_tr_b16 v[48:49], v9 offset:8192
    ds_read_b64_tr_b16 v[50:51], v9 offset:8704
    ds_read_b64_tr_b16 v[52:53], v9 offset:10240
    ds_read_b64_tr_b16 v[54:55], v9 offset:10752
    v_mfma_f32_32x32x16_bf16 v[96:111], v[72:75], v[216:219], v[96:111]
    ds_read_b64_tr_b16 v[56:57], v9 offset:12288
    ds_read_b64_tr_b16 v[58:59], v9 offset:12800
    ds_read_b64_tr_b16 v[60:61], v9 offset:14336
    ds_read_b64_tr_b16 v[62:63], v9 offset:14848
    v_mfma_f32_32x32x16_bf16 v[96:111], v[76:79], v[220:223], v[96:111]
    ds_read_b64_tr_b16 v[28:29], v10 offset:8192
    ds_read_b64_tr_b16 v[30:31], v10 offset:8704
    v_mfma_f32_4x4x4_16b_bf16 v[124:127], v[244:245], v[120:121], v[124:127]
    s_nop 1
    v_mfma_f32_4x4x4_16b_bf16 v[124:127], v[244:245], v[122:123], v[124:127]
    v_dot2c_f32_bf16 v40, v208, v244
    v_dot2c_f32_bf16 v42, v208, v208
    v_dot2c_f32_bf16 v41, v209, v244
    v_dot2c_f32_bf16 v43, v209, v209
    v_dot2c_f32_bf16 v40, v210, v244
    v_dot2c_f32_bf16 v42, v210, v210
    v_dot2c_f32_bf16 v41, v211, v244
    v_dot2c_f32_bf16 v43, v211, v211
    v_dot2c_f32_bf16 v40, v212, v244
    v_dot2c_f32_bf16 v42, v212, v212
    v_dot2c_f32_bf16 v41, v213, v244
    v_dot2c_f32_bf16 v43, v213, v213
    v_dot2c_f32_bf16 v40, v214, v244
    v_dot2c_f32_bf16 v42, v214, v214
    v_dot2c_f32_bf16 v41, v215, v244
    v_dot2c_f32_bf16 v43, v215, v215
    v_dot2c_f32_bf16 v40, v216, v244
    v_dot2c_f32_bf16 v42, v216, v216
    v_dot2c_f32_bf16 v41, v217, v244
    v_dot2c_f32_bf16 v43, v217, v217
    v_dot2c_f32_bf16 v40, v218, v244
    v_dot2c_f32_bf16 v42, v218, v218
    v_dot2c_f32_bf16 v41, v219, v244
    v_dot2c_f32_bf16 v43, v219, v219
    v_dot2c_f32_bf16 v40, v220, v244
    v_dot2c_f32_bf16 v42, v220, v220
    v_dot2c_f32_bf16 v41, v221, v244
    v_dot2c_f32_bf16 v43, v221, v221
    v_dot2c_f32_bf16 v40, v222, v244
    v_dot2c_f32_bf16 v42, v222, v222
    v_dot2c_f32_bf16 v41, v223, v244
    v_dot2c_f32_bf16 v43, v223, v223
    s_waitcnt lgkmcnt(0)
    v_mfma_f32_32x32x16_bf16 v[96:111], v[48:51], v[224:227], v[96:111]
    v_mfma_f32_32x32x16_bf16 v[96:111], v[52:55], v[228:231], v[96:111]
    v_mfma_f32_32x32x16_bf16 v[96:111], v[56:59], v[232:235], v[96:111]
    v_mfma_f32_32x32x16_bf16 v[96:111], v[60:63], v[236:239], v[96:111]
    v_mfma_f32_4x4x4_16b_bf16 v[124:127], v[244:245], v[28:29], v[124:127]
    s_nop 1
    v_mfma_f32_4x4x4_16b_bf16 v[124:127], v[244:245], v[30:31], v[124:127]
    v_dot2c_f32_bf16 v40, v224, v244
    v_dot2c_f32_bf16 v42, v224, v224
    v_dot2c_f32_bf16 v41, v225, v244
    v_dot2c_f32_bf16 v43, v225, v225
    v_dot2c_f32_bf16 v40, v226, v244
    v_dot2c_f32_bf16 v42, v226, v226
    v_dot2c_f32_bf16 v41, v227, v244
    v_dot2c_f32_bf16 v43, v227, v227
    v_dot2c_f32_bf16 v40, v228, v244
    v_dot2c_f32_bf16 v42, v228, v228
    v_dot2c_f32_bf16 v41, v229, v244
    v_dot2c_f32_bf16 v43, v229, v229
    v_dot2c_f32_bf16 v40, v230, v244
    v_dot2c_f32_bf16 v42, v230, v230
    v_dot2c_f32_bf16 v41, v231, v244
    v_dot2c_f32_bf16 v43, v231, v231
    v_dot2c_f32_bf16 v40, v232, v244
    v_dot2c_f32_bf16 v42, v232, v232
    v_dot2c_f32_bf16 v41, v233, v244
    v_dot2c_f32_bf16 v43, v233, v233
    v_dot2c_f32_bf16 v40, v234, v244
    v_dot2c_f32_bf16 v42, v234, v234
    v_dot2c_f32_bf16 v41, v235, v244
    v_dot2c_f32_bf16 v43, v235, v235
    v_dot2c_f32_bf16 v40, v236, v244
    v_dot2c_f32_bf16 v42, v236, v236
    v_dot2c_f32_bf16 v41, v237, v244
    v_dot2c_f32_bf16 v43, v237, v237
    v_dot2c_f32_bf16 v40, v238, v244
    v_dot2c_f32_bf16 v42, v238, v238
    v_dot2c_f32_bf16 v41, v239, v244
    v_dot2c_f32_bf16 v43, v239, v239
    v_mov_b32 v46, v124
    v_mov_b32 v33, v124
    s_nop 1
    v_permlane32_swap_b32 v46, v33
    v_add_f32 v46, v46, v33
    ds_write_b32 v249, v46
    v_add_f32 v40, v40, v41
    v_add_f32 v41, v42, v43
    v_mov_b32 v42, v40
    v_mov_b32 v43, v41
    s_nop 0
    v_permlane32_swap_b32 v42, v40
    v_permlane32_swap_b32 v43, v41
    v_add_f32 v40, v40, v42
    v_add_f32 v41, v41, v43
    v_mul_f32 v16, 0x3b124925, v40
    v_mul_f32 v41, 0x3b124925, v41
    v_fma_f32 v41, -v16, v16, v41
    v_max_f32 v41, 0, v41
    v_add_f32 v41, 0x3727c5ac, v41
    v_rsq_f32 v17, v41
    v_add_u32 v18, 160768, v246
    ds_write_b64 v18, v[16:17]
    v_sub_f32 v20, 0, v16
    v_and_b32 v21, 0xffff0000, v20
    v_sub_f32 v22, v20, v21
    v_lshrrev_b32 v23, 16, v21
    v_or_b32 v42, v21, v23
    v_lshrrev_b32 v43, 16, v22
    v_mov_b32 v44, v42
    v_mov_b32 v45, v43
    s_waitcnt lgkmcnt(0)
    s_barrier
    s_cmp_ge_u32 s20, 14
    s_cbranch_scc1 KAF_Z1
    ds_read_b32 v26, v247
    ds_read_b32 v27, v247 offset:128
    s_waitcnt lgkmcnt(1)
    v_and_b32 v32, 0xffff0000, v26
    v_sub_f32 v33, v26, v32
    v_lshrrev_b32 v29, 16, v32
    v_and_or_b32 v28, v33, s60, v29
    s_waitcnt lgkmcnt(0)
    v_and_b32 v32, 0xffff0000, v27
    v_sub_f32 v33, v27, v32
    v_lshrrev_b32 v31, 16, v32
    v_and_or_b32 v30, v33, s60, v31
    s_nop 1
    v_mfma_f32_32x32x16_bf16 v[96:111], v[28:31], v[42:45], v[96:111]
    s_nop 11
    v_mul_f32 v96, v96, v17
    v_mul_f32 v97, v97, v17
    v_mul_f32 v98, v98, v17
    s_add_u32 s88, s17, 0
    s_mul_i32 s89, s88, 3072
    s_lshr_b32 s87, s88, 2
    s_add_u32 s87, s87, s64
    s_sub_u32 s83, s87, 7
    s_cmp_ge_u32 s87, 7
    s_cselect_b32 s87, s83, s87
    s_lshl_b32 s87, s87, 2
    s_and_b32 s88, s88, 3
    s_add_u32 s87, s87, s88
    s_mul_i32 s87, s87, 43008
    s_add_u32 s87, s87, s63
    s_add_u32 m0, s89, 73728
    s_nop 0
    buffer_load_dwordx4 v12, s[36:39], s87 offen lds
    v_mul_f32 v99, v99, v17
    v_mul_f32 v100, v100, v17
    v_mul_f32 v101, v101, v17
    v_mul_f32 v102, v102, v17
    v_mul_f32 v103, v103, v17
    v_mul_f32 v104, v104, v17
    v_mul_f32 v105, v105, v17
    v_mul_f32 v106, v106, v17
    v_mul_f32 v107, v107, v17
    v_mul_f32 v108, v108, v17
    v_mul_f32 v109, v109, v17
    v_mul_f32 v110, v110, v17
    v_mul_f32 v111, v111, v17
    v_mul_f32 v18, v96, v96
    v_mul_f32 v19, v97, v97
    v_mul_f32 v20, v98, v98
    v_mul_f32 v21, v99, v99
    v_mul_f32 v22, v100, v100
    v_mul_f32 v23, v101, v101
    v_mul_f32 v24, v102, v102
    v_mul_f32 v25, v103, v103
    v_fma_f32 v18, v18, s56, v47
    s_add_u32 m0, s89, 74752
    s_nop 0
    buffer_load_dwordx4 v13, s[36:39], s87 offen lds
    v_fma_f32 v19, v19, s56, v47
    v_fma_f32 v20, v20, s56, v47
    v_fma_f32 v21, v21, s56, v47
    v_fma_f32 v22, v22, s56, v47
    v_fma_f32 v23, v23, s56, v47
    v_fma_f32 v24, v24, s56, v47
    v_fma_f32 v25, v25, s56, v47
    v_mul_f32 v18, v18, v96
    v_mul_f32 v19, v19, v97
    v_mul_f32 v20, v20, v98
    v_mul_f32 v21, v21, v99
    v_mul_f32 v22, v22, v100
    v_mul_f32 v23, v23, v101
    v_mul_f32 v24, v24, v102
    v_mul_f32 v25, v25, v103
    v_exp_f32 v18, v18
    v_exp_f32 v19, v19
    v_exp_f32 v20, v20
    v_exp_f32 v21, v21
    v_exp_f32 v22, v22
    v_exp_f32 v23, v23
    v_exp_f32 v24, v24
    v_exp_f32 v25, v25
    s_add_u32 m0, s89, 75776
    s_nop 0
    buffer_load_dwordx4 v14, s[36:39], s87 offen lds
    v_add_f32 v18, 1.0, v18
    v_add_f32 v19, 1.0, v19
    v_add_f32 v20, 1.0, v20
    v_add_f32 v21, 1.0, v21
    v_add_f32 v22, 1.0, v22
    v_add_f32 v23, 1.0, v23
    v_add_f32 v24, 1.0, v24
    v_add_f32 v25, 1.0, v25
    v_rcp_f32 v18, v18
    v_rcp_f32 v19, v19
    v_rcp_f32 v20, v20
    v_rcp_f32 v21, v21
    v_rcp_f32 v22, v22
    v_rcp_f32 v23, v23
    v_rcp_f32 v24, v24
    v_rcp_f32 v25, v25
    v_mul_f32 v80, v96, v18
    v_mul_f32 v81, v97, v19
    v_mul_f32 v82, v98, v20
    v_mul_f32 v83, v99, v21
    v_mul_f32 v84, v100, v22
    v_mul_f32 v85, v101, v23
    v_mul_f32 v86, v102, v24
    s_add_u32 s88, s17, 8
    s_mul_i32 s89, s88, 3072
    s_lshr_b32 s87, s88, 2
    s_add_u32 s87, s87, s64
    s_sub_u32 s83, s87, 7
    s_cmp_ge_u32 s87, 7
    s_cselect_b32 s87, s83, s87
    s_lshl_b32 s87, s87, 2
    s_and_b32 s88, s88, 3
    s_add_u32 s87, s87, s88
    s_mul_i32 s87, s87, 43008
    s_add_u32 s87, s87, s63
    s_add_u32 m0, s89, 73728
    s_nop 0
    buffer_load_dwordx4 v12, s[36:39], s87 offen lds
    v_mul_f32 v87, v103, v25
    v_mul_f32 v18, v104, v104
    v_mul_f32 v19, v105, v105
    v_mul_f32 v20, v106, v106
    v_mul_f32 v21, v107, v107
    v_mul_f32 v22, v108, v108
    v_mul_f32 v23, v109, v109
    v_mul_f32 v24, v110, v110
    v_mul_f32 v25, v111, v111
    v_fma_f32 v18, v18, s56, v47
    v_fma_f32 v19, v19, s56, v47
    v_fma_f32 v20, v20, s56, v47
    v_fma_f32 v21, v21, s56, v47
    v_fma_f32 v22, v22, s56, v47
    v_fma_f32 v23, v23, s56, v47
    v_fma_f32 v24, v24, s56, v47
    v_fma_f32 v25, v25, s56, v47
    v_mul_f32 v18, v18, v104
    v_mul_f32 v19, v19, v105
    v_mul_f32 v20, v20, v106
    v_mul_f32 v21, v21, v107
    v_mul_f32 v22, v22, v108
    s_add_u32 m0, s89, 74752
    s_nop 0
    buffer_load_dwordx4 v13, s[36:39], s87 offen lds
    v_mul_f32 v23, v23, v109
    v_mul_f32 v24, v24, v110
    v_mul_f32 v25, v25, v111
    v_exp_f32 v18, v18
    v_exp_f32 v19, v19
    v_exp_f32 v20, v20
    v_exp_f32 v21, v21
    v_exp_f32 v22, v22
    v_exp_f32 v23, v23
    v_exp_f32 v24, v24
    v_exp_f32 v25, v25
    v_add_f32 v18, 1.0, v18
    v_add_f32 v19, 1.0, v19
    v_add_f32 v20, 1.0, v20
    v_add_f32 v21, 1.0, v21
    v_add_f32 v22, 1.0, v22
    v_add_f32 v23, 1.0, v23
    v_add_f32 v24, 1.0, v24
    v_add_f32 v25, 1.0, v25
    v_rcp_f32 v18, v18
    v_rcp_f32 v19, v19
    v_rcp_f32 v20, v20
    v_rcp_f32 v21, v21
    s_add_u32 m0, s89, 75776
    s_nop 0
    buffer_load_dwordx4 v14, s[36:39], s87 offen lds
    v_rcp_f32 v22, v22
    v_rcp_f32 v23, v23
    v_rcp_f32 v24, v24
    v_rcp_f32 v25, v25
    v_mul_f32 v88, v104, v18
    v_mul_f32 v89, v105, v19
    v_mul_f32 v90, v106, v20
    v_mul_f32 v91, v107, v21
    v_mul_f32 v92, v108, v22
    v_mul_f32 v93, v109, v23
    v_mul_f32 v94, v110, v24
    v_mul_f32 v95, v111, v25
    v_mov_b32 v34, v80
    v_mul_f32 v35, v80, v80
    v_add_f32 v34, v34, v81
    v_fmac_f32 v35, v81, v81
    v_add_f32 v34, v34, v82
    v_fmac_f32 v35, v82, v82
    v_add_f32 v34, v34, v83
    v_fmac_f32 v35, v83, v83
    v_add_f32 v34, v34, v84
    v_fmac_f32 v35, v84, v84
    v_add_f32 v34, v34, v85
    v_fmac_f32 v35, v85, v85
    v_add_f32 v34, v34, v86
    v_fmac_f32 v35, v86, v86
    v_add_f32 v34, v34, v87
    v_fmac_f32 v35, v87, v87
    v_add_f32 v34, v34, v88
    v_fmac_f32 v35, v88, v88
    v_add_f32 v34, v34, v89
    v_fmac_f32 v35, v89, v89
    v_add_f32 v34, v34, v90
    v_fmac_f32 v35, v90, v90
    v_add_f32 v34, v34, v91
    v_fmac_f32 v35, v91, v91
    v_add_f32 v34, v34, v92
    v_fmac_f32 v35, v92, v92
    v_add_f32 v34, v34, v93
    v_fmac_f32 v35, v93, v93
    v_add_f32 v34, v34, v94
    v_fmac_f32 v35, v94, v94
    v_add_f32 v34, v34, v95
    v_fmac_f32 v35, v95, v95
    v_mov_b32 v36, v34
    v_mov_b32 v37, v35
    s_nop 0
    v_permlane32_swap_b32 v36, v34
    v_permlane32_swap_b32 v37, v35
    v_add_f32 v34, v34, v36
    v_add_f32 v35, v35, v37
    v_add_u32 v18, 162816, v246
    ds_write_b64 v18, v[34:35]
    s_branch KAF_D
KAF_Z1:
    s_sub_u32 s57, s20, 2
    ds_read_b32 v26, v247
    ds_read_b32 v27, v247 offset:128
    s_waitcnt lgkmcnt(1)
    v_and_b32 v32, 0xffff0000, v26
    v_sub_f32 v33, v26, v32
    v_lshrrev_b32 v29, 16, v32
    v_and_or_b32 v28, v33, s60, v29
    s_waitcnt lgkmcnt(0)
    v_and_b32 v32, 0xffff0000, v27
    v_sub_f32 v33, v27, v32
    v_lshrrev_b32 v31, 16, v32
    v_and_or_b32 v30, v33, s60, v31
    s_nop 1
    v_mfma_f32_32x32x16_bf16 v[96:111], v[28:31], v[42:45], v[96:111]
    s_nop 11
    v_mul_f32 v96, v96, v17
    v_mul_f32 v97, v97, v17
    v_mul_f32 v98, v98, v17
    s_add_u32 s88, s17, 0
    s_mul_i32 s89, s88, 3072
    s_lshr_b32 s87, s88, 2
    s_add_u32 s87, s87, s64
    s_sub_u32 s83, s87, 7
    s_cmp_ge_u32 s87, 7
    s_cselect_b32 s87, s83, s87
    s_lshl_b32 s87, s87, 2
    s_and_b32 s88, s88, 3
    s_add_u32 s87, s87, s88
    s_mul_i32 s87, s87, 43008
    s_add_u32 s87, s87, s63
    s_add_u32 m0, s89, 73728
    s_nop 0
    buffer_load_dwordx4 v12, s[36:39], s87 offen lds
    v_mul_f32 v99, v99, v17
    v_mul_f32 v100, v100, v17
    v_mul_f32 v101, v101, v17
    v_mul_f32 v102, v102, v17
    v_mul_f32 v103, v103, v17
    v_mul_f32 v104, v104, v17
    v_mul_f32 v105, v105, v17
    v_mul_f32 v106, v106, v17
    v_mul_f32 v107, v107, v17
    v_mul_f32 v108, v108, v17
    v_mul_f32 v109, v109, v17
    v_mul_f32 v110, v110, v17
    v_mul_f32 v111, v111, v17
    v_mul_f32 v18, v96, v96
    v_mul_f32 v19, v97, v97
    v_mul_f32 v20, v98, v98
    v_mul_f32 v21, v99, v99
    v_mul_f32 v22, v100, v100
    v_mul_f32 v23, v101, v101
    s_add_u32 m0, s89, 74752
    s_nop 0
    buffer_load_dwordx4 v13, s[36:39], s87 offen lds
    v_mul_f32 v24, v102, v102
    v_mul_f32 v25, v103, v103
    v_fma_f32 v18, v18, s56, v47
    v_fma_f32 v19, v19, s56, v47
    v_fma_f32 v20, v20, s56, v47
    v_fma_f32 v21, v21, s56, v47
    v_fma_f32 v22, v22, s56, v47
    v_fma_f32 v23, v23, s56, v47
    v_fma_f32 v24, v24, s56, v47
    v_fma_f32 v25, v25, s56, v47
    v_mul_f32 v18, v18, v96
    v_mul_f32 v19, v19, v97
    v_mul_f32 v20, v20, v98
    v_mul_f32 v21, v21, v99
    v_mul_f32 v22, v22, v100
    v_mul_f32 v23, v23, v101
    v_mul_f32 v24, v24, v102
    v_mul_f32 v25, v25, v103
    v_exp_f32 v18, v18
    s_add_u32 m0, s89, 75776
    s_nop 0
    buffer_load_dwordx4 v14, s[36:39], s87 offen lds
    v_exp_f32 v19, v19
    v_exp_f32 v20, v20
    v_exp_f32 v21, v21
    v_exp_f32 v22, v22
    v_exp_f32 v23, v23
    v_exp_f32 v24, v24
    v_exp_f32 v25, v25
    v_add_f32 v18, 1.0, v18
    v_add_f32 v19, 1.0, v19
    v_add_f32 v20, 1.0, v20
    v_add_f32 v21, 1.0, v21
    v_add_f32 v22, 1.0, v22
    v_add_f32 v23, 1.0, v23
    v_add_f32 v24, 1.0, v24
    v_add_f32 v25, 1.0, v25
    v_rcp_f32 v18, v18
    v_rcp_f32 v19, v19
    v_rcp_f32 v20, v20
    v_rcp_f32 v21, v21
    v_rcp_f32 v22, v22
    s_add_u32 s88, s17, 8
    s_mul_i32 s89, s88, 3072
    s_lshr_b32 s87, s88, 2
    s_add_u32 s87, s87, s64
    s_sub_u32 s83, s87, 7
    s_cmp_ge_u32 s87, 7
    s_cselect_b32 s87, s83, s87
    s_lshl_b32 s87, s87, 2
    s_and_b32 s88, s88, 3
    s_add_u32 s87, s87, s88
    s_mul_i32 s87, s87, 43008
    s_add_u32 s87, s87, s63
    s_add_u32 m0, s89, 73728
    s_nop 0
    buffer_load_dwordx4 v12, s[36:39], s87 offen lds
    v_rcp_f32 v23, v23
    v_rcp_f32 v24, v24
    v_rcp_f32 v25, v25
    v_mul_f32 v96, v96, v18
    v_mul_f32 v97, v97, v19
    v_mul_f32 v98, v98, v20
    v_mul_f32 v99, v99, v21
    v_mul_f32 v100, v100, v22
    v_mul_f32 v101, v101, v23
    v_mul_f32 v102, v102, v24
    v_mul_f32 v103, v103, v25
    v_mul_f32 v18, v104, v104
    v_mul_f32 v19, v105, v105
    v_mul_f32 v20, v106, v106
    v_mul_f32 v21, v107, v107
    v_mul_f32 v22, v108, v108
    v_mul_f32 v23, v109, v109
    v_mul_f32 v24, v110, v110
    v_mul_f32 v25, v111, v111
    s_add_u32 m0, s89, 74752
    s_nop 0
    buffer_load_dwordx4 v13, s[36:39], s87 offen lds
    v_fma_f32 v18, v18, s56, v47
    v_fma_f32 v19, v19, s56, v47
    v_fma_f32 v20, v20, s56, v47
    v_fma_f32 v21, v21, s56, v47
    v_fma_f32 v22, v22, s56, v47
    v_fma_f32 v23, v23, s56, v47
    v_fma_f32 v24, v24, s56, v47
    v_fma_f32 v25, v25, s56, v47
    v_mul_f32 v18, v18, v104
    v_mul_f32 v19, v19, v105
    v_mul_f32 v20, v20, v106
    v_mul_f32 v21, v21, v107
    v_mul_f32 v22, v22, v108
    v_mul_f32 v23, v23, v109
    v_mul_f32 v24, v24, v110
    v_mul_f32 v25, v25, v111
    v_exp_f32 v18, v18
    v_exp_f32 v19, v19
    v_exp_f32 v20, v20
    s_add_u32 m0, s89, 75776
    s_nop 0
    buffer_load_dwordx4 v14, s[36:39], s87 offen lds
    v_exp_f32 v21, v21
    v_exp_f32 v22, v22
    v_exp_f32 v23, v23
    v_exp_f32 v24, v24
    v_exp_f32 v25, v25
    v_add_f32 v18, 1.0, v18
    v_add_f32 v19, 1.0, v19
    v_add_f32 v20, 1.0, v20
    v_add_f32 v21, 1.0, v21
    v_add_f32 v22, 1.0, v22
    v_add_f32 v23, 1.0, v23
    v_add_f32 v24, 1.0, v24
    v_add_f32 v25, 1.0, v25
    v_rcp_f32 v18, v18
    v_rcp_f32 v19, v19
    v_rcp_f32 v20, v20
    v_rcp_f32 v21, v21
    v_rcp_f32 v22, v22
    v_rcp_f32 v23, v23
    v_rcp_f32 v24, v24
    v_rcp_f32 v25, v25
    v_mul_f32 v104, v104, v18
    v_mul_f32 v105, v105, v19
    v_mul_f32 v106, v106, v20
    v_mul_f32 v107, v107, v21
    v_mul_f32 v108, v108, v22
    v_mul_f32 v109, v109, v23
    v_mul_f32 v110, v110, v24
    v_mul_f32 v111, v111, v25
    v_cvt_pk_bf16_f32 v34, v96, v97
    v_cvt_pk_bf16_f32 v35, v98, v99
    v_cvt_pk_bf16_f32 v36, v100, v101
    v_cvt_pk_bf16_f32 v37, v102, v103
    v_cvt_pk_bf16_f32 v38, v104, v105
    v_cvt_pk_bf16_f32 v39, v106, v107
    v_cvt_pk_bf16_f32 v40, v108, v109
    v_cvt_pk_bf16_f32 v41, v110, v111
    s_mul_i32 s51, s22, 57344
    s_lshl_b32 s52, s57, 12
    s_add_u32 s51, s51, s52
    s_add_u32 s51, s51, 6291456
    buffer_store_dwordx4 v[34:37], v1, s[24:27], s51 offen offset:0 sc1
    buffer_store_dwordx4 v[38:41], v1, s[24:27], s51 offen offset:1024 sc1
KAF_D:
    s_waitcnt lgkmcnt(0)
    s_barrier
    s_sub_u32 s57, s20, 2
    s_cmp_ge_u32 s57, 12
    s_cbranch_scc1 KA_NOSECOND
    v_add_u32 v250, 16384, v9
    v_add_u32 v251, 16384, v10
    ds_read_b64_tr_b16 v[48:49], v250 offset:0
    ds_read_b64_tr_b16 v[50:51], v250 offset:512
    ds_read_b64_tr_b16 v[52:53], v250 offset:2048
    ds_read_b64_tr_b16 v[54:55], v250 offset:2560
    ds_read_b64_tr_b16 v[56:57], v250 offset:4096
    ds_read_b64_tr_b16 v[58:59], v250 offset:4608
    ds_read_b64_tr_b16 v[60:61], v250 offset:6144
    ds_read_b64_tr_b16 v[62:63], v250 offset:6656
    ds_read_b64_tr_b16 v[64:65], v250 offset:8192
    ds_read_b64_tr_b16 v[66:67], v250 offset:8704
    ds_read_b64_tr_b16 v[26:27], v251 offset:0
    ds_read_b64_tr_b16 v[28:29], v251 offset:512
    v_mov_b32 v124, 0
    v_mov_b32 v125, 0
    v_mov_b32 v126, 0
    v_mov_b32 v127, 0
    s_waitcnt lgkmcnt(10)
    v_mfma_f32_32x32x16_bf16 v[96:111], v[48:51], v[128:131], 0
    ds_read_b64_tr_b16 v[68:69], v250 offset:10240
    ds_read_b64_tr_b16 v[70:71], v250 offset:10752
    s_waitcnt lgkmcnt(10)
    v_mfma_f32_32x32x16_bf16 v[96:111], v[52:55], v[132:135], v[96:111]
    ds_read_b64_tr_b16 v[72:73], v250 offset:12288
    ds_read_b64_tr_b16 v[74:75], v250 offset:12800
    s_waitcnt lgkmcnt(5)
    v_mfma_f32_4x4x4_16b_bf16 v[124:127], v[244:245], v[26:27], v[124:127]
    s_waitcnt lgkmcnt(4)
    s_nop 0
    v_mfma_f32_4x4x4_16b_bf16 v[124:127], v[244:245], v[28:29], v[124:127]
    ds_read_b64_tr_b16 v[30:31], v251 offset:8192
    ds_read_b64_tr_b16 v[32:33], v251 offset:8704
    v_mfma_f32_32x32x16_bf16 v[96:111], v[56:59], v[136:139], v[96:111]
    ds_read_b64_tr_b16 v[76:77], v250 offset:14336
    ds_read_b64_tr_b16 v[78:79], v250 offset:14848
    s_add_u32 s88, s17, 12
    s_mul_i32 s89, s88, 3072
    s_lshr_b32 s87, s88, 2
    s_add_u32 s87, s87, s64
    s_sub_u32 s83, s87, 7
    s_cmp_ge_u32 s87, 7
    s_cselect_b32 s87, s83, s87
    s_lshl_b32 s87, s87, 2
    s_and_b32 s88, s88, 3
    s_add_u32 s87, s87, s88
    s_mul_i32 s87, s87, 43008
    s_add_u32 s87, s87, s63
    s_add_u32 m0, s89, 73728
    s_nop 0
    buffer_load_dwordx4 v12, s[36:39], s87 offen lds
    v_mfma_f32_32x32x16_bf16 v[96:111], v[60:63], v[140:143], v[96:111]
    ds_read_b64_tr_b16 v[48:49], v250 offset:16384
    ds_read_b64_tr_b16 v[50:51], v250 offset:16896
    v_mfma_f32_32x32x16_bf16 v[96:111], v[64:67], v[144:147], v[96:111]
    ds_read_b64_tr_b16 v[52:53], v250 offset:18432
    ds_read_b64_tr_b16 v[54:55], v250 offset:18944
    s_waitcnt lgkmcnt(7)
    v_mfma_f32_4x4x4_16b_bf16 v[124:127], v[244:245], v[30:31], v[124:127]
    s_waitcnt lgkmcnt(6)
    s_nop 0
    v_mfma_f32_4x4x4_16b_bf16 v[124:127], v[244:245], v[32:33], v[124:127]
    ds_read_b64_tr_b16 v[26:27], v251 offset:16384
    ds_read_b64_tr_b16 v[28:29], v251 offset:16896
    v_mfma_f32_32x32x16_bf16 v[96:111], v[68:71], v[148:151], v[96:111]
    ds_read_b64_tr_b16 v[56:57], v250 offset:20480
    ds_read_b64_tr_b16 v[58:59], v250 offset:20992
    s_add_u32 m0, s89, 74752
    s_nop 0
    buffer_load_dwordx4 v13, s[36:39], s87 offen lds
    v_mfma_f32_32x32x16_bf16 v[96:111], v[72:75], v[152:155], v[96:111]
    ds_read_b64_tr_b16 v[60:61], v250 offset:22528
    ds_read_b64_tr_b16 v[62:63], v250 offset:23040
    s_waitcnt lgkmcnt(10)
    v_mfma_f32_32x32x16_bf16 v[96:111], v[76:79], v[156:159], v[96:111]
    ds_read_b64_tr_b16 v[64:65], v250 offset:24576
    ds_read_b64_tr_b16 v[66:67], v250 offset:25088
    s_waitcnt lgkmcnt(7)
    v_mfma_f32_4x4x4_16b_bf16 v[124:127], v[244:245], v[26:27], v[124:127]
    s_waitcnt lgkmcnt(6)
    s_nop 0
    v_mfma_f32_4x4x4_16b_bf16 v[124:127], v[244:245], v[28:29], v[124:127]
    ds_read_b64_tr_b16 v[30:31], v251 offset:24576
    ds_read_b64_tr_b16 v[32:33], v251 offset:25088
    v_mfma_f32_32x32x16_bf16 v[96:111], v[48:51], v[160:163], v[96:111]
    ds_read_b64_tr_b16 v[68:69], v250 offset:26624
    ds_read_b64_tr_b16 v[70:71], v250 offset:27136
    s_add_u32 m0, s89, 75776
    s_nop 0
    buffer_load_dwordx4 v14, s[36:39], s87 offen lds
    v_mfma_f32_32x32x16_bf16 v[96:111], v[52:55], v[164:167], v[96:111]
    ds_read_b64_tr_b16 v[72:73], v250 offset:28672
    ds_read_b64_tr_b16 v[74:75], v250 offset:29184
    s_waitcnt lgkmcnt(10)
    v_mfma_f32_32x32x16_bf16 v[96:111], v[56:59], v[168:171], v[96:111]
    ds_read_b64_tr_b16 v[76:77], v250 offset:30720
    ds_read_b64_tr_b16 v[78:79], v250 offset:31232
    s_waitcnt lgkmcnt(7)
    v_mfma_f32_4x4x4_16b_bf16 v[124:127], v[244:245], v[30:31], v[124:127]
    s_waitcnt lgkmcnt(6)
    s_nop 0
    v_mfma_f32_4x4x4_16b_bf16 v[124:127], v[244:245], v[32:33], v[124:127]
    ds_read_b64_tr_b16 v[26:27], v251 offset:32768
    ds_read_b64_tr_b16 v[28:29], v251 offset:33280
    v_mfma_f32_32x32x16_bf16 v[96:111], v[60:63], v[172:175], v[96:111]
    ds_read_b64_tr_b16 v[48:49], v250 offset:32768
    ds_read_b64_tr_b16 v[50:51], v250 offset:33280
    s_add_u32 s88, s17, 24
    s_mul_i32 s89, s88, 3072
    s_lshr_b32 s87, s88, 2
    s_add_u32 s87, s87, s64
    s_sub_u32 s83, s87, 7
    s_cmp_ge_u32 s87, 7
    s_cselect_b32 s87, s83, s87
    s_lshl_b32 s87, s87, 2
    s_and_b32 s88, s88, 3
    s_add_u32 s87, s87, s88
    s_mul_i32 s87, s87, 43008
    s_add_u32 s87, s87, s63
    s_add_u32 m0, s89, 73728
    s_nop 0
    buffer_load_dwordx4 v12, s[36:39], s87 offen lds
    v_mfma_f32_32x32x16_bf16 v[96:111], v[64:67], v[176:179], v[96:111]
    ds_read_b64_tr_b16 v[52:53], v250 offset:34816
    ds_read_b64_tr_b16 v[54:55], v250 offset:35328
    s_waitcnt lgkmcnt(10)
    v_mfma_f32_32x32x16_bf16 v[96:111], v[68:71], v[180:183], v[96:111]
    ds_read_b64_tr_b16 v[56:57], v250 offset:36864
    ds_read_b64_tr_b16 v[58:59], v250 offset:37376
    s_waitcnt lgkmcnt(7)
    v_mfma_f32_4x4x4_16b_bf16 v[124:127], v[244:245], v[26:27], v[124:127]
    s_waitcnt lgkmcnt(6)
    s_nop 0
    v_mfma_f32_4x4x4_16b_bf16 v[124:127], v[244:245], v[28:29], v[124:127]
    ds_read_b64_tr_b16 v[30:31], v251 offset:40960
    ds_read_b64_tr_b16 v[32:33], v251 offset:41472
    v_mfma_f32_32x32x16_bf16 v[96:111], v[72:75], v[184:187], v[96:111]
    ds_read_b64_tr_b16 v[60:61], v250 offset:38912
    ds_read_b64_tr_b16 v[62:63], v250 offset:39424
    s_add_u32 m0, s89, 74752
    s_nop 0
    buffer_load_dwordx4 v13, s[36:39], s87 offen lds
    v_mfma_f32_32x32x16_bf16 v[96:111], v[76:79], v[188:191], v[96:111]
    ds_read_b64_tr_b16 v[64:65], v250 offset:40960
    ds_read_b64_tr_b16 v[66:67], v250 offset:41472
    s_waitcnt lgkmcnt(10)
    v_mfma_f32_32x32x16_bf16 v[96:111], v[48:51], v[192:195], v[96:111]
    ds_read_b64_tr_b16 v[68:69], v250 offset:43008
    ds_read_b64_tr_b16 v[70:71], v250 offset:43520
    s_waitcnt lgkmcnt(7)
    v_mfma_f32_4x4x4_16b_bf16 v[124:127], v[244:245], v[30:31], v[124:127]
    s_waitcnt lgkmcnt(6)
    s_nop 0
    v_mfma_f32_4x4x4_16b_bf16 v[124:127], v[244:245], v[32:33], v[124:127]
    ds_read_b64_tr_b16 v[26:27], v251 offset:49152
    ds_read_b64_tr_b16 v[28:29], v251 offset:49664
    v_mfma_f32_32x32x16_bf16 v[96:111], v[52:55], v[196:199], v[96:111]
    ds_read_b64_tr_b16 v[72:73], v250 offset:45056
    ds_read_b64_tr_b16 v[74:75], v250 offset:45568
    s_add_u32 m0, s89, 75776
    s_nop 0
    buffer_load_dwordx4 v14, s[36:39], s87 offen lds
    v_mfma_f32_32x32x16_bf16 v[96:111], v[56:59], v[200:203], v[96:111]
    ds_read_b64_tr_b16 v[76:77], v250 offset:47104
    ds_read_b64_tr_b16 v[78:79], v250 offset:47616
    s_waitcnt lgkmcnt(10)
    v_mfma_f32_32x32x16_bf16 v[96:111], v[60:63], v[204:207], v[96:111]
    ds_read_b64_tr_b16 v[48:49], v250 offset:49152
    ds_read_b64_tr_b16 v[50:51], v250 offset:49664
    s_waitcnt lgkmcnt(7)
    v_mfma_f32_4x4x4_16b_bf16 v[124:127], v[244:245], v[26:27], v[124:127]
    s_waitcnt lgkmcnt(6)
    s_nop 0
    v_mfma_f32_4x4x4_16b_bf16 v[124:127], v[244:245], v[28:29], v[124:127]
    v_mfma_f32_32x32x16_bf16 v[96:111], v[64:67], v[208:211], v[96:111]
    ds_read_b64_tr_b16 v[52:53], v250 offset:51200
    ds_read_b64_tr_b16 v[54:55], v250 offset:51712
    v_mfma_f32_32x32x16_bf16 v[96:111], v[68:71], v[212:215], v[96:111]
    ds_read_b64_tr_b16 v[56:57], v250 offset:53248
    ds_read_b64_tr_b16 v[58:59], v250 offset:53760
    s_waitcnt lgkmcnt(8)
    v_mfma_f32_32x32x16_bf16 v[96:111], v[72:75], v[216:219], v[96:111]
    ds_read_b64_tr_b16 v[60:61], v250 offset:55296
    ds_read_b64_tr_b16 v[62:63], v250 offset:55808
    s_waitcnt lgkmcnt(8)
    v_mfma_f32_32x32x16_bf16 v[96:111], v[76:79], v[220:223], v[96:111]
    v_mov_b32 v46, v124
    v_mov_b32 v33, v124
    s_nop 1
    v_permlane32_swap_b32 v46, v33
    v_add_f32 v46, v46, v33
    ds_write_b32 v249, v46
    s_waitcnt lgkmcnt(7)
    v_mfma_f32_32x32x16_bf16 v[96:111], v[48:51], v[224:227], v[96:111]
    s_waitcnt lgkmcnt(5)
    v_mfma_f32_32x32x16_bf16 v[96:111], v[52:55], v[228:231], v[96:111]
    s_waitcnt lgkmcnt(3)
    v_mfma_f32_32x32x16_bf16 v[96:111], v[56:59], v[232:235], v[96:111]
    s_waitcnt lgkmcnt(1)
    v_mfma_f32_32x32x16_bf16 v[96:111], v[60:63], v[236:239], v[96:111]
    s_waitcnt lgkmcnt(0)
    s_barrier
    ds_read_b32 v26, v247
    ds_read_b32 v27, v247 offset:128
    s_waitcnt lgkmcnt(1)
    v_and_b32 v32, 0xffff0000, v26
    v_sub_f32 v33, v26, v32
    v_lshrrev_b32 v29, 16, v32
    v_and_or_b32 v28, v33, s60, v29
    s_waitcnt lgkmcnt(0)
    v_and_b32 v32, 0xffff0000, v27
    v_sub_f32 v33, v27, v32
    v_lshrrev_b32 v31, 16, v32
    v_and_or_b32 v30, v33, s60, v31
    s_nop 1
    v_mfma_f32_32x32x16_bf16 v[96:111], v[28:31], v[42:45], v[96:111]
    s_nop 11
    v_mul_f32 v96, v96, v17
    v_mul_f32 v97, v97, v17
    v_mul_f32 v98, v98, v17
    v_mul_f32 v99, v99, v17
    v_mul_f32 v100, v100, v17
    v_mul_f32 v101, v101, v17
    v_mul_f32 v102, v102, v17
    v_mul_f32 v103, v103, v17
    v_mul_f32 v104, v104, v17
    v_mul_f32 v105, v105, v17
    v_mul_f32 v106, v106, v17
    v_mul_f32 v107, v107, v17
    v_mul_f32 v108, v108, v17
    v_mul_f32 v109, v109, v17
    v_mul_f32 v110, v110, v17
    v_mul_f32 v111, v111, v17
    v_mul_f32 v18, v96, v96
    v_mul_f32 v19, v97, v97
    v_mul_f32 v20, v98, v98
    v_mul_f32 v21, v99, v99
    v_mul_f32 v22, v100, v100
    v_mul_f32 v23, v101, v101
    v_mul_f32 v24, v102, v102
    v_mul_f32 v25, v103, v103
    v_fma_f32 v18, v18, s56, v47
    v_fma_f32 v19, v19, s56, v47
    v_fma_f32 v20, v20, s56, v47
    v_fma_f32 v21, v21, s56, v47
    v_fma_f32 v22, v22, s56, v47
    v_fma_f32 v23, v23, s56, v47
    v_fma_f32 v24, v24, s56, v47
    v_fma_f32 v25, v25, s56, v47
    v_mul_f32 v18, v18, v96
    v_mul_f32 v19, v19, v97
    v_mul_f32 v20, v20, v98
    v_mul_f32 v21, v21, v99
    v_mul_f32 v22, v22, v100
    v_mul_f32 v23, v23, v101
    v_mul_f32 v24, v24, v102
    v_mul_f32 v25, v25, v103
    v_exp_f32 v18, v18
    v_exp_f32 v19, v19
    v_exp_f32 v20, v20
    v_exp_f32 v21, v21
    v_exp_f32 v22, v22
    v_exp_f32 v23, v23
    v_exp_f32 v24, v24
    v_exp_f32 v25, v25
    v_add_f32 v18, 1.0, v18
    v_add_f32 v19, 1.0, v19
    v_add_f32 v20, 1.0, v20
    v_add_f32 v21, 1.0, v21
    v_add_f32 v22, 1.0, v22
    v_add_f32 v23, 1.0, v23
    v_add_f32 v24, 1.0, v24
    v_add_f32 v25, 1.0, v25
    v_rcp_f32 v18, v18
    v_rcp_f32 v19, v19
    v_rcp_f32 v20, v20
    v_rcp_f32 v21, v21
    v_rcp_f32 v22, v22
    v_rcp_f32 v23, v23
    v_rcp_f32 v24, v24
    v_rcp_f32 v25, v25
    v_mul_f32 v96, v96, v18
    v_mul_f32 v97, v97, v19
    v_mul_f32 v98, v98, v20
    v_mul_f32 v99, v99, v21
    v_mul_f32 v100, v100, v22
    v_mul_f32 v101, v101, v23
    v_mul_f32 v102, v102, v24
    v_mul_f32 v103, v103, v25
    v_mul_f32 v18, v104, v104
    v_mul_f32 v19, v105, v105
    v_mul_f32 v20, v106, v106
    v_mul_f32 v21, v107, v107
    v_mul_f32 v22, v108, v108
    v_mul_f32 v23, v109, v109
    v_mul_f32 v24, v110, v110
    v_mul_f32 v25, v111, v111
    v_fma_f32 v18, v18, s56, v47
    v_fma_f32 v19, v19, s56, v47
    v_fma_f32 v20, v20, s56, v47
    v_fma_f32 v21, v21, s56, v47
    v_fma_f32 v22, v22, s56, v47
    v_fma_f32 v23, v23, s56, v47
    v_fma_f32 v24, v24, s56, v47
    v_fma_f32 v25, v25, s56, v47
    v_mul_f32 v18, v18, v104
    v_mul_f32 v19, v19, v105
    v_mul_f32 v20, v20, v106
    v_mul_f32 v21, v21, v107
    v_mul_f32 v22, v22, v108
    v_mul_f32 v23, v23, v109
    v_mul_f32 v24, v24, v110
    v_mul_f32 v25, v25, v111
    v_exp_f32 v18, v18
    v_exp_f32 v19, v19
    v_exp_f32 v20, v20
    v_exp_f32 v21, v21
    v_exp_f32 v22, v22
    v_exp_f32 v23, v23
    v_exp_f32 v24, v24
    v_exp_f32 v25, v25
    v_add_f32 v18, 1.0, v18
    v_add_f32 v19, 1.0, v19
    v_add_f32 v20, 1.0, v20
    v_add_f32 v21, 1.0, v21
    v_add_f32 v22, 1.0, v22
    v_add_f32 v23, 1.0, v23
    v_add_f32 v24, 1.0, v24
    v_add_f32 v25, 1.0, v25
    v_rcp_f32 v18, v18
    v_rcp_f32 v19, v19
    v_rcp_f32 v20, v20
    v_rcp_f32 v21, v21
    v_rcp_f32 v22, v22
    v_rcp_f32 v23, v23
    v_rcp_f32 v24, v24
    v_rcp_f32 v25, v25
    v_mul_f32 v104, v104, v18
    v_mul_f32 v105, v105, v19
    v_mul_f32 v106, v106, v20
    v_mul_f32 v107, v107, v21
    v_mul_f32 v108, v108, v22
    v_mul_f32 v109, v109, v23
    v_mul_f32 v110, v110, v24
    v_mul_f32 v111, v111, v25
    v_cvt_pk_bf16_f32 v34, v96, v97
    v_cvt_pk_bf16_f32 v35, v98, v99
    v_cvt_pk_bf16_f32 v36, v100, v101
    v_cvt_pk_bf16_f32 v37, v102, v103
    v_cvt_pk_bf16_f32 v38, v104, v105
    v_cvt_pk_bf16_f32 v39, v106, v107
    v_cvt_pk_bf16_f32 v40, v108, v109
    v_cvt_pk_bf16_f32 v41, v110, v111
    s_mul_i32 s51, s22, 57344
    s_lshl_b32 s52, s57, 12
    s_add_u32 s51, s51, s52
    s_add_u32 s51, s51, 6291456
    buffer_store_dwordx4 v[34:37], v1, s[24:27], s51 offen offset:0 sc1
    buffer_store_dwordx4 v[38:41], v1, s[24:27], s51 offen offset:1024 sc1
    s_waitcnt vmcnt(2)
    s_barrier
    v_add_u32 v250, 0, v15
    s_mul_i32 s51, s17, 3072
    v_add_u32 v251, s51, v250
    v_add_u32 v252, 43008, v250
    v_add_u32 v253, 43008, v251
    ds_read_b64_tr_b16 v[48:49], v250 offset:0
    ds_read_b64_tr_b16 v[50:51], v250 offset:768
    ds_read_b64_tr_b16 v[52:53], v250 offset:3072
    ds_read_b64_tr_b16 v[54:55], v250 offset:3840
    ds_read_b64_tr_b16 v[56:57], v250 offset:6144
    ds_read_b64_tr_b16 v[58:59], v250 offset:6912
    ds_read_b64_tr_b16 v[60:61], v250 offset:9216
    ds_read_b64_tr_b16 v[62:63], v250 offset:9984
    ds_read_b64_tr_b16 v[64:65], v250 offset:12288
    ds_read_b64_tr_b16 v[66:67], v250 offset:13056
    ds_read_b64_tr_b16 v[26:27], v251 offset:0
    ds_read_b64_tr_b16 v[28:29], v251 offset:768
    v_mov_b32 v124, 0
    v_mov_b32 v125, 0
    v_mov_b32 v126, 0
    v_mov_b32 v127, 0
    s_waitcnt lgkmcnt(10)
    v_mfma_f32_32x32x16_bf16 v[96:111], v[48:51], v[128:131], 0
    ds_read_b64_tr_b16 v[68:69], v250 offset:15360
    ds_read_b64_tr_b16 v[70:71], v250 offset:16128
    s_waitcnt lgkmcnt(10)
    v_mfma_f32_32x32x16_bf16 v[96:111], v[52:55], v[132:135], v[96:111]
    ds_read_b64_tr_b16 v[72:73], v250 offset:18432
    ds_read_b64_tr_b16 v[74:75], v250 offset:19200
    s_waitcnt lgkmcnt(5)
    v_mfma_f32_4x4x4_16b_bf16 v[124:127], v[244:245], v[26:27], v[124:127]
    s_waitcnt lgkmcnt(4)
    s_nop 0
    v_mfma_f32_4x4x4_16b_bf16 v[124:127], v[244:245], v[28:29], v[124:127]
    ds_read_b64_tr_b16 v[30:31], v251 offset:12288
    ds_read_b64_tr_b16 v[32:33], v251 offset:13056
    v_mfma_f32_32x32x16_bf16 v[96:111], v[56:59], v[136:139], v[96:111]
    ds_read_b64_tr_b16 v[76:77], v250 offset:21504
    ds_read_b64_tr_b16 v[78:79], v250 offset:22272
    v_mfma_f32_32x32x16_bf16 v[96:111], v[60:63], v[140:143], v[96:111]
    ds_read_b64_tr_b16 v[48:49], v250 offset:24576
    ds_read_b64_tr_b16 v[50:51], v250 offset:25344
    v_mfma_f32_32x32x16_bf16 v[96:111], v[64:67], v[144:147], v[96:111]
    ds_read_b64_tr_b16 v[52:53], v250 offset:27648
    ds_read_b64_tr_b16 v[54:55], v250 offset:28416
    s_waitcnt lgkmcnt(7)
    v_mfma_f32_4x4x4_16b_bf16 v[124:127], v[244:245], v[30:31], v[124:127]
    s_waitcnt lgkmcnt(6)
    s_nop 0
    v_mfma_f32_4x4x4_16b_bf16 v[124:127], v[244:245], v[32:33], v[124:127]
    ds_read_b64_tr_b16 v[26:27], v251 offset:24576
    ds_read_b64_tr_b16 v[28:29], v251 offset:25344
    v_mfma_f32_32x32x16_bf16 v[96:111], v[68:71], v[148:151], v[96:111]
    ds_read_b64_tr_b16 v[56:57], v250 offset:30720
    ds_read_b64_tr_b16 v[58:59], v250 offset:31488
    v_mfma_f32_32x32x16_bf16 v[96:111], v[72:75], v[152:155], v[96:111]
    ds_read_b64_tr_b16 v[60:61], v250 offset:33792
    ds_read_b64_tr_b16 v[62:63], v250 offset:34560
    s_waitcnt lgkmcnt(10)
    v_mfma_f32_32x32x16_bf16 v[96:111], v[76:79], v[156:159], v[96:111]
    ds_read_b64_tr_b16 v[64:65], v250 offset:36864
    ds_read_b64_tr_b16 v[66:67], v250 offset:37632
    s_waitcnt lgkmcnt(7)
    v_mfma_f32_4x4x4_16b_bf16 v[124:127], v[244:245], v[26:27], v[124:127]
    s_waitcnt lgkmcnt(6)
    s_nop 0
    v_mfma_f32_4x4x4_16b_bf16 v[124:127], v[244:245], v[28:29], v[124:127]
    ds_read_b64_tr_b16 v[30:31], v251 offset:36864
    ds_read_b64_tr_b16 v[32:33], v251 offset:37632
    v_mfma_f32_32x32x16_bf16 v[96:111], v[48:51], v[160:163], v[96:111]
    ds_read_b64_tr_b16 v[68:69], v250 offset:39936
    ds_read_b64_tr_b16 v[70:71], v250 offset:40704
    v_mfma_f32_32x32x16_bf16 v[96:111], v[52:55], v[164:167], v[96:111]
    ds_read_b64_tr_b16 v[72:73], v252 offset:0
    ds_read_b64_tr_b16 v[74:75], v252 offset:768
    s_waitcnt lgkmcnt(10)
    v_mfma_f32_32x32x16_bf16 v[96:111], v[56:59], v[168:171], v[96:111]
    ds_read_b64_tr_b16 v[76:77], v252 offset:3072
    ds_read_b64_tr_b16 v[78:79], v252 offset:3840
    s_waitcnt lgkmcnt(7)
    v_mfma_f32_4x4x4_16b_bf16 v[124:127], v[244:245], v[30:31], v[124:127]
    s_waitcnt lgkmcnt(6)
    s_nop 0
    v_mfma_f32_4x4x4_16b_bf16 v[124:127], v[244:245], v[32:33], v[124:127]
    ds_read_b64_tr_b16 v[26:27], v253 offset:6144
    ds_read_b64_tr_b16 v[28:29], v253 offset:6912
    v_mfma_f32_32x32x16_bf16 v[96:111], v[60:63], v[172:175], v[96:111]
    ds_read_b64_tr_b16 v[48:49], v252 offset:6144
    ds_read_b64_tr_b16 v[50:51], v252 offset:6912
    v_mfma_f32_32x32x16_bf16 v[96:111], v[64:67], v[176:179], v[96:111]
    ds_read_b64_tr_b16 v[52:53], v252 offset:9216
    ds_read_b64_tr_b16 v[54:55], v252 offset:9984
    s_waitcnt lgkmcnt(10)
    v_mfma_f32_32x32x16_bf16 v[96:111], v[68:71], v[180:183], v[96:111]
    ds_read_b64_tr_b16 v[56:57], v252 offset:12288
    ds_read_b64_tr_b16 v[58:59], v252 offset:13056
    s_waitcnt lgkmcnt(7)
    v_mfma_f32_4x4x4_16b_bf16 v[124:127], v[244:245], v[26:27], v[124:127]
    s_waitcnt lgkmcnt(6)
    s_nop 0
    v_mfma_f32_4x4x4_16b_bf16 v[124:127], v[244:245], v[28:29], v[124:127]
    ds_read_b64_tr_b16 v[30:31], v253 offset:18432
    ds_read_b64_tr_b16 v[32:33], v253 offset:19200
    v_mfma_f32_32x32x16_bf16 v[96:111], v[72:75], v[184:187], v[96:111]
    ds_read_b64_tr_b16 v[60:61], v252 offset:15360
    ds_read_b64_tr_b16 v[62:63], v252 offset:16128
    v_mfma_f32_32x32x16_bf16 v[96:111], v[76:79], v[188:191], v[96:111]
    ds_read_b64_tr_b16 v[64:65], v252 offset:18432
    ds_read_b64_tr_b16 v[66:67], v252 offset:19200
    s_waitcnt lgkmcnt(10)
    v_mfma_f32_32x32x16_bf16 v[96:111], v[48:51], v[192:195], v[96:111]
    ds_read_b64_tr_b16 v[68:69], v252 offset:21504
    ds_read_b64_tr_b16 v[70:71], v252 offset:22272
    s_waitcnt lgkmcnt(7)
    v_mfma_f32_4x4x4_16b_bf16 v[124:127], v[244:245], v[30:31], v[124:127]
    s_waitcnt lgkmcnt(6)
    s_nop 0
    v_mfma_f32_4x4x4_16b_bf16 v[124:127], v[244:245], v[32:33], v[124:127]
    ds_read_b64_tr_b16 v[26:27], v253 offset:30720
    ds_read_b64_tr_b16 v[28:29], v253 offset:31488
    v_mfma_f32_32x32x16_bf16 v[96:111], v[52:55], v[196:199], v[96:111]
    ds_read_b64_tr_b16 v[72:73], v252 offset:24576
    ds_read_b64_tr_b16 v[74:75], v252 offset:25344
    v_mfma_f32_32x32x16_bf16 v[96:111], v[56:59], v[200:203], v[96:111]
    ds_read_b64_tr_b16 v[76:77], v252 offset:27648
    ds_read_b64_tr_b16 v[78:79], v252 offset:28416
    s_waitcnt lgkmcnt(10)
    v_mfma_f32_32x32x16_bf16 v[96:111], v[60:63], v[204:207], v[96:111]
    ds_read_b64_tr_b16 v[48:49], v252 offset:30720
    ds_read_b64_tr_b16 v[50:51], v252 offset:31488
    s_waitcnt lgkmcnt(7)
    v_mfma_f32_4x4x4_16b_bf16 v[124:127], v[244:245], v[26:27], v[124:127]
    s_waitcnt lgkmcnt(6)
    s_nop 0
    v_mfma_f32_4x4x4_16b_bf16 v[124:127], v[244:245], v[28:29], v[124:127]
    v_mfma_f32_32x32x16_bf16 v[96:111], v[64:67], v[208:211], v[96:111]
    ds_read_b64_tr_b16 v[52:53], v252 offset:33792
    ds_read_b64_tr_b16 v[54:55], v252 offset:34560
    v_mfma_f32_32x32x16_bf16 v[96:111], v[68:71], v[212:215], v[96:111]
    ds_read_b64_tr_b16 v[56:57], v252 offset:36864
    ds_read_b64_tr_b16 v[58:59], v252 offset:37632
    s_waitcnt lgkmcnt(8)
    v_mfma_f32_32x32x16_bf16 v[96:111], v[72:75], v[216:219], v[96:111]
    ds_read_b64_tr_b16 v[60:61], v252 offset:39936
    ds_read_b64_tr_b16 v[62:63], v252 offset:40704
    s_waitcnt lgkmcnt(8)
    v_mfma_f32_32x32x16_bf16 v[96:111], v[76:79], v[220:223], v[96:111]
    v_mov_b32 v46, v124
    v_mov_b32 v33, v124
    s_nop 1
    v_permlane32_swap_b32 v46, v33
    v_add_f32 v46, v46, v33
    ds_write_b32 v249, v46
    s_waitcnt lgkmcnt(7)
    v_mfma_f32_32x32x16_bf16 v[96:111], v[48:51], v[224:227], v[96:111]
    s_waitcnt lgkmcnt(5)
    v_mfma_f32_32x32x16_bf16 v[96:111], v[52:55], v[228:231], v[96:111]
    s_waitcnt lgkmcnt(3)
    v_mfma_f32_32x32x16_bf16 v[96:111], v[56:59], v[232:235], v[96:111]
    s_waitcnt lgkmcnt(1)
    v_mfma_f32_32x32x16_bf16 v[96:111], v[60:63], v[236:239], v[96:111]
    s_waitcnt lgkmcnt(0)
    s_barrier
    s_branch KA_JOIN
KA_NOSECOND:
    s_add_u32 s88, s17, 12
    s_mul_i32 s89, s88, 3072
    s_lshr_b32 s87, s88, 2
    s_add_u32 s87, s87, s64
    s_sub_u32 s83, s87, 7
    s_cmp_ge_u32 s87, 7
    s_cselect_b32 s87, s83, s87
    s_lshl_b32 s87, s87, 2
    s_and_b32 s88, s88, 3
    s_add_u32 s87, s87, s88
    s_mul_i32 s87, s87, 43008
    s_add_u32 s87, s87, s63
    s_add_u32 m0, s89, 73728
    s_nop 0
    buffer_load_dwordx4 v12, s[36:39], s87 offen lds
    s_add_u32 m0, s89, 74752
    s_nop 0
    buffer_load_dwordx4 v13, s[36:39], s87 offen lds
    s_add_u32 m0, s89, 75776
    s_nop 0
    buffer_load_dwordx4 v14, s[36:39], s87 offen lds
    s_add_u32 s88, s17, 24
    s_mul_i32 s89, s88, 3072
    s_lshr_b32 s87, s88, 2
    s_add_u32 s87, s87, s64
    s_sub_u32 s83, s87, 7
    s_cmp_ge_u32 s87, 7
    s_cselect_b32 s87, s83, s87
    s_lshl_b32 s87, s87, 2
    s_and_b32 s88, s88, 3
    s_add_u32 s87, s87, s88
    s_mul_i32 s87, s87, 43008
    s_add_u32 s87, s87, s63
    s_add_u32 m0, s89, 73728
    s_nop 0
    buffer_load_dwordx4 v12, s[36:39], s87 offen lds
    s_add_u32 m0, s89, 74752
    s_nop 0
    buffer_load_dwordx4 v13, s[36:39], s87 offen lds
    s_add_u32 m0, s89, 75776
    s_nop 0
    buffer_load_dwordx4 v14, s[36:39], s87 offen lds
    s_waitcnt vmcnt(0)
    s_barrier
    v_add_u32 v250, 0, v15
    s_mul_i32 s51, s17, 3072
    v_add_u32 v251, s51, v250
    v_add_u32 v252, 43008, v250
    v_add_u32 v253, 43008, v251
    ds_read_b64_tr_b16 v[48:49], v250 offset:0
    ds_read_b64_tr_b16 v[50:51], v250 offset:768
    ds_read_b64_tr_b16 v[52:53], v250 offset:3072
    ds_read_b64_tr_b16 v[54:55], v250 offset:3840
    ds_read_b64_tr_b16 v[56:57], v250 offset:6144
    ds_read_b64_tr_b16 v[58:59], v250 offset:6912
    ds_read_b64_tr_b16 v[60:61], v250 offset:9216
    ds_read_b64_tr_b16 v[62:63], v250 offset:9984
    ds_read_b64_tr_b16 v[64:65], v250 offset:12288
    ds_read_b64_tr_b16 v[66:67], v250 offset:13056
    ds_read_b64_tr_b16 v[26:27], v251 offset:0
    ds_read_b64_tr_b16 v[28:29], v251 offset:768
    v_mov_b32 v124, 0
    v_mov_b32 v125, 0
    v_mov_b32 v126, 0
    v_mov_b32 v127, 0
    s_waitcnt lgkmcnt(10)
    v_mfma_f32_32x32x16_bf16 v[96:111], v[48:51], v[128:131], 0
    ds_read_b64_tr_b16 v[68:69], v250 offset:15360
    ds_read_b64_tr_b16 v[70:71], v250 offset:16128
    s_waitcnt lgkmcnt(10)
    v_mfma_f32_32x32x16_bf16 v[96:111], v[52:55], v[132:135], v[96:111]
    ds_read_b64_tr_b16 v[72:73], v250 offset:18432
    ds_read_b64_tr_b16 v[74:75], v250 offset:19200
    s_waitcnt lgkmcnt(5)
    v_mfma_f32_4x4x4_16b_bf16 v[124:127], v[244:245], v[26:27], v[124:127]
    s_waitcnt lgkmcnt(4)
    s_nop 0
    v_mfma_f32_4x4x4_16b_bf16 v[124:127], v[244:245], v[28:29], v[124:127]
    ds_read_b64_tr_b16 v[30:31], v251 offset:12288
    ds_read_b64_tr_b16 v[32:33], v251 offset:13056
    v_mfma_f32_32x32x16_bf16 v[96:111], v[56:59], v[136:139], v[96:111]
    ds_read_b64_tr_b16 v[76:77], v250 offset:21504
    ds_read_b64_tr_b16 v[78:79], v250 offset:22272
    v_mfma_f32_32x32x16_bf16 v[96:111], v[60:63], v[140:143], v[96:111]
    ds_read_b64_tr_b16 v[48:49], v250 offset:24576
    ds_read_b64_tr_b16 v[50:51], v250 offset:25344
    v_mfma_f32_32x32x16_bf16 v[96:111], v[64:67], v[144:147], v[96:111]
    ds_read_b64_tr_b16 v[52:53], v250 offset:27648
    ds_read_b64_tr_b16 v[54:55], v250 offset:28416
    s_waitcnt lgkmcnt(7)
    v_mfma_f32_4x4x4_16b_bf16 v[124:127], v[244:245], v[30:31], v[124:127]
    s_waitcnt lgkmcnt(6)
    s_nop 0
    v_mfma_f32_4x4x4_16b_bf16 v[124:127], v[244:245], v[32:33], v[124:127]
    ds_read_b64_tr_b16 v[26:27], v251 offset:24576
    ds_read_b64_tr_b16 v[28:29], v251 offset:25344
    v_mfma_f32_32x32x16_bf16 v[96:111], v[68:71], v[148:151], v[96:111]
    ds_read_b64_tr_b16 v[56:57], v250 offset:30720
    ds_read_b64_tr_b16 v[58:59], v250 offset:31488
    v_mfma_f32_32x32x16_bf16 v[96:111], v[72:75], v[152:155], v[96:111]
    ds_read_b64_tr_b16 v[60:61], v250 offset:33792
    ds_read_b64_tr_b16 v[62:63], v250 offset:34560
    s_waitcnt lgkmcnt(10)
    v_mfma_f32_32x32x16_bf16 v[96:111], v[76:79], v[156:159], v[96:111]
    ds_read_b64_tr_b16 v[64:65], v250 offset:36864
    ds_read_b64_tr_b16 v[66:67], v250 offset:37632
    s_waitcnt lgkmcnt(7)
    v_mfma_f32_4x4x4_16b_bf16 v[124:127], v[244:245], v[26:27], v[124:127]
    s_waitcnt lgkmcnt(6)
    s_nop 0
    v_mfma_f32_4x4x4_16b_bf16 v[124:127], v[244:245], v[28:29], v[124:127]
    ds_read_b64_tr_b16 v[30:31], v251 offset:36864
    ds_read_b64_tr_b16 v[32:33], v251 offset:37632
    v_mfma_f32_32x32x16_bf16 v[96:111], v[48:51], v[160:163], v[96:111]
    ds_read_b64_tr_b16 v[68:69], v250 offset:39936
    ds_read_b64_tr_b16 v[70:71], v250 offset:40704
    v_mfma_f32_32x32x16_bf16 v[96:111], v[52:55], v[164:167], v[96:111]
    ds_read_b64_tr_b16 v[72:73], v252 offset:0
    ds_read_b64_tr_b16 v[74:75], v252 offset:768
    s_waitcnt lgkmcnt(10)
    v_mfma_f32_32x32x16_bf16 v[96:111], v[56:59], v[168:171], v[96:111]
    ds_read_b64_tr_b16 v[76:77], v252 offset:3072
    ds_read_b64_tr_b16 v[78:79], v252 offset:3840
    s_waitcnt lgkmcnt(7)
    v_mfma_f32_4x4x4_16b_bf16 v[124:127], v[244:245], v[30:31], v[124:127]
    s_waitcnt lgkmcnt(6)
    s_nop 0
    v_mfma_f32_4x4x4_16b_bf16 v[124:127], v[244:245], v[32:33], v[124:127]
    ds_read_b64_tr_b16 v[26:27], v253 offset:6144
    ds_read_b64_tr_b16 v[28:29], v253 offset:6912
    v_mfma_f32_32x32x16_bf16 v[96:111], v[60:63], v[172:175], v[96:111]
    ds_read_b64_tr_b16 v[48:49], v252 offset:6144
    ds_read_b64_tr_b16 v[50:51], v252 offset:6912
    v_mfma_f32_32x32x16_bf16 v[96:111], v[64:67], v[176:179], v[96:111]
    ds_read_b64_tr_b16 v[52:53], v252 offset:9216
    ds_read_b64_tr_b16 v[54:55], v252 offset:9984
    s_waitcnt lgkmcnt(10)
    v_mfma_f32_32x32x16_bf16 v[96:111], v[68:71], v[180:183], v[96:111]
    ds_read_b64_tr_b16 v[56:57], v252 offset:12288
    ds_read_b64_tr_b16 v[58:59], v252 offset:13056
    s_waitcnt lgkmcnt(7)
    v_mfma_f32_4x4x4_16b_bf16 v[124:127], v[244:245], v[26:27], v[124:127]
    s_waitcnt lgkmcnt(6)
    s_nop 0
    v_mfma_f32_4x4x4_16b_bf16 v[124:127], v[244:245], v[28:29], v[124:127]
    ds_read_b64_tr_b16 v[30:31], v253 offset:18432
    ds_read_b64_tr_b16 v[32:33], v253 offset:19200
    v_mfma_f32_32x32x16_bf16 v[96:111], v[72:75], v[184:187], v[96:111]
    ds_read_b64_tr_b16 v[60:61], v252 offset:15360
    ds_read_b64_tr_b16 v[62:63], v252 offset:16128
    v_mfma_f32_32x32x16_bf16 v[96:111], v[76:79], v[188:191], v[96:111]
    ds_read_b64_tr_b16 v[64:65], v252 offset:18432
    ds_read_b64_tr_b16 v[66:67], v252 offset:19200
    s_waitcnt lgkmcnt(10)
    v_mfma_f32_32x32x16_bf16 v[96:111], v[48:51], v[192:195], v[96:111]
    ds_read_b64_tr_b16 v[68:69], v252 offset:21504
    ds_read_b64_tr_b16 v[70:71], v252 offset:22272
    s_waitcnt lgkmcnt(7)
    v_mfma_f32_4x4x4_16b_bf16 v[124:127], v[244:245], v[30:31], v[124:127]
    s_waitcnt lgkmcnt(6)
    s_nop 0
    v_mfma_f32_4x4x4_16b_bf16 v[124:127], v[244:245], v[32:33], v[124:127]
    ds_read_b64_tr_b16 v[26:27], v253 offset:30720
    ds_read_b64_tr_b16 v[28:29], v253 offset:31488
    v_mfma_f32_32x32x16_bf16 v[96:111], v[52:55], v[196:199], v[96:111]
    ds_read_b64_tr_b16 v[72:73], v252 offset:24576
    ds_read_b64_tr_b16 v[74:75], v252 offset:25344
    v_mfma_f32_32x32x16_bf16 v[96:111], v[56:59], v[200:203], v[96:111]
    ds_read_b64_tr_b16 v[76:77], v252 offset:27648
    ds_read_b64_tr_b16 v[78:79], v252 offset:28416
    s_waitcnt lgkmcnt(10)
    v_mfma_f32_32x32x16_bf16 v[96:111], v[60:63], v[204:207], v[96:111]
    ds_read_b64_tr_b16 v[48:49], v252 offset:30720
    ds_read_b64_tr_b16 v[50:51], v252 offset:31488
    s_waitcnt lgkmcnt(7)
    v_mfma_f32_4x4x4_16b_bf16 v[124:127], v[244:245], v[26:27], v[124:127]
    s_waitcnt lgkmcnt(6)
    s_nop 0
    v_mfma_f32_4x4x4_16b_bf16 v[124:127], v[244:245], v[28:29], v[124:127]
    v_mfma_f32_32x32x16_bf16 v[96:111], v[64:67], v[208:211], v[96:111]
    ds_read_b64_tr_b16 v[52:53], v252 offset:33792
    ds_read_b64_tr_b16 v[54:55], v252 offset:34560
    v_mfma_f32_32x32x16_bf16 v[96:111], v[68:71], v[212:215], v[96:111]
    ds_read_b64_tr_b16 v[56:57], v252 offset:36864
    ds_read_b64_tr_b16 v[58:59], v252 offset:37632
    s_waitcnt lgkmcnt(8)
    v_mfma_f32_32x32x16_bf16 v[96:111], v[72:75], v[216:219], v[96:111]
    ds_read_b64_tr_b16 v[60:61], v252 offset:39936
    ds_read_b64_tr_b16 v[62:63], v252 offset:40704
    s_waitcnt lgkmcnt(8)
    v_mfma_f32_32x32x16_bf16 v[96:111], v[76:79], v[220:223], v[96:111]
    v_mov_b32 v46, v124
    v_mov_b32 v33, v124
    s_nop 1
    v_permlane32_swap_b32 v46, v33
    v_add_f32 v46, v46, v33
    ds_write_b32 v249, v46
    s_waitcnt lgkmcnt(7)
    v_mfma_f32_32x32x16_bf16 v[96:111], v[48:51], v[224:227], v[96:111]
    s_waitcnt lgkmcnt(5)
    v_mfma_f32_32x32x16_bf16 v[96:111], v[52:55], v[228:231], v[96:111]
    s_waitcnt lgkmcnt(3)
    v_mfma_f32_32x32x16_bf16 v[96:111], v[56:59], v[232:235], v[96:111]
    s_waitcnt lgkmcnt(1)
    v_mfma_f32_32x32x16_bf16 v[96:111], v[60:63], v[236:239], v[96:111]
    s_waitcnt lgkmcnt(0)
    s_barrier
KA_JOIN:
    s_mul_i32 s62, s20, 3
    s_lshr_b32 s52, s62, 4
    s_and_b32 s53, s62, 15
    v_mov_b32 v46, v17
    s_cmp_lg_u32 s52, 0
    s_cbranch_scc1 KAH0_NQ
    v_mul_f32 v46, 0x3e8b97f6, v46
KAH0_NQ:
    ds_read_b32 v26, v247
    ds_read_b32 v27, v247 offset:128
    s_waitcnt lgkmcnt(1)
    v_and_b32 v32, 0xffff0000, v26
    v_sub_f32 v33, v26, v32
    v_lshrrev_b32 v29, 16, v32
    v_and_or_b32 v28, v33, s60, v29
    s_waitcnt lgkmcnt(0)
    v_and_b32 v32, 0xffff0000, v27
    v_sub_f32 v33, v27, v32
    v_lshrrev_b32 v31, 16, v32
    v_and_or_b32 v30, v33, s60, v31
    s_nop 1
    v_mfma_f32_32x32x16_bf16 v[96:111], v[28:31], v[42:45], v[96:111]
    s_nop 11
    v_mul_f32 v96, v96, v46
    v_mul_f32 v97, v97, v46
    v_mul_f32 v98, v98, v46
    v_mul_f32 v99, v99, v46
    v_mul_f32 v100, v100, v46
    v_mul_f32 v101, v101, v46
    v_mul_f32 v102, v102, v46
    v_mul_f32 v103, v103, v46
    v_mul_f32 v104, v104, v46
    v_mul_f32 v105, v105, v46
    v_mul_f32 v106, v106, v46
    v_mul_f32 v107, v107, v46
    v_mul_f32 v108, v108, v46
    v_mul_f32 v109, v109, v46
    v_mul_f32 v110, v110, v46
    v_mul_f32 v111, v111, v46
    s_cmp_eq_u32 s52, 0
    s_cselect_b32 s54, 0, 1.0
    s_cmp_eq_u32 s52, 1
    s_cselect_b32 s55, 1.0, 0
    s_mov_b64 exec, s[58:59]
    v_mov_b32 v108, s54
    v_mov_b32 v109, s55
    v_mov_b32 v110, 0
    v_mov_b32 v111, 0
    s_mov_b64 exec, -1
    v_cvt_pk_bf16_f32 v34, v96, v97
    v_cvt_pk_bf16_f32 v35, v98, v99
    v_cvt_pk_bf16_f32 v36, v100, v101
    v_cvt_pk_bf16_f32 v37, v102, v103
    v_cvt_pk_bf16_f32 v38, v104, v105
    v_cvt_pk_bf16_f32 v39, v106, v107
    v_cvt_pk_bf16_f32 v40, v108, v109
    v_cvt_pk_bf16_f32 v41, v110, v111
    s_lshl_b32 s54, s53, 6
    s_add_u32 s54, s54, s22
    s_cmp_eq_u32 s52, 2
    s_cbranch_scc1 KAH0_V
    s_lshl_b32 s55, s54, 11
    s_add_u32 s55, s55, 0
    s_lshl_b32 s54, s54, 12
    s_add_u32 s54, s54, 2097152
    s_cmp_eq_u32 s52, 0
    s_cselect_b32 s54, s55, s54
    buffer_store_dwordx4 v[34:37], v1, s[24:27], s54 offen offset:0 sc1
    buffer_store_dwordx4 v[38:41], v1, s[24:27], s54 offen offset:1024 sc1
    s_branch KAH0_D
KAH0_V:
    ds_write_b64 v241, v[34:35] offset:0
    ds_write_b64 v241, v[36:37] offset:16
    ds_write_b64 v241, v[38:39] offset:32
    ds_write_b64 v241, v[40:41] offset:48
    s_waitcnt lgkmcnt(0)
    ds_read_b64_tr_b16 v[20:21], v242 offset:0
    ds_read_b64_tr_b16 v[22:23], v242 offset:576
    ds_read_b64_tr_b16 v[24:25], v242 offset:1152
    ds_read_b64_tr_b16 v[26:27], v242 offset:1728
    s_lshl_b32 s54, s54, 12
    s_add_u32 s54, s54, 2099200
    s_waitcnt lgkmcnt(2)
    buffer_store_dwordx4 v[20:23], v1, s[24:27], s54 offen offset:0 sc1
    s_waitcnt lgkmcnt(0)
    buffer_store_dwordx4 v[24:27], v1, s[24:27], s54 offen offset:1024 sc1
KAH0_D:
    v_add_u32 v250, 112, v15
    s_mul_i32 s51, s17, 3072
    v_add_u32 v251, s51, v250
    v_add_u32 v252, 43008, v250
    v_add_u32 v253, 43008, v251
    ds_read_b64_tr_b16 v[48:49], v250 offset:0
    ds_read_b64_tr_b16 v[50:51], v250 offset:768
    ds_read_b64_tr_b16 v[52:53], v250 offset:3072
    ds_read_b64_tr_b16 v[54:55], v250 offset:3840
    ds_read_b64_tr_b16 v[56:57], v250 offset:6144
    ds_read_b64_tr_b16 v[58:59], v250 offset:6912
    ds_read_b64_tr_b16 v[60:61], v250 offset:9216
    ds_read_b64_tr_b16 v[62:63], v250 offset:9984
    ds_read_b64_tr_b16 v[64:65], v250 offset:12288
    ds_read_b64_tr_b16 v[66:67], v250 offset:13056
    ds_read_b64_tr_b16 v[26:27], v251 offset:0
    ds_read_b64_tr_b16 v[28:29], v251 offset:768
    s_barrier
    v_mov_b32 v124, 0
    v_mov_b32 v125, 0
    v_mov_b32 v126, 0
    v_mov_b32 v127, 0
    s_waitcnt lgkmcnt(10)
    v_mfma_f32_32x32x16_bf16 v[96:111], v[48:51], v[128:131], 0
    ds_read_b64_tr_b16 v[68:69], v250 offset:15360
    ds_read_b64_tr_b16 v[70:71], v250 offset:16128
    s_waitcnt lgkmcnt(10)
    v_mfma_f32_32x32x16_bf16 v[96:111], v[52:55], v[132:135], v[96:111]
    ds_read_b64_tr_b16 v[72:73], v250 offset:18432
    ds_read_b64_tr_b16 v[74:75], v250 offset:19200
    s_waitcnt lgkmcnt(5)
    v_mfma_f32_4x4x4_16b_bf16 v[124:127], v[244:245], v[26:27], v[124:127]
    s_waitcnt lgkmcnt(4)
    s_nop 0
    v_mfma_f32_4x4x4_16b_bf16 v[124:127], v[244:245], v[28:29], v[124:127]
    ds_read_b64_tr_b16 v[30:31], v251 offset:12288
    ds_read_b64_tr_b16 v[32:33], v251 offset:13056
    v_mfma_f32_32x32x16_bf16 v[96:111], v[56:59], v[136:139], v[96:111]
    ds_read_b64_tr_b16 v[76:77], v250 offset:21504
    ds_read_b64_tr_b16 v[78:79], v250 offset:22272
    v_mfma_f32_32x32x16_bf16 v[96:111], v[60:63], v[140:143], v[96:111]
    ds_read_b64_tr_b16 v[48:49], v250 offset:24576
    ds_read_b64_tr_b16 v[50:51], v250 offset:25344
    v_mfma_f32_32x32x16_bf16 v[96:111], v[64:67], v[144:147], v[96:111]
    ds_read_b64_tr_b16 v[52:53], v250 offset:27648
    ds_read_b64_tr_b16 v[54:55], v250 offset:28416
    s_waitcnt lgkmcnt(7)
    v_mfma_f32_4x4x4_16b_bf16 v[124:127], v[244:245], v[30:31], v[124:127]
    s_waitcnt lgkmcnt(6)
    s_nop 0
    v_mfma_f32_4x4x4_16b_bf16 v[124:127], v[244:245], v[32:33], v[124:127]
    ds_read_b64_tr_b16 v[26:27], v251 offset:24576
    ds_read_b64_tr_b16 v[28:29], v251 offset:25344
    v_mfma_f32_32x32x16_bf16 v[96:111], v[68:71], v[148:151], v[96:111]
    ds_read_b64_tr_b16 v[56:57], v250 offset:30720
    ds_read_b64_tr_b16 v[58:59], v250 offset:31488
    v_mfma_f32_32x32x16_bf16 v[96:111], v[72:75], v[152:155], v[96:111]
    ds_read_b64_tr_b16 v[60:61], v250 offset:33792
    ds_read_b64_tr_b16 v[62:63], v250 offset:34560
    s_waitcnt lgkmcnt(10)
    v_mfma_f32_32x32x16_bf16 v[96:111], v[76:79], v[156:159], v[96:111]
    ds_read_b64_tr_b16 v[64:65], v250 offset:36864
    ds_read_b64_tr_b16 v[66:67], v250 offset:37632
    s_waitcnt lgkmcnt(7)
    v_mfma_f32_4x4x4_16b_bf16 v[124:127], v[244:245], v[26:27], v[124:127]
    s_waitcnt lgkmcnt(6)
    s_nop 0
    v_mfma_f32_4x4x4_16b_bf16 v[124:127], v[244:245], v[28:29], v[124:127]
    ds_read_b64_tr_b16 v[30:31], v251 offset:36864
    ds_read_b64_tr_b16 v[32:33], v251 offset:37632
    v_mfma_f32_32x32x16_bf16 v[96:111], v[48:51], v[160:163], v[96:111]
    ds_read_b64_tr_b16 v[68:69], v250 offset:39936
    ds_read_b64_tr_b16 v[70:71], v250 offset:40704
    v_mfma_f32_32x32x16_bf16 v[96:111], v[52:55], v[164:167], v[96:111]
    ds_read_b64_tr_b16 v[72:73], v252 offset:0
    ds_read_b64_tr_b16 v[74:75], v252 offset:768
    s_waitcnt lgkmcnt(10)
    v_mfma_f32_32x32x16_bf16 v[96:111], v[56:59], v[168:171], v[96:111]
    ds_read_b64_tr_b16 v[76:77], v252 offset:3072
    ds_read_b64_tr_b16 v[78:79], v252 offset:3840
    s_waitcnt lgkmcnt(7)
    v_mfma_f32_4x4x4_16b_bf16 v[124:127], v[244:245], v[30:31], v[124:127]
    s_waitcnt lgkmcnt(6)
    s_nop 0
    v_mfma_f32_4x4x4_16b_bf16 v[124:127], v[244:245], v[32:33], v[124:127]
    ds_read_b64_tr_b16 v[26:27], v253 offset:6144
    ds_read_b64_tr_b16 v[28:29], v253 offset:6912
    v_mfma_f32_32x32x16_bf16 v[96:111], v[60:63], v[172:175], v[96:111]
    ds_read_b64_tr_b16 v[48:49], v252 offset:6144
    ds_read_b64_tr_b16 v[50:51], v252 offset:6912
    v_mfma_f32_32x32x16_bf16 v[96:111], v[64:67], v[176:179], v[96:111]
    ds_read_b64_tr_b16 v[52:53], v252 offset:9216
    ds_read_b64_tr_b16 v[54:55], v252 offset:9984
    s_waitcnt lgkmcnt(10)
    v_mfma_f32_32x32x16_bf16 v[96:111], v[68:71], v[180:183], v[96:111]
    ds_read_b64_tr_b16 v[56:57], v252 offset:12288
    ds_read_b64_tr_b16 v[58:59], v252 offset:13056
    s_waitcnt lgkmcnt(7)
    v_mfma_f32_4x4x4_16b_bf16 v[124:127], v[244:245], v[26:27], v[124:127]
    s_waitcnt lgkmcnt(6)
    s_nop 0
    v_mfma_f32_4x4x4_16b_bf16 v[124:127], v[244:245], v[28:29], v[124:127]
    ds_read_b64_tr_b16 v[30:31], v253 offset:18432
    ds_read_b64_tr_b16 v[32:33], v253 offset:19200
    v_mfma_f32_32x32x16_bf16 v[96:111], v[72:75], v[184:187], v[96:111]
    ds_read_b64_tr_b16 v[60:61], v252 offset:15360
    ds_read_b64_tr_b16 v[62:63], v252 offset:16128
    v_mfma_f32_32x32x16_bf16 v[96:111], v[76:79], v[188:191], v[96:111]
    ds_read_b64_tr_b16 v[64:65], v252 offset:18432
    ds_read_b64_tr_b16 v[66:67], v252 offset:19200
    s_waitcnt lgkmcnt(10)
    v_mfma_f32_32x32x16_bf16 v[96:111], v[48:51], v[192:195], v[96:111]
    ds_read_b64_tr_b16 v[68:69], v252 offset:21504
    ds_read_b64_tr_b16 v[70:71], v252 offset:22272
    s_waitcnt lgkmcnt(7)
    v_mfma_f32_4x4x4_16b_bf16 v[124:127], v[244:245], v[30:31], v[124:127]
    s_waitcnt lgkmcnt(6)
    s_nop 0
    v_mfma_f32_4x4x4_16b_bf16 v[124:127], v[244:245], v[32:33], v[124:127]
    ds_read_b64_tr_b16 v[26:27], v253 offset:30720
    ds_read_b64_tr_b16 v[28:29], v253 offset:31488
    v_mfma_f32_32x32x16_bf16 v[96:111], v[52:55], v[196:199], v[96:111]
    ds_read_b64_tr_b16 v[72:73], v252 offset:24576
    ds_read_b64_tr_b16 v[74:75], v252 offset:25344
    v_mfma_f32_32x32x16_bf16 v[96:111], v[56:59], v[200:203], v[96:111]
    ds_read_b64_tr_b16 v[76:77], v252 offset:27648
    ds_read_b64_tr_b16 v[78:79], v252 offset:28416
    s_waitcnt lgkmcnt(10)
    v_mfma_f32_32x32x16_bf16 v[96:111], v[60:63], v[204:207], v[96:111]
    ds_read_b64_tr_b16 v[48:49], v252 offset:30720
    ds_read_b64_tr_b16 v[50:51], v252 offset:31488
    s_waitcnt lgkmcnt(7)
    v_mfma_f32_4x4x4_16b_bf16 v[124:127], v[244:245], v[26:27], v[124:127]
    s_waitcnt lgkmcnt(6)
    s_nop 0
    v_mfma_f32_4x4x4_16b_bf16 v[124:127], v[244:245], v[28:29], v[124:127]
    v_mfma_f32_32x32x16_bf16 v[96:111], v[64:67], v[208:211], v[96:111]
    ds_read_b64_tr_b16 v[52:53], v252 offset:33792
    ds_read_b64_tr_b16 v[54:55], v252 offset:34560
    v_mfma_f32_32x32x16_bf16 v[96:111], v[68:71], v[212:215], v[96:111]
    ds_read_b64_tr_b16 v[56:57], v252 offset:36864
    ds_read_b64_tr_b16 v[58:59], v252 offset:37632
    s_waitcnt lgkmcnt(8)
    v_mfma_f32_32x32x16_bf16 v[96:111], v[72:75], v[216:219], v[96:111]
    ds_read_b64_tr_b16 v[60:61], v252 offset:39936
    ds_read_b64_tr_b16 v[62:63], v252 offset:40704
    s_waitcnt lgkmcnt(8)
    v_mfma_f32_32x32x16_bf16 v[96:111], v[76:79], v[220:223], v[96:111]
    v_mov_b32 v46, v124
    v_mov_b32 v33, v124
    s_nop 1
    v_permlane32_swap_b32 v46, v33
    v_add_f32 v46, v46, v33
    ds_write_b32 v249, v46
    s_waitcnt lgkmcnt(7)
    v_mfma_f32_32x32x16_bf16 v[96:111], v[48:51], v[224:227], v[96:111]
    s_waitcnt lgkmcnt(5)
    v_mfma_f32_32x32x16_bf16 v[96:111], v[52:55], v[228:231], v[96:111]
    s_waitcnt lgkmcnt(3)
    v_mfma_f32_32x32x16_bf16 v[96:111], v[56:59], v[232:235], v[96:111]
    s_waitcnt lgkmcnt(1)
    v_mfma_f32_32x32x16_bf16 v[96:111], v[60:63], v[236:239], v[96:111]
    s_waitcnt lgkmcnt(0)
    s_barrier
    s_mul_i32 s62, s20, 3
    s_add_u32 s62, s62, 2
    s_lshr_b32 s52, s62, 4
    s_and_b32 s53, s62, 15
    v_mov_b32 v46, v17
    s_cmp_lg_u32 s52, 0
    s_cbranch_scc1 KAH2_NQ
    v_mul_f32 v46, 0x3e8b97f6, v46
KAH2_NQ:
    ds_read_b32 v26, v247
    ds_read_b32 v27, v247 offset:128
    s_waitcnt lgkmcnt(1)
    v_and_b32 v32, 0xffff0000, v26
    v_sub_f32 v33, v26, v32
    v_lshrrev_b32 v29, 16, v32
    v_and_or_b32 v28, v33, s60, v29
    s_waitcnt lgkmcnt(0)
    v_and_b32 v32, 0xffff0000, v27
    v_sub_f32 v33, v27, v32
    v_lshrrev_b32 v31, 16, v32
    v_and_or_b32 v30, v33, s60, v31
    s_nop 1
    v_mfma_f32_32x32x16_bf16 v[96:111], v[28:31], v[42:45], v[96:111]
    s_nop 11
    v_mul_f32 v96, v96, v46
    v_mul_f32 v97, v97, v46
    v_mul_f32 v98, v98, v46
    v_mul_f32 v99, v99, v46
    v_mul_f32 v100, v100, v46
    v_mul_f32 v101, v101, v46
    v_mul_f32 v102, v102, v46
    v_mul_f32 v103, v103, v46
    v_mul_f32 v104, v104, v46
    v_mul_f32 v105, v105, v46
    v_mul_f32 v106, v106, v46
    v_mul_f32 v107, v107, v46
    v_mul_f32 v108, v108, v46
    v_mul_f32 v109, v109, v46
    v_mul_f32 v110, v110, v46
    v_mul_f32 v111, v111, v46
    s_cmp_eq_u32 s52, 0
    s_cselect_b32 s54, 0, 1.0
    s_cmp_eq_u32 s52, 1
    s_cselect_b32 s55, 1.0, 0
    s_mov_b64 exec, s[58:59]
    v_mov_b32 v108, s54
    v_mov_b32 v109, s55
    v_mov_b32 v110, 0
    v_mov_b32 v111, 0
    s_mov_b64 exec, -1
    v_cvt_pk_bf16_f32 v34, v96, v97
    v_cvt_pk_bf16_f32 v35, v98, v99
    v_cvt_pk_bf16_f32 v36, v100, v101
    v_cvt_pk_bf16_f32 v37, v102, v103
    v_cvt_pk_bf16_f32 v38, v104, v105
    v_cvt_pk_bf16_f32 v39, v106, v107
    v_cvt_pk_bf16_f32 v40, v108, v109
    v_cvt_pk_bf16_f32 v41, v110, v111
    s_lshl_b32 s54, s53, 6
    s_add_u32 s54, s54, s22
    s_cmp_eq_u32 s52, 2
    s_cbranch_scc1 KAH2_V
    s_lshl_b32 s55, s54, 11
    s_add_u32 s55, s55, 0
    s_lshl_b32 s54, s54, 12
    s_add_u32 s54, s54, 2097152
    s_cmp_eq_u32 s52, 0
    s_cselect_b32 s54, s55, s54
    buffer_store_dwordx4 v[34:37], v1, s[24:27], s54 offen offset:0 sc1
    buffer_store_dwordx4 v[38:41], v1, s[24:27], s54 offen offset:1024 sc1
    s_branch KAH2_D
KAH2_V:
    ds_write_b64 v241, v[34:35] offset:0
    ds_write_b64 v241, v[36:37] offset:16
    ds_write_b64 v241, v[38:39] offset:32
    ds_write_b64 v241, v[40:41] offset:48
    s_waitcnt lgkmcnt(0)
    ds_read_b64_tr_b16 v[20:21], v242 offset:0
    ds_read_b64_tr_b16 v[22:23], v242 offset:576
    ds_read_b64_tr_b16 v[24:25], v242 offset:1152
    ds_read_b64_tr_b16 v[26:27], v242 offset:1728
    s_lshl_b32 s54, s54, 12
    s_add_u32 s54, s54, 2099200
    s_waitcnt lgkmcnt(2)
    buffer_store_dwordx4 v[20:23], v1, s[24:27], s54 offen offset:0 sc1
    s_waitcnt lgkmcnt(0)
    buffer_store_dwordx4 v[24:27], v1, s[24:27], s54 offen offset:1024 sc1
KAH2_D:
    s_cmp_ge_u32 s20, 14
    s_cbranch_scc1 KA_NOFIN
    v_add_u32 v18, 162816, v246
    ds_read_b64 v[34:35], v18
    s_waitcnt lgkmcnt(0)
    v_fma_f32 v80, v80, v35, -v34
    v_fma_f32 v81, v81, v35, -v34
    v_fma_f32 v82, v82, v35, -v34
    v_fma_f32 v83, v83, v35, -v34
    v_fma_f32 v84, v84, v35, -v34
    v_fma_f32 v85, v85, v35, -v34
    v_fma_f32 v86, v86, v35, -v34
    v_fma_f32 v87, v87, v35, -v34
    v_fma_f32 v88, v88, v35, -v34
    v_fma_f32 v89, v89, v35, -v34
    v_fma_f32 v90, v90, v35, -v34
    v_fma_f32 v91, v91, v35, -v34
    v_fma_f32 v92, v92, v35, -v34
    v_fma_f32 v93, v93, v35, -v34
    v_fma_f32 v94, v94, v35, -v34
    v_fma_f32 v95, v95, v35, -v34
    v_cvt_pk_bf16_f32 v36, v80, v81
    v_cvt_pk_bf16_f32 v37, v82, v83
    v_cvt_pk_bf16_f32 v38, v84, v85
    v_cvt_pk_bf16_f32 v39, v86, v87
    v_cvt_pk_bf16_f32 v40, v88, v89
    v_cvt_pk_bf16_f32 v41, v90, v91
    v_cvt_pk_bf16_f32 v42, v92, v93
    v_cvt_pk_bf16_f32 v43, v94, v95
    ds_write_b64 v241, v[36:37] offset:0
    ds_write_b64 v241, v[38:39] offset:16
    ds_write_b64 v241, v[40:41] offset:32
    ds_write_b64 v241, v[42:43] offset:48
    s_waitcnt lgkmcnt(0)
    ds_read_b64_tr_b16 v[20:21], v243 offset:0
    ds_read_b64_tr_b16 v[22:23], v243 offset:288
    ds_read_b64_tr_b16 v[24:25], v243 offset:1152
    ds_read_b64_tr_b16 v[26:27], v243 offset:1440
    s_lshl_b32 s51, s20, 7
    s_lshl_b32 s52, s22, 1
    s_add_u32 s51, s51, s52
    s_lshl_b32 s51, s51, 11
    s_lshl_b32 s52, s18, 10
    s_add_u32 s51, s51, s52
    s_add_u32 s51, s51, 10485760
    s_waitcnt lgkmcnt(2)
    buffer_store_dwordx4 v[20:23], v1, s[24:27], s51 offen sc1
    s_waitcnt lgkmcnt(0)
    buffer_store_dwordx4 v[24:27], v1, s[24:27], s51 offen offset:2048 sc1
KA_NOFIN:
    s_branch K1_END
K1_GROUPB:
    s_lshl_b32 s50, s19, 7
    s_add_u32 s50, s50, 24117248
    buffer_load_dword v39, v248, s[24:27], s50 offen sc1
    s_add_u32 s65, s64, 0
    s_sub_u32 s83, s65, 7
    s_cmp_ge_u32 s65, 7
    s_cselect_b32 s65, s83, s65
    s_lshl_b32 s49, s65, 7
    s_add_u32 s49, s49, s94
    s_lshl_b32 m0, s16, 11
    s_add_u32 m0, m0, 0
    s_add_u32 s48, s49, 0
    buffer_load_dwordx4 v2, s[28:31], s48 offen lds
    s_lshl_b32 m0, s16, 11
    s_add_u32 m0, m0, 1024
    s_add_u32 s48, s49, 7168
    buffer_load_dwordx4 v3, s[28:31], s48 offen lds
    s_lshl_b32 m0, s16, 10
    s_add_u32 m0, m0, 114688
    s_mul_i32 s48, s65, 229376
    s_add_u32 s48, s48, s95
    buffer_load_dwordx4 v4, s[32:35], s48 offen lds
    s_add_u32 s65, s64, 1
    s_sub_u32 s83, s65, 7
    s_cmp_ge_u32 s65, 7
    s_cselect_b32 s65, s83, s65
    s_lshl_b32 s49, s65, 7
    s_add_u32 s49, s49, s94
    s_lshl_b32 m0, s16, 11
    s_add_u32 m0, m0, 16384
    s_add_u32 s48, s49, 0
    buffer_load_dwordx4 v2, s[28:31], s48 offen lds
    s_lshl_b32 m0, s16, 11
    s_add_u32 m0, m0, 17408
    s_add_u32 s48, s49, 7168
    buffer_load_dwordx4 v3, s[28:31], s48 offen lds
    s_lshl_b32 m0, s16, 10
    s_add_u32 m0, m0, 122880
    s_mul_i32 s48, s65, 229376
    s_add_u32 s48, s48, s95
    buffer_load_dwordx4 v4, s[32:35], s48 offen lds
    s_add_u32 s65, s64, 2
    s_sub_u32 s83, s65, 7
    s_cmp_ge_u32 s65, 7
    s_cselect_b32 s65, s83, s65
    s_lshl_b32 s49, s65, 7
    s_add_u32 s49, s49, s94
    s_lshl_b32 m0, s16, 11
    s_add_u32 m0, m0, 32768
    s_add_u32 s48, s49, 0
    buffer_load_dwordx4 v2, s[28:31], s48 offen lds
    s_lshl_b32 m0, s16, 11
    s_add_u32 m0, m0, 33792
    s_add_u32 s48, s49, 7168
    buffer_load_dwordx4 v3, s[28:31], s48 offen lds
    s_lshl_b32 m0, s16, 10
    s_add_u32 m0, m0, 131072
    s_mul_i32 s48, s65, 229376
    s_add_u32 s48, s48, s95
    buffer_load_dwordx4 v4, s[32:35], s48 offen lds
    s_cmp_lg_u32 s16, 7
    s_cbranch_scc1 K1_CP1
    s_getpc_b64 s[66:67]
K1_PC:
    s_sub_u32 s66, s66, K1_PC-k1_kernel
    s_subb_u32 s67, s67, 0
    s_mul_i32 s51, s15, 10
    v_add_u32 v26, s51, v0
    s_lshl_b32 s52, s2, 1
    s_add_u32 s52, s52, (k2_kernel-k1_kernel)/128-10
    v_add_u32 v27, s52, v0
    v_cmp_gt_u32 vcc, 10, v0
    s_nop 1
    v_cndmask_b32 v26, v27, v26, vcc
    v_lshlrev_b32 v26, 7, v26
    v_min_u32 v26, CODE_END-k1_kernel-4, v26
    v_cmp_gt_u32 vcc, 12, v0
    s_nop 0
    s_and_saveexec_b64 s[68:69], vcc
    global_load_dword v27, v26, s[66:67]
    s_mov_b64 exec, s[68:69]
K1_CP1:
    v_and_b32 v18, 31, v0
    v_lshrrev_b32 v19, 5, v0
    v_lshrrev_b32 v20, 1, v18
    v_and_b32 v20, 7, v20
    v_xor_b32 v20, v20, v19
    v_lshlrev_b32 v18, 7, v18
    s_lshl_b32 s51, s17, 12
    v_add_u32 v18, s51, v18
    v_xor_b32 v21, 0, v20
    v_lshl_add_u32 v5, v21, 4, v18
    v_xor_b32 v21, 2, v20
    v_lshl_add_u32 v6, v21, 4, v18
    v_xor_b32 v21, 4, v20
    v_lshl_add_u32 v7, v21, 4, v18
    v_xor_b32 v21, 6, v20
    v_lshl_add_u32 v8, v21, 4, v18
    v_lshrrev_b32 v18, 4, v0
    v_and_b32 v19, 1, v18
    v_lshrrev_b32 v18, 1, v18
    v_lshrrev_b32 v20, 2, v0
    v_and_b32 v20, 3, v20
    v_and_b32 v21, 3, v0
    v_lshl_add_u32 v22, v18, 3, v20
    v_lshlrev_b32 v23, 7, v22
    v_lshrrev_b32 v24, 1, v21
    v_lshl_add_u32 v24, v19, 1, v24
    s_lshl_b32 s51, s18, 2
    v_add_u32 v24, s51, v24
    v_lshrrev_b32 v25, 1, v20
    v_lshlrev_b32 v25, 2, v25
    v_xor_b32 v24, v24, v25
    v_lshl_add_u32 v23, v24, 4, v23
    v_and_b32 v24, 1, v21
    v_lshl_add_u32 v9, v24, 3, v23
    s_lshl_b32 s51, s17, 11
    v_add_u32 v10, s51, v9
    v_add_u32 v252, 114688, v9
    v_add_u32 v253, 114688, v10
    v_add_u32 v23, 0, v0
    v_mul_u32_u24 v24, 43691, v23
    v_lshrrev_b32 v24, 19, v24
    v_mul_u32_u24 v25, 12, v24
    v_sub_u32 v25, v23, v25
    v_mul_u32_u24 v24, 2688, v24
    v_lshl_add_u32 v12, v25, 4, v24
    v_add_u32 v23, 64, v0
    v_mul_u32_u24 v24, 43691, v23
    v_lshrrev_b32 v24, 19, v24
    v_mul_u32_u24 v25, 12, v24
    v_sub_u32 v25, v23, v25
    v_mul_u32_u24 v24, 2688, v24
    v_lshl_add_u32 v13, v25, 4, v24
    v_add_u32 v23, 128, v0
    v_mul_u32_u24 v24, 43691, v23
    v_lshrrev_b32 v24, 19, v24
    v_mul_u32_u24 v25, 12, v24
    v_sub_u32 v25, v23, v25
    v_mul_u32_u24 v24, 2688, v24
    v_lshl_add_u32 v14, v25, 4, v24
    v_mul_u32_u24 v23, 192, v22
    v_lshl_add_u32 v23, v19, 5, v23
    v_lshl_add_u32 v15, v21, 3, v23
    v_add_u32 v15, 73728, v15
    v_and_b32 v23, 31, v0
    v_mul_u32_u24 v23, 72, v23
    v_lshrrev_b32 v24, 5, v0
    v_lshl_add_u32 v23, v24, 3, v23
    s_mul_i32 s51, s16, 2304
    s_add_u32 s51, s51, 0
    v_add_u32 v241, s51, v23
    v_lshl_add_u32 v23, v18, 2, v20
    v_mul_u32_u24 v23, 72, v23
    v_lshl_add_u32 v23, v19, 5, v23
    v_lshl_add_u32 v23, v21, 3, v23
    v_add_u32 v242, s51, v23
    v_mul_u32_u24 v23, 72, v22
    v_lshl_add_u32 v23, v19, 5, v23
    v_lshl_add_u32 v23, v21, 3, v23
    v_add_u32 v243, s51, v23
    v_and_b32 v23, 31, v0
    v_lshlrev_b32 v23, 2, v23
    s_lshl_b32 s51, s18, 9
    s_add_u32 s51, s51, 159744
    v_add_u32 v23, s51, v23
    s_lshl_b32 s52, s17, 7
    v_add_u32 v249, s52, v23
    v_lshrrev_b32 v24, 5, v0
    v_lshl_add_u32 v247, v24, 8, v23
    v_mov_b32 v244, 0x3f803f80
    v_mov_b32 v245, 0x3f803f80
    v_and_b32 v23, 31, v0
    s_lshl_b32 s51, s17, 5
    v_add_u32 v23, s51, v23
    v_lshlrev_b32 v246, 3, v23
    v_mov_b32 v47, 0xc0135761
    s_waitcnt vmcnt(9)
    v_add_u32 v39, 1, v39
    s_nop 0
    v_readfirstlane_b32 s21, v39
    s_mul_i32 s63, s20, 168
    s_waitcnt vmcnt(6)
    s_barrier
    ds_read_b128 v[128:131], v5 offset:0
    ds_read_b128 v[132:135], v6 offset:0
    ds_read_b128 v[136:139], v7 offset:0
    ds_read_b128 v[140:143], v8 offset:0
    s_add_u32 s65, s64, 3
    s_sub_u32 s83, s65, 7
    s_cmp_ge_u32 s65, 7
    s_cselect_b32 s65, s83, s65
    s_lshl_b32 s49, s65, 7
    s_add_u32 s49, s49, s47
    s_lshl_b32 m0, s17, 12
    s_add_u32 m0, m0, 49152
    s_add_u32 s48, s49, 0
    buffer_load_dwordx4 v2, s[28:31], s48 offen lds
    s_lshl_b32 m0, s17, 12
    s_add_u32 m0, m0, 50176
    s_add_u32 s48, s49, 7168
    buffer_load_dwordx4 v3, s[28:31], s48 offen lds
    s_lshl_b32 m0, s17, 12
    s_add_u32 m0, m0, 51200
    s_add_u32 s48, s49, 14336
    buffer_load_dwordx4 v2, s[28:31], s48 offen lds
    s_lshl_b32 m0, s17, 12
    s_add_u32 m0, m0, 52224
    s_add_u32 s48, s49, 21504
    buffer_load_dwordx4 v3, s[28:31], s48 offen lds
    s_add_u32 s65, s64, 3
    s_sub_u32 s83, s65, 7
    s_cmp_ge_u32 s65, 7
    s_cselect_b32 s65, s83, s65
    s_mul_i32 s49, s65, 229376
    s_add_u32 s49, s49, s44
    s_lshl_b32 m0, s17, 11
    s_add_u32 m0, m0, 139264
    s_add_u32 s48, s49, 0
    buffer_load_dwordx4 v4, s[32:35], s48 offen lds
    s_lshl_b32 m0, s17, 11
    s_add_u32 m0, m0, 140288
    s_add_u32 s48, s49, 28672
    buffer_load_dwordx4 v4, s[32:35], s48 offen lds
    s_waitcnt lgkmcnt(0)
    s_waitcnt vmcnt(9)
    s_barrier
    ds_read_b128 v[144:147], v5 offset:16384
    ds_read_b128 v[148:151], v6 offset:16384
    ds_read_b128 v[152:155], v7 offset:16384
    ds_read_b128 v[156:159], v8 offset:16384
    s_add_u32 s65, s64, 4
    s_sub_u32 s83, s65, 7
    s_cmp_ge_u32 s65, 7
    s_cselect_b32 s65, s83, s65
    s_lshl_b32 s49, s65, 7
    s_add_u32 s49, s49, s47
    s_lshl_b32 m0, s17, 12
    s_add_u32 m0, m0, 65536
    s_add_u32 s48, s49, 0
    buffer_load_dwordx4 v2, s[28:31], s48 offen lds
    s_lshl_b32 m0, s17, 12
    s_add_u32 m0, m0, 66560
    s_add_u32 s48, s49, 7168
    buffer_load_dwordx4 v3, s[28:31], s48 offen lds
    s_lshl_b32 m0, s17, 12
    s_add_u32 m0, m0, 67584
    s_add_u32 s48, s49, 14336
    buffer_load_dwordx4 v2, s[28:31], s48 offen lds
    s_lshl_b32 m0, s17, 12
    s_add_u32 m0, m0, 68608
    s_add_u32 s48, s49, 21504
    buffer_load_dwordx4 v3, s[28:31], s48 offen lds
    s_add_u32 s65, s64, 4
    s_sub_u32 s83, s65, 7
    s_cmp_ge_u32 s65, 7
    s_cselect_b32 s65, s83, s65
    s_mul_i32 s49, s65, 229376
    s_add_u32 s49, s49, s44
    s_lshl_b32 m0, s17, 11
    s_add_u32 m0, m0, 147456
    s_add_u32 s48, s49, 0
    buffer_load_dwordx4 v4, s[32:35], s48 offen lds
    s_lshl_b32 m0, s17, 11
    s_add_u32 m0, m0, 148480
    s_add_u32 s48, s49, 28672
    buffer_load_dwordx4 v4, s[32:35], s48 offen lds
    s_waitcnt lgkmcnt(0)
    s_waitcnt vmcnt(12)
    s_barrier
    ds_read_b128 v[160:163], v5 offset:32768
    ds_read_b128 v[164:167], v6 offset:32768
    ds_read_b128 v[168:171], v7 offset:32768
    ds_read_b128 v[172:175], v8 offset:32768
    s_add_u32 s65, s64, 5
    s_sub_u32 s83, s65, 7
    s_cmp_ge_u32 s65, 7
    s_cselect_b32 s65, s83, s65
    s_lshl_b32 s49, s65, 7
    s_add_u32 s49, s49, s47
    s_lshl_b32 m0, s17, 12
    s_add_u32 m0, m0, 81920
    s_add_u32 s48, s49, 0
    buffer_load_dwordx4 v2, s[28:31], s48 offen lds
    s_lshl_b32 m0, s17, 12
    s_add_u32 m0, m0, 82944
    s_add_u32 s48, s49, 7168
    buffer_load_dwordx4 v3, s[28:31], s48 offen lds
    s_lshl_b32 m0, s17, 12
    s_add_u32 m0, m0, 83968
    s_add_u32 s48, s49, 14336
    buffer_load_dwordx4 v2, s[28:31], s48 offen lds
    s_lshl_b32 m0, s17, 12
    s_add_u32 m0, m0, 84992
    s_add_u32 s48, s49, 21504
    buffer_load_dwordx4 v3, s[28:31], s48 offen lds
    s_add_u32 s65, s64, 5
    s_sub_u32 s83, s65, 7
    s_cmp_ge_u32 s65, 7
    s_cselect_b32 s65, s83, s65
    s_mul_i32 s49, s65, 229376
    s_add_u32 s49, s49, s44
    s_lshl_b32 m0, s17, 11
    s_add_u32 m0, m0, 0
    s_add_u32 s48, s49, 0
    buffer_load_dwordx4 v4, s[32:35], s48 offen lds
    s_lshl_b32 m0, s17, 11
    s_add_u32 m0, m0, 1024
    s_add_u32 s48, s49, 28672
    buffer_load_dwordx4 v4, s[32:35], s48 offen lds
    s_waitcnt lgkmcnt(0)
    s_waitcnt vmcnt(12)
    s_barrier
    ds_read_b128 v[176:179], v5 offset:49152
    ds_read_b128 v[180:183], v6 offset:49152
    ds_read_b128 v[184:187], v7 offset:49152
    ds_read_b128 v[188:191], v8 offset:49152
    s_add_u32 s65, s64, 6
    s_sub_u32 s83, s65, 7
    s_cmp_ge_u32 s65, 7
    s_cselect_b32 s65, s83, s65
    s_lshl_b32 s49, s65, 7
    s_add_u32 s49, s49, s47
    s_lshl_b32 m0, s17, 12
    s_add_u32 m0, m0, 98304
    s_add_u32 s48, s49, 0
    buffer_load_dwordx4 v2, s[28:31], s48 offen lds
    s_lshl_b32 m0, s17, 12
    s_add_u32 m0, m0, 99328
    s_add_u32 s48, s49, 7168
    buffer_load_dwordx4 v3, s[28:31], s48 offen lds
    s_lshl_b32 m0, s17, 12
    s_add_u32 m0, m0, 100352
    s_add_u32 s48, s49, 14336
    buffer_load_dwordx4 v2, s[28:31], s48 offen lds
    s_lshl_b32 m0, s17, 12
    s_add_u32 m0, m0, 101376
    s_add_u32 s48, s49, 21504
    buffer_load_dwordx4 v3, s[28:31], s48 offen lds
    s_add_u32 s65, s64, 6
    s_sub_u32 s83, s65, 7
    s_cmp_ge_u32 s65, 7
    s_cselect_b32 s65, s83, s65
    s_mul_i32 s49, s65, 229376
    s_add_u32 s49, s49, s44
    s_lshl_b32 m0, s17, 11
    s_add_u32 m0, m0, 8192
    s_add_u32 s48, s49, 0
    buffer_load_dwordx4 v4, s[32:35], s48 offen lds
    s_lshl_b32 m0, s17, 11
    s_add_u32 m0, m0, 9216
    s_add_u32 s48, s49, 28672
    buffer_load_dwordx4 v4, s[32:35], s48 offen lds
    s_waitcnt lgkmcnt(0)
    s_waitcnt vmcnt(12)
    s_barrier
    v_add_u32 v5, 0x10000, v5
    v_add_u32 v6, 0x10000, v6
    v_add_u32 v7, 0x10000, v7
    v_add_u32 v8, 0x10000, v8
    ds_read_b128 v[192:195], v5 offset:0
    ds_read_b128 v[196:199], v6 offset:0
    ds_read_b128 v[200:203], v7 offset:0
    ds_read_b128 v[204:207], v8 offset:0
    s_add_u32 s65, s64, 0
    s_sub_u32 s83, s65, 7
    s_cmp_ge_u32 s65, 7
    s_cselect_b32 s65, s83, s65
    s_mul_i32 s49, s65, 229376
    s_add_u32 s49, s49, s45
    s_lshl_b32 m0, s17, 11
    s_add_u32 m0, m0, 16384
    s_add_u32 s48, s49, 0
    buffer_load_dwordx4 v4, s[32:35], s48 offen lds
    s_lshl_b32 m0, s17, 11
    s_add_u32 m0, m0, 17408
    s_add_u32 s48, s49, 28672
    buffer_load_dwordx4 v4, s[32:35], s48 offen lds
    s_add_u32 s65, s64, 1
    s_sub_u32 s83, s65, 7
    s_cmp_ge_u32 s65, 7
    s_cselect_b32 s65, s83, s65
    s_mul_i32 s49, s65, 229376
    s_add_u32 s49, s49, s45
    s_lshl_b32 m0, s17, 11
    s_add_u32 m0, m0, 24576
    s_add_u32 s48, s49, 0
    buffer_load_dwordx4 v4, s[32:35], s48 offen lds
    s_lshl_b32 m0, s17, 11
    s_add_u32 m0, m0, 25600
    s_add_u32 s48, s49, 28672
    buffer_load_dwordx4 v4, s[32:35], s48 offen lds
    s_add_u32 s65, s64, 2
    s_sub_u32 s83, s65, 7
    s_cmp_ge_u32 s65, 7
    s_cselect_b32 s65, s83, s65
    s_mul_i32 s49, s65, 229376
    s_add_u32 s49, s49, s45
    s_lshl_b32 m0, s17, 11
    s_add_u32 m0, m0, 32768
    s_add_u32 s48, s49, 0
    buffer_load_dwordx4 v4, s[32:35], s48 offen lds
    s_lshl_b32 m0, s17, 11
    s_add_u32 m0, m0, 33792
    s_add_u32 s48, s49, 28672
    buffer_load_dwordx4 v4, s[32:35], s48 offen lds
    s_waitcnt lgkmcnt(0)
    s_waitcnt vmcnt(12)
    s_barrier
    ds_read_b128 v[208:211], v5 offset:16384
    ds_read_b128 v[212:215], v6 offset:16384
    ds_read_b128 v[216:219], v7 offset:16384
    ds_read_b128 v[220:223], v8 offset:16384
    s_add_u32 s65, s64, 3
    s_sub_u32 s83, s65, 7
    s_cmp_ge_u32 s65, 7
    s_cselect_b32 s65, s83, s65
    s_mul_i32 s49, s65, 229376
    s_add_u32 s49, s49, s45
    s_lshl_b32 m0, s17, 11
    s_add_u32 m0, m0, 40960
    s_add_u32 s48, s49, 0
    buffer_load_dwordx4 v4, s[32:35], s48 offen lds
    s_lshl_b32 m0, s17, 11
    s_add_u32 m0, m0, 41984
    s_add_u32 s48, s49, 28672
    buffer_load_dwordx4 v4, s[32:35], s48 offen lds
    s_add_u32 s65, s64, 4
    s_sub_u32 s83, s65, 7
    s_cmp_ge_u32 s65, 7
    s_cselect_b32 s65, s83, s65
    s_mul_i32 s49, s65, 229376
    s_add_u32 s49, s49, s45
    s_lshl_b32 m0, s17, 11
    s_add_u32 m0, m0, 49152
    s_add_u32 s48, s49, 0
    buffer_load_dwordx4 v4, s[32:35], s48 offen lds
    s_lshl_b32 m0, s17, 11
    s_add_u32 m0, m0, 50176
    s_add_u32 s48, s49, 28672
    buffer_load_dwordx4 v4, s[32:35], s48 offen lds
    s_add_u32 s65, s64, 5
    s_sub_u32 s83, s65, 7
    s_cmp_ge_u32 s65, 7
    s_cselect_b32 s65, s83, s65
    s_mul_i32 s49, s65, 229376
    s_add_u32 s49, s49, s45
    s_lshl_b32 m0, s17, 11
    s_add_u32 m0, m0, 57344
    s_add_u32 s48, s49, 0
    buffer_load_dwordx4 v4, s[32:35], s48 offen lds
    s_lshl_b32 m0, s17, 11
    s_add_u32 m0, m0, 58368
    s_add_u32 s48, s49, 28672
    buffer_load_dwordx4 v4, s[32:35], s48 offen lds
    s_waitcnt lgkmcnt(0)
    s_waitcnt vmcnt(12)
    s_barrier
    ds_read_b128 v[224:227], v5 offset:32768
    ds_read_b128 v[228:231], v6 offset:32768
    ds_read_b128 v[232:235], v7 offset:32768
    ds_read_b128 v[236:239], v8 offset:32768
    s_add_u32 s65, s64, 6
    s_sub_u32 s83, s65, 7
    s_cmp_ge_u32 s65, 7
    s_cselect_b32 s65, s83, s65
    s_mul_i32 s49, s65, 229376
    s_add_u32 s49, s49, s45
    s_lshl_b32 m0, s17, 11
    s_add_u32 m0, m0, 65536
    s_add_u32 s48, s49, 0
    buffer_load_dwordx4 v4, s[32:35], s48 offen lds
    s_lshl_b32 m0, s17, 11
    s_add_u32 m0, m0, 66560
    s_add_u32 s48, s49, 28672
    buffer_load_dwordx4 v4, s[32:35], s48 offen lds
    s_waitcnt lgkmcnt(0)
    s_barrier
    v_add_u32 v18, 160768, v246
    ds_read_b64 v[16:17], v18
    s_waitcnt lgkmcnt(0)
    v_sub_f32 v20, 0, v16
    v_and_b32 v21, 0xffff0000, v20
    v_sub_f32 v22, v20, v21
    v_lshrrev_b32 v23, 16, v21
    v_or_b32 v42, v21, v23
    v_lshrrev_b32 v43, 16, v22
    v_mov_b32 v44, v42
    v_mov_b32 v45, v43
    ds_read_b64_tr_b16 v[48:49], v252 offset:0
    ds_read_b64_tr_b16 v[50:51], v252 offset:512
    ds_read_b64_tr_b16 v[52:53], v252 offset:2048
    ds_read_b64_tr_b16 v[54:55], v252 offset:2560
    ds_read_b64_tr_b16 v[56:57], v252 offset:4096
    ds_read_b64_tr_b16 v[58:59], v252 offset:4608
    ds_read_b64_tr_b16 v[60:61], v252 offset:6144
    ds_read_b64_tr_b16 v[62:63], v252 offset:6656
    ds_read_b64_tr_b16 v[64:65], v252 offset:8192
    ds_read_b64_tr_b16 v[66:67], v252 offset:8704
    ds_read_b64_tr_b16 v[26:27], v253 offset:0
    ds_read_b64_tr_b16 v[28:29], v253 offset:512
    v_mov_b32 v124, 0
    v_mov_b32 v125, 0
    v_mov_b32 v126, 0
    v_mov_b32 v127, 0
    s_waitcnt lgkmcnt(10)
    v_mfma_f32_32x32x16_bf16 v[96:111], v[48:51], v[128:131], 0
    ds_read_b64_tr_b16 v[68:69], v252 offset:10240
    ds_read_b64_tr_b16 v[70:71], v252 offset:10752
    s_waitcnt lgkmcnt(10)
    v_mfma_f32_32x32x16_bf16 v[96:111], v[52:55], v[132:135], v[96:111]
    ds_read_b64_tr_b16 v[72:73], v252 offset:12288
    ds_read_b64_tr_b16 v[74:75], v252 offset:12800
    s_waitcnt lgkmcnt(5)
    v_mfma_f32_4x4x4_16b_bf16 v[124:127], v[244:245], v[26:27], v[124:127]
    s_waitcnt lgkmcnt(4)
    s_nop 0
    v_mfma_f32_4x4x4_16b_bf16 v[124:127], v[244:245], v[28:29], v[124:127]
    ds_read_b64_tr_b16 v[30:31], v253 offset:8192
    ds_read_b64_tr_b16 v[32:33], v253 offset:8704
    v_mfma_f32_32x32x16_bf16 v[96:111], v[56:59], v[136:139], v[96:111]
    ds_read_b64_tr_b16 v[76:77], v252 offset:14336
    ds_read_b64_tr_b16 v[78:79], v252 offset:14848
    s_add_u32 s88, s17, 4
    s_mul_i32 s89, s88, 3072
    s_lshr_b32 s87, s88, 2
    s_add_u32 s87, s87, s64
    s_sub_u32 s83, s87, 7
    s_cmp_ge_u32 s87, 7
    s_cselect_b32 s87, s83, s87
    s_lshl_b32 s87, s87, 2
    s_and_b32 s88, s88, 3
    s_add_u32 s87, s87, s88
    s_mul_i32 s87, s87, 43008
    s_add_u32 s87, s87, s63
    s_add_u32 m0, s89, 73728
    s_nop 0
    buffer_load_dwordx4 v12, s[36:39], s87 offen lds
    v_mfma_f32_32x32x16_bf16 v[96:111], v[60:63], v[140:143], v[96:111]
    ds_read_b64_tr_b16 v[48:49], v252 offset:16384
    ds_read_b64_tr_b16 v[50:51], v252 offset:16896
    v_mfma_f32_32x32x16_bf16 v[96:111], v[64:67], v[144:147], v[96:111]
    ds_read_b64_tr_b16 v[52:53], v252 offset:18432
    ds_read_b64_tr_b16 v[54:55], v252 offset:18944
    s_waitcnt lgkmcnt(7)
    v_mfma_f32_4x4x4_16b_bf16 v[124:127], v[244:245], v[30:31], v[124:127]
    s_waitcnt lgkmcnt(6)
    s_nop 0
    v_mfma_f32_4x4x4_16b_bf16 v[124:127], v[244:245], v[32:33], v[124:127]
    ds_read_b64_tr_b16 v[26:27], v253 offset:16384
    ds_read_b64_tr_b16 v[28:29], v253 offset:16896
    v_mfma_f32_32x32x16_bf16 v[96:111], v[68:71], v[148:151], v[96:111]
    ds_read_b64_tr_b16 v[56:57], v252 offset:20480
    ds_read_b64_tr_b16 v[58:59], v252 offset:20992
    s_add_u32 m0, s89, 74752
    s_nop 0
    buffer_load_dwordx4 v13, s[36:39], s87 offen lds
    v_mfma_f32_32x32x16_bf16 v[96:111], v[72:75], v[152:155], v[96:111]
    ds_read_b64_tr_b16 v[60:61], v252 offset:22528
    ds_read_b64_tr_b16 v[62:63], v252 offset:23040
    s_waitcnt lgkmcnt(10)
    v_mfma_f32_32x32x16_bf16 v[96:111], v[76:79], v[156:159], v[96:111]
    ds_read_b64_tr_b16 v[64:65], v252 offset:24576
    ds_read_b64_tr_b16 v[66:67], v252 offset:25088
    s_waitcnt lgkmcnt(7)
    v_mfma_f32_4x4x4_16b_bf16 v[124:127], v[244:245], v[26:27], v[124:127]
    s_waitcnt lgkmcnt(6)
    s_nop 0
    v_mfma_f32_4x4x4_16b_bf16 v[124:127], v[244:245], v[28:29], v[124:127]
    ds_read_b64_tr_b16 v[30:31], v253 offset:24576
    ds_read_b64_tr_b16 v[32:33], v253 offset:25088
    v_mfma_f32_32x32x16_bf16 v[96:111], v[48:51], v[160:163], v[96:111]
    ds_read_b64_tr_b16 v[68:69], v252 offset:26624
    ds_read_b64_tr_b16 v[70:71], v252 offset:27136
    s_add_u32 m0, s89, 75776
    s_nop 0
    buffer_load_dwordx4 v14, s[36:39], s87 offen lds
    v_mfma_f32_32x32x16_bf16 v[96:111], v[52:55], v[164:167], v[96:111]
    ds_read_b64_tr_b16 v[72:73], v252 offset:28672
    ds_read_b64_tr_b16 v[74:75], v252 offset:29184
    s_waitcnt lgkmcnt(10)
    v_mfma_f32_32x32x16_bf16 v[96:111], v[56:59], v[168:171], v[96:111]
    ds_read_b64_tr_b16 v[76:77], v252 offset:30720
    ds_read_b64_tr_b16 v[78:79], v252 offset:31232
    s_waitcnt lgkmcnt(7)
    v_mfma_f32_4x4x4_16b_bf16 v[124:127], v[244:245], v[30:31], v[124:127]
    s_waitcnt lgkmcnt(6)
    s_nop 0
    v_mfma_f32_4x4x4_16b_bf16 v[124:127], v[244:245], v[32:33], v[124:127]
    ds_read_b64_tr_b16 v[26:27], v253 offset:32768
    ds_read_b64_tr_b16 v[28:29], v253 offset:33280
    v_mfma_f32_32x32x16_bf16 v[96:111], v[60:63], v[172:175], v[96:111]
    ds_read_b64_tr_b16 v[48:49], v252 offset:32768
    ds_read_b64_tr_b16 v[50:51], v252 offset:33280
    v_mfma_f32_32x32x16_bf16 v[96:111], v[64:67], v[176:179], v[96:111]
    ds_read_b64_tr_b16 v[52:53], v252 offset:34816
    ds_read_b64_tr_b16 v[54:55], v252 offset:35328
    s_waitcnt lgkmcnt(10)
    v_mfma_f32_32x32x16_bf16 v[96:111], v[68:71], v[180:183], v[96:111]
    ds_read_b64_tr_b16 v[56:57], v252 offset:36864
    ds_read_b64_tr_b16 v[58:59], v252 offset:37376
    s_waitcnt lgkmcnt(7)
    v_mfma_f32_4x4x4_16b_bf16 v[124:127], v[244:245], v[26:27], v[124:127]
    s_waitcnt lgkmcnt(6)
    s_nop 0
    v_mfma_f32_4x4x4_16b_bf16 v[124:127], v[244:245], v[28:29], v[124:127]
    ds_read_b64_tr_b16 v[30:31], v10 offset:0
    ds_read_b64_tr_b16 v[32:33], v10 offset:512
    v_mfma_f32_32x32x16_bf16 v[96:111], v[72:75], v[184:187], v[96:111]
    ds_read_b64_tr_b16 v[60:61], v252 offset:38912
    ds_read_b64_tr_b16 v[62:63], v252 offset:39424
    v_mfma_f32_32x32x16_bf16 v[96:111], v[76:79], v[188:191], v[96:111]
    ds_read_b64_tr_b16 v[64:65], v9 offset:0
    ds_read_b64_tr_b16 v[66:67], v9 offset:512
    s_waitcnt lgkmcnt(10)
    v_mfma_f32_32x32x16_bf16 v[96:111], v[48:51], v[192:195], v[96:111]
    ds_read_b64_tr_b16 v[68:69], v9 offset:2048
    ds_read_b64_tr_b16 v[70:71], v9 offset:2560
    s_waitcnt lgkmcnt(7)
    v_mfma_f32_4x4x4_16b_bf16 v[124:127], v[244:245], v[30:31], v[124:127]
    s_waitcnt lgkmcnt(6)
    s_nop 0
    v_mfma_f32_4x4x4_16b_bf16 v[124:127], v[244:245], v[32:33], v[124:127]
    ds_read_b64_tr_b16 v[26:27], v10 offset:8192
    ds_read_b64_tr_b16 v[28:29], v10 offset:8704
    v_mfma_f32_32x32x16_bf16 v[96:111], v[52:55], v[196:199], v[96:111]
    ds_read_b64_tr_b16 v[72:73], v9 offset:4096
    ds_read_b64_tr_b16 v[74:75], v9 offset:4608
    v_mfma_f32_32x32x16_bf16 v[96:111], v[56:59], v[200:203], v[96:111]
    ds_read_b64_tr_b16 v[76:77], v9 offset:6144
    ds_read_b64_tr_b16 v[78:79], v9 offset:6656
    s_waitcnt lgkmcnt(10)
    v_mfma_f32_32x32x16_bf16 v[96:111], v[60:63], v[204:207], v[96:111]
    ds_read_b64_tr_b16 v[48:49], v9 offset:8192
    ds_read_b64_tr_b16 v[50:51], v9 offset:8704
    s_waitcnt lgkmcnt(7)
    v_mfma_f32_4x4x4_16b_bf16 v[124:127], v[244:245], v[26:27], v[124:127]
    s_waitcnt lgkmcnt(6)
    s_nop 0
    v_mfma_f32_4x4x4_16b_bf16 v[124:127], v[244:245], v[28:29], v[124:127]
    v_mfma_f32_32x32x16_bf16 v[96:111], v[64:67], v[208:211], v[96:111]
    ds_read_b64_tr_b16 v[52:53], v9 offset:10240
    ds_read_b64_tr_b16 v[54:55], v9 offset:10752
    v_mfma_f32_32x32x16_bf16 v[96:111], v[68:71], v[212:215], v[96:111]
    ds_read_b64_tr_b16 v[56:57], v9 offset:12288
    ds_read_b64_tr_b16 v[58:59], v9 offset:12800
    s_waitcnt lgkmcnt(8)
    v_mfma_f32_32x32x16_bf16 v[96:111], v[72:75], v[216:219], v[96:111]
    ds_read_b64_tr_b16 v[60:61], v9 offset:14336
    ds_read_b64_tr_b16 v[62:63], v9 offset:14848
    s_waitcnt lgkmcnt(8)
    v_mfma_f32_32x32x16_bf16 v[96:111], v[76:79], v[220:223], v[96:111]
    v_mov_b32 v46, v124
    v_mov_b32 v33, v124
    s_nop 1
    v_permlane32_swap_b32 v46, v33
    v_add_f32 v46, v46, v33
    ds_write_b32 v249, v46
    s_waitcnt lgkmcnt(7)
    v_mfma_f32_32x32x16_bf16 v[96:111], v[48:51], v[224:227], v[96:111]
    s_waitcnt lgkmcnt(5)
    v_mfma_f32_32x32x16_bf16 v[96:111], v[52:55], v[228:231], v[96:111]
    s_waitcnt lgkmcnt(3)
    v_mfma_f32_32x32x16_bf16 v[96:111], v[56:59], v[232:235], v[96:111]
    s_waitcnt lgkmcnt(1)
    v_mfma_f32_32x32x16_bf16 v[96:111], v[60:63], v[236:239], v[96:111]
    s_waitcnt vmcnt(3) lgkmcnt(0)
    s_barrier
    s_sub_u32 s57, s20, 2
    s_cmp_ge_u32 s57, 12
    s_cbranch_scc1 KB_NOSECOND
    ds_read_b32 v26, v247
    ds_read_b32 v27, v247 offset:128
    s_waitcnt lgkmcnt(1)
    v_and_b32 v32, 0xffff0000, v26
    v_sub_f32 v33, v26, v32
    v_lshrrev_b32 v29, 16, v32
    v_and_or_b32 v28, v33, s60, v29
    s_waitcnt lgkmcnt(0)
    v_and_b32 v32, 0xffff0000, v27
    v_sub_f32 v33, v27, v32
    v_lshrrev_b32 v31, 16, v32
    v_and_or_b32 v30, v33, s60, v31
    s_nop 1
    v_mfma_f32_32x32x16_bf16 v[96:111], v[28:31], v[42:45], v[96:111]
    s_nop 11
    v_mul_f32 v96, v96, v17
    v_mul_f32 v97, v97, v17
    v_mul_f32 v98, v98, v17
    s_add_u32 s88, s17, 16
    s_mul_i32 s89, s88, 3072
    s_lshr_b32 s87, s88, 2
    s_add_u32 s87, s87, s64
    s_sub_u32 s83, s87, 7
    s_cmp_ge_u32 s87, 7
    s_cselect_b32 s87, s83, s87
    s_lshl_b32 s87, s87, 2
    s_and_b32 s88, s88, 3
    s_add_u32 s87, s87, s88
    s_mul_i32 s87, s87, 43008
    s_add_u32 s87, s87, s63
    s_add_u32 m0, s89, 73728
    s_nop 0
    buffer_load_dwordx4 v12, s[36:39], s87 offen lds
    v_mul_f32 v99, v99, v17
    v_mul_f32 v100, v100, v17
    v_mul_f32 v101, v101, v17
    v_mul_f32 v102, v102, v17
    v_mul_f32 v103, v103, v17
    v_mul_f32 v104, v104, v17
    v_mul_f32 v105, v105, v17
    v_mul_f32 v106, v106, v17
    v_mul_f32 v107, v107, v17
    v_mul_f32 v108, v108, v17
    v_mul_f32 v109, v109, v17
    v_mul_f32 v110, v110, v17
    v_mul_f32 v111, v111, v17
    v_mul_f32 v18, v96, v96
    v_mul_f32 v19, v97, v97
    v_mul_f32 v20, v98, v98
    v_mul_f32 v21, v99, v99
    v_mul_f32 v22, v100, v100
    v_mul_f32 v23, v101, v101
    v_mul_f32 v24, v102, v102
    v_mul_f32 v25, v103, v103
    v_fma_f32 v18, v18, s56, v47
    s_add_u32 m0, s89, 74752
    s_nop 0
    buffer_load_dwordx4 v13, s[36:39], s87 offen lds
    v_fma_f32 v19, v19, s56, v47
    v_fma_f32 v20, v20, s56, v47
    v_fma_f32 v21, v21, s56, v47
    v_fma_f32 v22, v22, s56, v47
    v_fma_f32 v23, v23, s56, v47
    v_fma_f32 v24, v24, s56, v47
    v_fma_f32 v25, v25, s56, v47
    v_mul_f32 v18, v18, v96
    v_mul_f32 v19, v19, v97
    v_mul_f32 v20, v20, v98
    v_mul_f32 v21, v21, v99
    v_mul_f32 v22, v22, v100
    v_mul_f32 v23, v23, v101
    v_mul_f32 v24, v24, v102
    v_mul_f32 v25, v25, v103
    v_exp_f32 v18, v18
    v_exp_f32 v19, v19
    v_exp_f32 v20, v20
    v_exp_f32 v21, v21
    v_exp_f32 v22, v22
    v_exp_f32 v23, v23
    v_exp_f32 v24, v24
    v_exp_f32 v25, v25
    s_add_u32 m0, s89, 75776
    s_nop 0
    buffer_load_dwordx4 v14, s[36:39], s87 offen lds
    v_add_f32 v18, 1.0, v18
    v_add_f32 v19, 1.0, v19
    v_add_f32 v20, 1.0, v20
    v_add_f32 v21, 1.0, v21
    v_add_f32 v22, 1.0, v22
    v_add_f32 v23, 1.0, v23
    v_add_f32 v24, 1.0, v24
    v_add_f32 v25, 1.0, v25
    v_rcp_f32 v18, v18
    v_rcp_f32 v19, v19
    v_rcp_f32 v20, v20
    v_rcp_f32 v21, v21
    v_rcp_f32 v22, v22
    v_rcp_f32 v23, v23
    v_rcp_f32 v24, v24
    v_rcp_f32 v25, v25
    v_mul_f32 v80, v96, v18
    v_mul_f32 v81, v97, v19
    v_mul_f32 v82, v98, v20
    v_mul_f32 v83, v99, v21
    v_mul_f32 v84, v100, v22
    v_mul_f32 v85, v101, v23
    v_mul_f32 v86, v102, v24
    s_add_u32 s88, s17, 20
    s_mul_i32 s89, s88, 3072
    s_lshr_b32 s87, s88, 2
    s_add_u32 s87, s87, s64
    s_sub_u32 s83, s87, 7
    s_cmp_ge_u32 s87, 7
    s_cselect_b32 s87, s83, s87
    s_lshl_b32 s87, s87, 2
    s_and_b32 s88, s88, 3
    s_add_u32 s87, s87, s88
    s_mul_i32 s87, s87, 43008
    s_add_u32 s87, s87, s63
    s_add_u32 m0, s89, 73728
    s_nop 0
    buffer_load_dwordx4 v12, s[36:39], s87 offen lds
    v_mul_f32 v87, v103, v25
    v_mul_f32 v18, v104, v104
    v_mul_f32 v19, v105, v105
    v_mul_f32 v20, v106, v106
    v_mul_f32 v21, v107, v107
    v_mul_f32 v22, v108, v108
    v_mul_f32 v23, v109, v109
    v_mul_f32 v24, v110, v110
    v_mul_f32 v25, v111, v111
    v_fma_f32 v18, v18, s56, v47
    v_fma_f32 v19, v19, s56, v47
    v_fma_f32 v20, v20, s56, v47
    v_fma_f32 v21, v21, s56, v47
    v_fma_f32 v22, v22, s56, v47
    v_fma_f32 v23, v23, s56, v47
    v_fma_f32 v24, v24, s56, v47
    v_fma_f32 v25, v25, s56, v47
    v_mul_f32 v18, v18, v104
    v_mul_f32 v19, v19, v105
    v_mul_f32 v20, v20, v106
    v_mul_f32 v21, v21, v107
    v_mul_f32 v22, v22, v108
    s_add_u32 m0, s89, 74752
    s_nop 0
    buffer_load_dwordx4 v13, s[36:39], s87 offen lds
    v_mul_f32 v23, v23, v109
    v_mul_f32 v24, v24, v110
    v_mul_f32 v25, v25, v111
    v_exp_f32 v18, v18
    v_exp_f32 v19, v19
    v_exp_f32 v20, v20
    v_exp_f32 v21, v21
    v_exp_f32 v22, v22
    v_exp_f32 v23, v23
    v_exp_f32 v24, v24
    v_exp_f32 v25, v25
    v_add_f32 v18, 1.0, v18
    v_add_f32 v19, 1.0, v19
    v_add_f32 v20, 1.0, v20
    v_add_f32 v21, 1.0, v21
    v_add_f32 v22, 1.0, v22
    v_add_f32 v23, 1.0, v23
    v_add_f32 v24, 1.0, v24
    v_add_f32 v25, 1.0, v25
    v_rcp_f32 v18, v18
    v_rcp_f32 v19, v19
    v_rcp_f32 v20, v20
    v_rcp_f32 v21, v21
    s_add_u32 m0, s89, 75776
    s_nop 0
    buffer_load_dwordx4 v14, s[36:39], s87 offen lds
    v_rcp_f32 v22, v22
    v_rcp_f32 v23, v23
    v_rcp_f32 v24, v24
    v_rcp_f32 v25, v25
    v_mul_f32 v88, v104, v18
    v_mul_f32 v89, v105, v19
    v_mul_f32 v90, v106, v20
    v_mul_f32 v91, v107, v21
    v_mul_f32 v92, v108, v22
    v_mul_f32 v93, v109, v23
    v_mul_f32 v94, v110, v24
    v_mul_f32 v95, v111, v25
    v_mov_b32 v34, v80
    v_mul_f32 v35, v80, v80
    v_add_f32 v34, v34, v81
    v_fmac_f32 v35, v81, v81
    v_add_f32 v34, v34, v82
    v_fmac_f32 v35, v82, v82
    v_add_f32 v34, v34, v83
    v_fmac_f32 v35, v83, v83
    v_add_f32 v34, v34, v84
    v_fmac_f32 v35, v84, v84
    v_add_f32 v34, v34, v85
    v_fmac_f32 v35, v85, v85
    v_add_f32 v34, v34, v86
    v_fmac_f32 v35, v86, v86
    v_add_f32 v34, v34, v87
    v_fmac_f32 v35, v87, v87
    v_add_f32 v34, v34, v88
    v_fmac_f32 v35, v88, v88
    v_add_f32 v34, v34, v89
    v_fmac_f32 v35, v89, v89
    v_add_f32 v34, v34, v90
    v_fmac_f32 v35, v90, v90
    v_add_f32 v34, v34, v91
    v_fmac_f32 v35, v91, v91
    v_add_f32 v34, v34, v92
    v_fmac_f32 v35, v92, v92
    v_add_f32 v34, v34, v93
    v_fmac_f32 v35, v93, v93
    v_add_f32 v34, v34, v94
    v_fmac_f32 v35, v94, v94
    v_add_f32 v34, v34, v95
    v_fmac_f32 v35, v95, v95
    v_mov_b32 v36, v34
    v_mov_b32 v37, v35
    s_nop 0
    v_permlane32_swap_b32 v36, v34
    v_permlane32_swap_b32 v37, v35
    v_add_f32 v34, v34, v36
    v_add_f32 v35, v35, v37
    v_add_u32 v18, 162816, v246
    ds_read_b64 v[36:37], v18
    s_waitcnt lgkmcnt(0)
    v_add_f32 v36, v36, v34
    v_add_f32 v38, v37, v35
    v_mov_b32 v37, s21
    v_mov_b32 v39, s21
    s_mul_i32 s51, s22, 7168
    s_lshl_b32 s52, s20, 9
    s_add_u32 s51, s51, s52
    s_add_u32 s51, s51, 23068672
    s_mov_b32 exec_hi, 0
    buffer_store_dwordx4 v[36:39], v1, s[24:27], s51 offen sc1
    s_mov_b64 exec, -1
    v_add_u32 v250, 16384, v9
    v_add_u32 v251, 16384, v10
    ds_read_b64_tr_b16 v[48:49], v250 offset:0
    ds_read_b64_tr_b16 v[50:51], v250 offset:512
    ds_read_b64_tr_b16 v[52:53], v250 offset:2048
    ds_read_b64_tr_b16 v[54:55], v250 offset:2560
    ds_read_b64_tr_b16 v[56:57], v250 offset:4096
    ds_read_b64_tr_b16 v[58:59], v250 offset:4608
    ds_read_b64_tr_b16 v[60:61], v250 offset:6144
    ds_read_b64_tr_b16 v[62:63], v250 offset:6656
    ds_read_b64_tr_b16 v[64:65], v250 offset:8192
    ds_read_b64_tr_b16 v[66:67], v250 offset:8704
    ds_read_b64_tr_b16 v[26:27], v251 offset:0
    ds_read_b64_tr_b16 v[28:29], v251 offset:512
    s_barrier
    v_mov_b32 v124, 0
    v_mov_b32 v125, 0
    v_mov_b32 v126, 0
    v_mov_b32 v127, 0
    s_waitcnt lgkmcnt(10)
    v_mfma_f32_32x32x16_bf16 v[96:111], v[48:51], v[128:131], 0
    ds_read_b64_tr_b16 v[68:69], v250 offset:10240
    ds_read_b64_tr_b16 v[70:71], v250 offset:10752
    s_waitcnt lgkmcnt(10)
    v_mfma_f32_32x32x16_bf16 v[96:111], v[52:55], v[132:135], v[96:111]
    ds_read_b64_tr_b16 v[72:73], v250 offset:12288
    ds_read_b64_tr_b16 v[74:75], v250 offset:12800
    s_waitcnt lgkmcnt(5)
    v_mfma_f32_4x4x4_16b_bf16 v[124:127], v[244:245], v[26:27], v[124:127]
    s_waitcnt lgkmcnt(4)
    s_nop 0
    v_mfma_f32_4x4x4_16b_bf16 v[124:127], v[244:245], v[28:29], v[124:127]
    ds_read_b64_tr_b16 v[30:31], v251 offset:8192
    ds_read_b64_tr_b16 v[32:33], v251 offset:8704
    v_mfma_f32_32x32x16_bf16 v[96:111], v[56:59], v[136:139], v[96:111]
    ds_read_b64_tr_b16 v[76:77], v250 offset:14336
    ds_read_b64_tr_b16 v[78:79], v250 offset:14848
    v_mfma_f32_32x32x16_bf16 v[96:111], v[60:63], v[140:143], v[96:111]
    ds_read_b64_tr_b16 v[48:49], v250 offset:16384
    ds_read_b64_tr_b16 v[50:51], v250 offset:16896
    v_mfma_f32_32x32x16_bf16 v[96:111], v[64:67], v[144:147], v[96:111]
    ds_read_b64_tr_b16 v[52:53], v250 offset:18432
    ds_read_b64_tr_b16 v[54:55], v250 offset:18944
    s_waitcnt lgkmcnt(7)
    v_mfma_f32_4x4x4_16b_bf16 v[124:127], v[244:245], v[30:31], v[124:127]
    s_waitcnt lgkmcnt(6)
    s_nop 0
    v_mfma_f32_4x4x4_16b_bf16 v[124:127], v[244:245], v[32:33], v[124:127]
    ds_read_b64_tr_b16 v[26:27], v251 offset:16384
    ds_read_b64_tr_b16 v[28:29], v251 offset:16896
    v_mfma_f32_32x32x16_bf16 v[96:111], v[68:71], v[148:151], v[96:111]
    ds_read_b64_tr_b16 v[56:57], v250 offset:20480
    ds_read_b64_tr_b16 v[58:59], v250 offset:20992
    v_mfma_f32_32x32x16_bf16 v[96:111], v[72:75], v[152:155], v[96:111]
    ds_read_b64_tr_b16 v[60:61], v250 offset:22528
    ds_read_b64_tr_b16 v[62:63], v250 offset:23040
    s_waitcnt lgkmcnt(10)
    v_mfma_f32_32x32x16_bf16 v[96:111], v[76:79], v[156:159], v[96:111]
    ds_read_b64_tr_b16 v[64:65], v250 offset:24576
    ds_read_b64_tr_b16 v[66:67], v250 offset:25088
    s_waitcnt lgkmcnt(7)
    v_mfma_f32_4x4x4_16b_bf16 v[124:127], v[244:245], v[26:27], v[124:127]
    s_waitcnt lgkmcnt(6)
    s_nop 0
    v_mfma_f32_4x4x4_16b_bf16 v[124:127], v[244:245], v[28:29], v[124:127]
    ds_read_b64_tr_b16 v[30:31], v251 offset:24576
    ds_read_b64_tr_b16 v[32:33], v251 offset:25088
    v_mfma_f32_32x32x16_bf16 v[96:111], v[48:51], v[160:163], v[96:111]
    ds_read_b64_tr_b16 v[68:69], v250 offset:26624
    ds_read_b64_tr_b16 v[70:71], v250 offset:27136
    v_mfma_f32_32x32x16_bf16 v[96:111], v[52:55], v[164:167], v[96:111]
    ds_read_b64_tr_b16 v[72:73], v250 offset:28672
    ds_read_b64_tr_b16 v[74:75], v250 offset:29184
    s_waitcnt lgkmcnt(10)
    v_mfma_f32_32x32x16_bf16 v[96:111], v[56:59], v[168:171], v[96:111]
    ds_read_b64_tr_b16 v[76:77], v250 offset:30720
    ds_read_b64_tr_b16 v[78:79], v250 offset:31232
    s_waitcnt lgkmcnt(7)
    v_mfma_f32_4x4x4_16b_bf16 v[124:127], v[244:245], v[30:31], v[124:127]
    s_waitcnt lgkmcnt(6)
    s_nop 0
    v_mfma_f32_4x4x4_16b_bf16 v[124:127], v[244:245], v[32:33], v[124:127]
    ds_read_b64_tr_b16 v[26:27], v251 offset:32768
    ds_read_b64_tr_b16 v[28:29], v251 offset:33280
    v_mfma_f32_32x32x16_bf16 v[96:111], v[60:63], v[172:175], v[96:111]
    ds_read_b64_tr_b16 v[48:49], v250 offset:32768
    ds_read_b64_tr_b16 v[50:51], v250 offset:33280
    v_mfma_f32_32x32x16_bf16 v[96:111], v[64:67], v[176:179], v[96:111]
    ds_read_b64_tr_b16 v[52:53], v250 offset:34816
    ds_read_b64_tr_b16 v[54:55], v250 offset:35328
    s_waitcnt lgkmcnt(10)
    v_mfma_f32_32x32x16_bf16 v[96:111], v[68:71], v[180:183], v[96:111]
    ds_read_b64_tr_b16 v[56:57], v250 offset:36864
    ds_read_b64_tr_b16 v[58:59], v250 offset:37376
    s_waitcnt lgkmcnt(7)
    v_mfma_f32_4x4x4_16b_bf16 v[124:127], v[244:245], v[26:27], v[124:127]
    s_waitcnt lgkmcnt(6)
    s_nop 0
    v_mfma_f32_4x4x4_16b_bf16 v[124:127], v[244:245], v[28:29], v[124:127]
    ds_read_b64_tr_b16 v[30:31], v251 offset:40960
    ds_read_b64_tr_b16 v[32:33], v251 offset:41472
    v_mfma_f32_32x32x16_bf16 v[96:111], v[72:75], v[184:187], v[96:111]
    ds_read_b64_tr_b16 v[60:61], v250 offset:38912
    ds_read_b64_tr_b16 v[62:63], v250 offset:39424
    v_mfma_f32_32x32x16_bf16 v[96:111], v[76:79], v[188:191], v[96:111]
    ds_read_b64_tr_b16 v[64:65], v250 offset:40960
    ds_read_b64_tr_b16 v[66:67], v250 offset:41472
    s_waitcnt lgkmcnt(10)
    v_mfma_f32_32x32x16_bf16 v[96:111], v[48:51], v[192:195], v[96:111]
    ds_read_b64_tr_b16 v[68:69], v250 offset:43008
    ds_read_b64_tr_b16 v[70:71], v250 offset:43520
    s_waitcnt lgkmcnt(7)
    v_mfma_f32_4x4x4_16b_bf16 v[124:127], v[244:245], v[30:31], v[124:127]
    s_waitcnt lgkmcnt(6)
    s_nop 0
    v_mfma_f32_4x4x4_16b_bf16 v[124:127], v[244:245], v[32:33], v[124:127]
    ds_read_b64_tr_b16 v[26:27], v251 offset:49152
    ds_read_b64_tr_b16 v[28:29], v251 offset:49664
    v_mfma_f32_32x32x16_bf16 v[96:111], v[52:55], v[196:199], v[96:111]
    ds_read_b64_tr_b16 v[72:73], v250 offset:45056
    ds_read_b64_tr_b16 v[74:75], v250 offset:45568
    v_mfma_f32_32x32x16_bf16 v[96:111], v[56:59], v[200:203], v[96:111]
    ds_read_b64_tr_b16 v[76:77], v250 offset:47104
    ds_read_b64_tr_b16 v[78:79], v250 offset:47616
    s_waitcnt lgkmcnt(10)
    v_mfma_f32_32x32x16_bf16 v[96:111], v[60:63], v[204:207], v[96:111]
    ds_read_b64_tr_b16 v[48:49], v250 offset:49152
    ds_read_b64_tr_b16 v[50:51], v250 offset:49664
    s_waitcnt lgkmcnt(7)
    v_mfma_f32_4x4x4_16b_bf16 v[124:127], v[244:245], v[26:27], v[124:127]
    s_waitcnt lgkmcnt(6)
    s_nop 0
    v_mfma_f32_4x4x4_16b_bf16 v[124:127], v[244:245], v[28:29], v[124:127]
    v_mfma_f32_32x32x16_bf16 v[96:111], v[64:67], v[208:211], v[96:111]
    ds_read_b64_tr_b16 v[52:53], v250 offset:51200
    ds_read_b64_tr_b16 v[54:55], v250 offset:51712
    v_mfma_f32_32x32x16_bf16 v[96:111], v[68:71], v[212:215], v[96:111]
    ds_read_b64_tr_b16 v[56:57], v250 offset:53248
    ds_read_b64_tr_b16 v[58:59], v250 offset:53760
    s_waitcnt lgkmcnt(8)
    v_mfma_f32_32x32x16_bf16 v[96:111], v[72:75], v[216:219], v[96:111]
    ds_read_b64_tr_b16 v[60:61], v250 offset:55296
    ds_read_b64_tr_b16 v[62:63], v250 offset:55808
    s_waitcnt lgkmcnt(8)
    v_mfma_f32_32x32x16_bf16 v[96:111], v[76:79], v[220:223], v[96:111]
    v_mov_b32 v46, v124
    v_mov_b32 v33, v124
    s_nop 1
    v_permlane32_swap_b32 v46, v33
    v_add_f32 v46, v46, v33
    ds_write_b32 v249, v46
    s_waitcnt lgkmcnt(7)
    v_mfma_f32_32x32x16_bf16 v[96:111], v[48:51], v[224:227], v[96:111]
    s_waitcnt lgkmcnt(5)
    v_mfma_f32_32x32x16_bf16 v[96:111], v[52:55], v[228:231], v[96:111]
    s_waitcnt lgkmcnt(3)
    v_mfma_f32_32x32x16_bf16 v[96:111], v[56:59], v[232:235], v[96:111]
    s_waitcnt lgkmcnt(1)
    v_mfma_f32_32x32x16_bf16 v[96:111], v[60:63], v[236:239], v[96:111]
    s_waitcnt vmcnt(1) lgkmcnt(0)
    s_barrier
    ds_read_b32 v26, v247
    ds_read_b32 v27, v247 offset:128
    s_waitcnt lgkmcnt(1)
    v_and_b32 v32, 0xffff0000, v26
    v_sub_f32 v33, v26, v32
    v_lshrrev_b32 v29, 16, v32
    v_and_or_b32 v28, v33, s60, v29
    s_waitcnt lgkmcnt(0)
    v_and_b32 v32, 0xffff0000, v27
    v_sub_f32 v33, v27, v32
    v_lshrrev_b32 v31, 16, v32
    v_and_or_b32 v30, v33, s60, v31
    s_nop 1
    v_mfma_f32_32x32x16_bf16 v[96:111], v[28:31], v[42:45], v[96:111]
    s_nop 11
    v_mul_f32 v96, v96, v17
    v_mul_f32 v97, v97, v17
    v_mul_f32 v98, v98, v17
    v_mul_f32 v99, v99, v17
    v_mul_f32 v100, v100, v17
    v_mul_f32 v101, v101, v17
    v_mul_f32 v102, v102, v17
    v_mul_f32 v103, v103, v17
    v_mul_f32 v104, v104, v17
    v_mul_f32 v105, v105, v17
    v_mul_f32 v106, v106, v17
    v_mul_f32 v107, v107, v17
    v_mul_f32 v108, v108, v17
    v_mul_f32 v109, v109, v17
    v_mul_f32 v110, v110, v17
    v_mul_f32 v111, v111, v17
    v_mul_f32 v18, v96, v96
    v_mul_f32 v19, v97, v97
    v_mul_f32 v20, v98, v98
    v_mul_f32 v21, v99, v99
    v_mul_f32 v22, v100, v100
    v_mul_f32 v23, v101, v101
    v_mul_f32 v24, v102, v102
    v_mul_f32 v25, v103, v103
    v_fma_f32 v18, v18, s56, v47
    v_fma_f32 v19, v19, s56, v47
    v_fma_f32 v20, v20, s56, v47
    v_fma_f32 v21, v21, s56, v47
    v_fma_f32 v22, v22, s56, v47
    v_fma_f32 v23, v23, s56, v47
    v_fma_f32 v24, v24, s56, v47
    v_fma_f32 v25, v25, s56, v47
    v_mul_f32 v18, v18, v96
    v_mul_f32 v19, v19, v97
    v_mul_f32 v20, v20, v98
    v_mul_f32 v21, v21, v99
    v_mul_f32 v22, v22, v100
    v_mul_f32 v23, v23, v101
    v_mul_f32 v24, v24, v102
    v_mul_f32 v25, v25, v103
    v_exp_f32 v18, v18
    v_exp_f32 v19, v19
    v_exp_f32 v20, v20
    v_exp_f32 v21, v21
    v_exp_f32 v22, v22
    v_exp_f32 v23, v23
    v_exp_f32 v24, v24
    v_exp_f32 v25, v25
    v_add_f32 v18, 1.0, v18
    v_add_f32 v19, 1.0, v19
    v_add_f32 v20, 1.0, v20
    v_add_f32 v21, 1.0, v21
    v_add_f32 v22, 1.0, v22
    v_add_f32 v23, 1.0, v23
    v_add_f32 v24, 1.0, v24
    v_add_f32 v25, 1.0, v25
    v_rcp_f32 v18, v18
    v_rcp_f32 v19, v19
    v_rcp_f32 v20, v20
    v_rcp_f32 v21, v21
    v_rcp_f32 v22, v22
    v_rcp_f32 v23, v23
    v_rcp_f32 v24, v24
    v_rcp_f32 v25, v25
    v_mul_f32 v96, v96, v18
    v_mul_f32 v97, v97, v19
    v_mul_f32 v98, v98, v20
    v_mul_f32 v99, v99, v21
    v_mul_f32 v100, v100, v22
    v_mul_f32 v101, v101, v23
    v_mul_f32 v102, v102, v24
    v_mul_f32 v103, v103, v25
    v_mul_f32 v18, v104, v104
    v_mul_f32 v19, v105, v105
    v_mul_f32 v20, v106, v106
    v_mul_f32 v21, v107, v107
    v_mul_f32 v22, v108, v108
    v_mul_f32 v23, v109, v109
    v_mul_f32 v24, v110, v110
    v_mul_f32 v25, v111, v111
    v_fma_f32 v18, v18, s56, v47
    v_fma_f32 v19, v19, s56, v47
    v_fma_f32 v20, v20, s56, v47
    v_fma_f32 v21, v21, s56, v47
    v_fma_f32 v22, v22, s56, v47
    v_fma_f32 v23, v23, s56, v47
    v_fma_f32 v24, v24, s56, v47
    v_fma_f32 v25, v25, s56, v47
    v_mul_f32 v18, v18, v104
    v_mul_f32 v19, v19, v105
    v_mul_f32 v20, v20, v106
    v_mul_f32 v21, v21, v107
    v_mul_f32 v22, v22, v108
    v_mul_f32 v23, v23, v109
    v_mul_f32 v24, v24, v110
    v_mul_f32 v25, v25, v111
    v_exp_f32 v18, v18
    v_exp_f32 v19, v19
    v_exp_f32 v20, v20
    v_exp_f32 v21, v21
    v_exp_f32 v22, v22
    v_exp_f32 v23, v23
    v_exp_f32 v24, v24
    v_exp_f32 v25, v25
    v_add_f32 v18, 1.0, v18
    v_add_f32 v19, 1.0, v19
    v_add_f32 v20, 1.0, v20
    v_add_f32 v21, 1.0, v21
    v_add_f32 v22, 1.0, v22
    v_add_f32 v23, 1.0, v23
    v_add_f32 v24, 1.0, v24
    v_add_f32 v25, 1.0, v25
    v_rcp_f32 v18, v18
    v_rcp_f32 v19, v19
    v_rcp_f32 v20, v20
    v_rcp_f32 v21, v21
    v_rcp_f32 v22, v22
    v_rcp_f32 v23, v23
    v_rcp_f32 v24, v24
    v_rcp_f32 v25, v25
    v_mul_f32 v104, v104, v18
    v_mul_f32 v105, v105, v19
    v_mul_f32 v106, v106, v20
    v_mul_f32 v107, v107, v21
    v_mul_f32 v108, v108, v22
    v_mul_f32 v109, v109, v23
    v_mul_f32 v110, v110, v24
    v_mul_f32 v111, v111, v25
    v_cvt_pk_bf16_f32 v34, v96, v97
    v_cvt_pk_bf16_f32 v35, v98, v99
    v_cvt_pk_bf16_f32 v36, v100, v101
    v_cvt_pk_bf16_f32 v37, v102, v103
    v_cvt_pk_bf16_f32 v38, v104, v105
    v_cvt_pk_bf16_f32 v39, v106, v107
    v_cvt_pk_bf16_f32 v40, v108, v109
    v_cvt_pk_bf16_f32 v41, v110, v111
    s_mul_i32 s51, s22, 57344
    s_lshl_b32 s52, s57, 12
    s_add_u32 s51, s51, s52
    s_add_u32 s51, s51, 6293504
    buffer_store_dwordx4 v[34:37], v1, s[24:27], s51 offen offset:0 sc1
    buffer_store_dwordx4 v[38:41], v1, s[24:27], s51 offen offset:1024 sc1
    v_add_u32 v250, 56, v15
    s_mul_i32 s51, s17, 3072
    v_add_u32 v251, s51, v250
    v_add_u32 v252, 43008, v250
    v_add_u32 v253, 43008, v251
    ds_read_b64_tr_b16 v[48:49], v250 offset:0
    ds_read_b64_tr_b16 v[50:51], v250 offset:768
    ds_read_b64_tr_b16 v[52:53], v250 offset:3072
    ds_read_b64_tr_b16 v[54:55], v250 offset:3840
    ds_read_b64_tr_b16 v[56:57], v250 offset:6144
    ds_read_b64_tr_b16 v[58:59], v250 offset:6912
    ds_read_b64_tr_b16 v[60:61], v250 offset:9216
    ds_read_b64_tr_b16 v[62:63], v250 offset:9984
    ds_read_b64_tr_b16 v[64:65], v250 offset:12288
    ds_read_b64_tr_b16 v[66:67], v250 offset:13056
    ds_read_b64_tr_b16 v[26:27], v251 offset:0
    ds_read_b64_tr_b16 v[28:29], v251 offset:768
    s_barrier
    s_branch KB_JOIN
KB_NOSECOND:
    s_add_u32 s88, s17, 16
    s_mul_i32 s89, s88, 3072
    s_lshr_b32 s87, s88, 2
    s_add_u32 s87, s87, s64
    s_sub_u32 s83, s87, 7
    s_cmp_ge_u32 s87, 7
    s_cselect_b32 s87, s83, s87
    s_lshl_b32 s87, s87, 2
    s_and_b32 s88, s88, 3
    s_add_u32 s87, s87, s88
    s_mul_i32 s87, s87, 43008
    s_add_u32 s87, s87, s63
    s_add_u32 m0, s89, 73728
    s_nop 0
    buffer_load_dwordx4 v12, s[36:39], s87 offen lds
    s_add_u32 m0, s89, 74752
    s_nop 0
    buffer_load_dwordx4 v13, s[36:39], s87 offen lds
    s_add_u32 m0, s89, 75776
    s_nop 0
    buffer_load_dwordx4 v14, s[36:39], s87 offen lds
    s_add_u32 s88, s17, 20
    s_mul_i32 s89, s88, 3072
    s_lshr_b32 s87, s88, 2
    s_add_u32 s87, s87, s64
    s_sub_u32 s83, s87, 7
    s_cmp_ge_u32 s87, 7
    s_cselect_b32 s87, s83, s87
    s_lshl_b32 s87, s87, 2
    s_and_b32 s88, s88, 3
    s_add_u32 s87, s87, s88
    s_mul_i32 s87, s87, 43008
    s_add_u32 s87, s87, s63
    s_add_u32 m0, s89, 73728
    s_nop 0
    buffer_load_dwordx4 v12, s[36:39], s87 offen lds
    s_add_u32 m0, s89, 74752
    s_nop 0
    buffer_load_dwordx4 v13, s[36:39], s87 offen lds
    s_add_u32 m0, s89, 75776
    s_nop 0
    buffer_load_dwordx4 v14, s[36:39], s87 offen lds
    s_waitcnt vmcnt(0)
    s_barrier
    s_cmp_ge_u32 s20, 14
    s_cbranch_scc1 KBF_Z1
    ds_read_b32 v26, v247
    ds_read_b32 v27, v247 offset:128
    s_waitcnt lgkmcnt(1)
    v_and_b32 v32, 0xffff0000, v26
    v_sub_f32 v33, v26, v32
    v_lshrrev_b32 v29, 16, v32
    v_and_or_b32 v28, v33, s60, v29
    s_waitcnt lgkmcnt(0)
    v_and_b32 v32, 0xffff0000, v27
    v_sub_f32 v33, v27, v32
    v_lshrrev_b32 v31, 16, v32
    v_and_or_b32 v30, v33, s60, v31
    s_nop 1
    v_mfma_f32_32x32x16_bf16 v[96:111], v[28:31], v[42:45], v[96:111]
    s_nop 11
    v_mul_f32 v96, v96, v17
    v_mul_f32 v97, v97, v17
    v_mul_f32 v98, v98, v17
    v_mul_f32 v99, v99, v17
    v_mul_f32 v100, v100, v17
    v_mul_f32 v101, v101, v17
    v_mul_f32 v102, v102, v17
    v_mul_f32 v103, v103, v17
    v_mul_f32 v104, v104, v17
    v_mul_f32 v105, v105, v17
    v_mul_f32 v106, v106, v17
    v_mul_f32 v107, v107, v17
    v_mul_f32 v108, v108, v17
    v_mul_f32 v109, v109, v17
    v_mul_f32 v110, v110, v17
    v_mul_f32 v111, v111, v17
    v_mul_f32 v18, v96, v96
    v_mul_f32 v19, v97, v97
    v_mul_f32 v20, v98, v98
    v_mul_f32 v21, v99, v99
    v_mul_f32 v22, v100, v100
    v_mul_f32 v23, v101, v101
    v_mul_f32 v24, v102, v102
    v_mul_f32 v25, v103, v103
    v_fma_f32 v18, v18, s56, v47
    v_fma_f32 v19, v19, s56, v47
    v_fma_f32 v20, v20, s56, v47
    v_fma_f32 v21, v21, s56, v47
    v_fma_f32 v22, v22, s56, v47
    v_fma_f32 v23, v23, s56, v47
    v_fma_f32 v24, v24, s56, v47
    v_fma_f32 v25, v25, s56, v47
    v_mul_f32 v18, v18, v96
    v_mul_f32 v19, v19, v97
    v_mul_f32 v20, v20, v98
    v_mul_f32 v21, v21, v99
    v_mul_f32 v22, v22, v100
    v_mul_f32 v23, v23, v101
    v_mul_f32 v24, v24, v102
    v_mul_f32 v25, v25, v103
    v_exp_f32 v18, v18
    v_exp_f32 v19, v19
    v_exp_f32 v20, v20
    v_exp_f32 v21, v21
    v_exp_f32 v22, v22
    v_exp_f32 v23, v23
    v_exp_f32 v24, v24
    v_exp_f32 v25, v25
    v_add_f32 v18, 1.0, v18
    v_add_f32 v19, 1.0, v19
    v_add_f32 v20, 1.0, v20
    v_add_f32 v21, 1.0, v21
    v_add_f32 v22, 1.0, v22
    v_add_f32 v23, 1.0, v23
    v_add_f32 v24, 1.0, v24
    v_add_f32 v25, 1.0, v25
    v_rcp_f32 v18, v18
    v_rcp_f32 v19, v19
    v_rcp_f32 v20, v20
    v_rcp_f32 v21, v21
    v_rcp_f32 v22, v22
    v_rcp_f32 v23, v23
    v_rcp_f32 v24, v24
    v_rcp_f32 v25, v25
    v_mul_f32 v80, v96, v18
    v_mul_f32 v81, v97, v19
    v_mul_f32 v82, v98, v20
    v_mul_f32 v83, v99, v21
    v_mul_f32 v84, v100, v22
    v_mul_f32 v85, v101, v23
    v_mul_f32 v86, v102, v24
    v_mul_f32 v87, v103, v25
    v_mul_f32 v18, v104, v104
    v_mul_f32 v19, v105, v105
    v_mul_f32 v20, v106, v106
    v_mul_f32 v21, v107, v107
    v_mul_f32 v22, v108, v108
    v_mul_f32 v23, v109, v109
    v_mul_f32 v24, v110, v110
    v_mul_f32 v25, v111, v111
    v_fma_f32 v18, v18, s56, v47
    v_fma_f32 v19, v19, s56, v47
    v_fma_f32 v20, v20, s56, v47
    v_fma_f32 v21, v21, s56, v47
    v_fma_f32 v22, v22, s56, v47
    v_fma_f32 v23, v23, s56, v47
    v_fma_f32 v24, v24, s56, v47
    v_fma_f32 v25, v25, s56, v47
    v_mul_f32 v18, v18, v104
    v_mul_f32 v19, v19, v105
    v_mul_f32 v20, v20, v106
    v_mul_f32 v21, v21, v107
    v_mul_f32 v22, v22, v108
    v_mul_f32 v23, v23, v109
    v_mul_f32 v24, v24, v110
    v_mul_f32 v25, v25, v111
    v_exp_f32 v18, v18
    v_exp_f32 v19, v19
    v_exp_f32 v20, v20
    v_exp_f32 v21, v21
    v_exp_f32 v22, v22
    v_exp_f32 v23, v23
    v_exp_f32 v24, v24
    v_exp_f32 v25, v25
    v_add_f32 v18, 1.0, v18
    v_add_f32 v19, 1.0, v19
    v_add_f32 v20, 1.0, v20
    v_add_f32 v21, 1.0, v21
    v_add_f32 v22, 1.0, v22
    v_add_f32 v23, 1.0, v23
    v_add_f32 v24, 1.0, v24
    v_add_f32 v25, 1.0, v25
    v_rcp_f32 v18, v18
    v_rcp_f32 v19, v19
    v_rcp_f32 v20, v20
    v_rcp_f32 v21, v21
    v_rcp_f32 v22, v22
    v_rcp_f32 v23, v23
    v_rcp_f32 v24, v24
    v_rcp_f32 v25, v25
    v_mul_f32 v88, v104, v18
    v_mul_f32 v89, v105, v19
    v_mul_f32 v90, v106, v20
    v_mul_f32 v91, v107, v21
    v_mul_f32 v92, v108, v22
    v_mul_f32 v93, v109, v23
    v_mul_f32 v94, v110, v24
    v_mul_f32 v95, v111, v25
    v_mov_b32 v34, v80
    v_mul_f32 v35, v80, v80
    v_add_f32 v34, v34, v81
    v_fmac_f32 v35, v81, v81
    v_add_f32 v34, v34, v82
    v_fmac_f32 v35, v82, v82
    v_add_f32 v34, v34, v83
    v_fmac_f32 v35, v83, v83
    v_add_f32 v34, v34, v84
    v_fmac_f32 v35, v84, v84
    v_add_f32 v34, v34, v85
    v_fmac_f32 v35, v85, v85
    v_add_f32 v34, v34, v86
    v_fmac_f32 v35, v86, v86
    v_add_f32 v34, v34, v87
    v_fmac_f32 v35, v87, v87
    v_add_f32 v34, v34, v88
    v_fmac_f32 v35, v88, v88
    v_add_f32 v34, v34, v89
    v_fmac_f32 v35, v89, v89
    v_add_f32 v34, v34, v90
    v_fmac_f32 v35, v90, v90
    v_add_f32 v34, v34, v91
    v_fmac_f32 v35, v91, v91
    v_add_f32 v34, v34, v92
    v_fmac_f32 v35, v92, v92
    v_add_f32 v34, v34, v93
    v_fmac_f32 v35, v93, v93
    v_add_f32 v34, v34, v94
    v_fmac_f32 v35, v94, v94
    v_add_f32 v34, v34, v95
    v_fmac_f32 v35, v95, v95
    v_mov_b32 v36, v34
    v_mov_b32 v37, v35
    s_nop 0
    v_permlane32_swap_b32 v36, v34
    v_permlane32_swap_b32 v37, v35
    v_add_f32 v34, v34, v36
    v_add_f32 v35, v35, v37
    v_add_u32 v18, 162816, v246
    ds_read_b64 v[36:37], v18
    s_waitcnt lgkmcnt(0)
    v_add_f32 v36, v36, v34
    v_add_f32 v38, v37, v35
    v_mov_b32 v37, s21
    v_mov_b32 v39, s21
    s_mul_i32 s51, s22, 7168
    s_lshl_b32 s52, s20, 9
    s_add_u32 s51, s51, s52
    s_add_u32 s51, s51, 23068672
    s_mov_b32 exec_hi, 0
    buffer_store_dwordx4 v[36:39], v1, s[24:27], s51 offen sc1
    s_mov_b64 exec, -1
    s_branch KBF_D
KBF_Z1:
    s_sub_u32 s57, s20, 2
    ds_read_b32 v26, v247
    ds_read_b32 v27, v247 offset:128
    s_waitcnt lgkmcnt(1)
    v_and_b32 v32, 0xffff0000, v26
    v_sub_f32 v33, v26, v32
    v_lshrrev_b32 v29, 16, v32
    v_and_or_b32 v28, v33, s60, v29
    s_waitcnt lgkmcnt(0)
    v_and_b32 v32, 0xffff0000, v27
    v_sub_f32 v33, v27, v32
    v_lshrrev_b32 v31, 16, v32
    v_and_or_b32 v30, v33, s60, v31
    s_nop 1
    v_mfma_f32_32x32x16_bf16 v[96:111], v[28:31], v[42:45], v[96:111]
    s_nop 11
    v_mul_f32 v96, v96, v17
    v_mul_f32 v97, v97, v17
    v_mul_f32 v98, v98, v17
    v_mul_f32 v99, v99, v17
    v_mul_f32 v100, v100, v17
    v_mul_f32 v101, v101, v17
    v_mul_f32 v102, v102, v17
    v_mul_f32 v103, v103, v17
    v_mul_f32 v104, v104, v17
    v_mul_f32 v105, v105, v17
    v_mul_f32 v106, v106, v17
    v_mul_f32 v107, v107, v17
    v_mul_f32 v108, v108, v17
    v_mul_f32 v109, v109, v17
    v_mul_f32 v110, v110, v17
    v_mul_f32 v111, v111, v17
    v_mul_f32 v18, v96, v96
    v_mul_f32 v19, v97, v97
    v_mul_f32 v20, v98, v98
    v_mul_f32 v21, v99, v99
    v_mul_f32 v22, v100, v100
    v_mul_f32 v23, v101, v101
    v_mul_f32 v24, v102, v102
    v_mul_f32 v25, v103, v103
    v_fma_f32 v18, v18, s56, v47
    v_fma_f32 v19, v19, s56, v47
    v_fma_f32 v20, v20, s56, v47
    v_fma_f32 v21, v21, s56, v47
    v_fma_f32 v22, v22, s56, v47
    v_fma_f32 v23, v23, s56, v47
    v_fma_f32 v24, v24, s56, v47
    v_fma_f32 v25, v25, s56, v47
    v_mul_f32 v18, v18, v96
    v_mul_f32 v19, v19, v97
    v_mul_f32 v20, v20, v98
    v_mul_f32 v21, v21, v99
    v_mul_f32 v22, v22, v100
    v_mul_f32 v23, v23, v101
    v_mul_f32 v24, v24, v102
    v_mul_f32 v25, v25, v103
    v_exp_f32 v18, v18
    v_exp_f32 v19, v19
    v_exp_f32 v20, v20
    v_exp_f32 v21, v21
    v_exp_f32 v22, v22
    v_exp_f32 v23, v23
    v_exp_f32 v24, v24
    v_exp_f32 v25, v25
    v_add_f32 v18, 1.0, v18
    v_add_f32 v19, 1.0, v19
    v_add_f32 v20, 1.0, v20
    v_add_f32 v21, 1.0, v21
    v_add_f32 v22, 1.0, v22
    v_add_f32 v23, 1.0, v23
    v_add_f32 v24, 1.0, v24
    v_add_f32 v25, 1.0, v25
    v_rcp_f32 v18, v18
    v_rcp_f32 v19, v19
    v_rcp_f32 v20, v20
    v_rcp_f32 v21, v21
    v_rcp_f32 v22, v22
    v_rcp_f32 v23, v23
    v_rcp_f32 v24, v24
    v_rcp_f32 v25, v25
    v_mul_f32 v96, v96, v18
    v_mul_f32 v97, v97, v19
    v_mul_f32 v98, v98, v20
    v_mul_f32 v99, v99, v21
    v_mul_f32 v100, v100, v22
    v_mul_f32 v101, v101, v23
    v_mul_f32 v102, v102, v24
    v_mul_f32 v103, v103, v25
    v_mul_f32 v18, v104, v104
    v_mul_f32 v19, v105, v105
    v_mul_f32 v20, v106, v106
    v_mul_f32 v21, v107, v107
    v_mul_f32 v22, v108, v108
    v_mul_f32 v23, v109, v109
    v_mul_f32 v24, v110, v110
    v_mul_f32 v25, v111, v111
    v_fma_f32 v18, v18, s56, v47
    v_fma_f32 v19, v19, s56, v47
    v_fma_f32 v20, v20, s56, v47
    v_fma_f32 v21, v21, s56, v47
    v_fma_f32 v22, v22, s56, v47
    v_fma_f32 v23, v23, s56, v47
    v_fma_f32 v24, v24, s56, v47
    v_fma_f32 v25, v25, s56, v47
    v_mul_f32 v18, v18, v104
    v_mul_f32 v19, v19, v105
    v_mul_f32 v20, v20, v106
    v_mul_f32 v21, v21, v107
    v_mul_f32 v22, v22, v108
    v_mul_f32 v23, v23, v109
    v_mul_f32 v24, v24, v110
    v_mul_f32 v25, v25, v111
    v_exp_f32 v18, v18
    v_exp_f32 v19, v19
    v_exp_f32 v20, v20
    v_exp_f32 v21, v21
    v_exp_f32 v22, v22
    v_exp_f32 v23, v23
    v_exp_f32 v24, v24
    v_exp_f32 v25, v25
    v_add_f32 v18, 1.0, v18
    v_add_f32 v19, 1.0, v19
    v_add_f32 v20, 1.0, v20
    v_add_f32 v21, 1.0, v21
    v_add_f32 v22, 1.0, v22
    v_add_f32 v23, 1.0, v23
    v_add_f32 v24, 1.0, v24
    v_add_f32 v25, 1.0, v25
    v_rcp_f32 v18, v18
    v_rcp_f32 v19, v19
    v_rcp_f32 v20, v20
    v_rcp_f32 v21, v21
    v_rcp_f32 v22, v22
    v_rcp_f32 v23, v23
    v_rcp_f32 v24, v24
    v_rcp_f32 v25, v25
    v_mul_f32 v104, v104, v18
    v_mul_f32 v105, v105, v19
    v_mul_f32 v106, v106, v20
    v_mul_f32 v107, v107, v21
    v_mul_f32 v108, v108, v22
    v_mul_f32 v109, v109, v23
    v_mul_f32 v110, v110, v24
    v_mul_f32 v111, v111, v25
    v_cvt_pk_bf16_f32 v34, v96, v97
    v_cvt_pk_bf16_f32 v35, v98, v99
    v_cvt_pk_bf16_f32 v36, v100, v101
    v_cvt_pk_bf16_f32 v37, v102, v103
    v_cvt_pk_bf16_f32 v38, v104, v105
    v_cvt_pk_bf16_f32 v39, v106, v107
    v_cvt_pk_bf16_f32 v40, v108, v109
    v_cvt_pk_bf16_f32 v41, v110, v111
    s_mul_i32 s51, s22, 57344
    s_lshl_b32 s52, s57, 12
    s_add_u32 s51, s51, s52
    s_add_u32 s51, s51, 6293504
    buffer_store_dwordx4 v[34:37], v1, s[24:27], s51 offen offset:0 sc1
    buffer_store_dwordx4 v[38:41], v1, s[24:27], s51 offen offset:1024 sc1
KBF_D:
    s_load_dwordx2 s[66:67], s[0:1], 16
    s_load_dwordx2 s[68:69], s[0:1], 56
    s_sub_u32 s51, s20, 12
    s_cmp_lt_u32 s20, 2
    s_cselect_b32 s51, s20, s51
    s_lshl_b32 s52, s19, 2
    s_add_u32 s51, s51, s52
    s_lshl_b32 s51, s51, 2
    s_add_u32 s70, s51, s17
    s_mul_i32 s71, s17, 5120
    s_add_u32 s71, s71, 20480
    s_mov_b32 s81, 401408
    s_mov_b32 s82, 802816
    v_lshrrev_b32 v26, 2, v0
    v_mul_u32_u24 v27, 896, v26
    v_and_b32 v28, 3, v0
    v_lshl_add_u32 v27, v28, 4, v27
    v_cmp_le_u32 vcc, 12, v26
    v_mov_b32 v28, 0
    v_mov_b32 v29, 0x7ff00000
    v_cndmask_b32 v28, v28, v29, vcc
    s_waitcnt lgkmcnt(0)
    s_add_u32 s80, s70, 0
    s_mul_i32 s51, s80, 745
    s_lshr_b32 s51, s51, 16
    s_mul_i32 s52, s51, 88
    s_sub_u32 s52, s80, s52
    s_lshl_b32 s51, s51, 6
    s_lshr_b32 s53, s52, 1
    s_mul_i32 s53, s53, 28
    s_and_b32 s54, s52, 1
    s_lshl_b32 s55, s54, 4
    s_add_u32 s53, s53, s55
    s_sub_u32 s55, s52, 32
    s_lshl_b32 s55, s55, 4
    s_cmp_lt_u32 s52, 32
    s_cselect_b32 s53, s53, s55
    s_cselect_b32 s72, s66, s68
    s_cselect_b32 s73, s67, s69
    s_cselect_b32 s74, s81, s82
    s_mov_b32 s75, 0x00020000
    s_cselect_b32 s54, s54, 0
    s_mul_i32 s53, s53, 896
    s_add_u32 s53, s53, s51
    s_cmp_lt_u32 s80, 1232
    s_cselect_b32 s53, s53, 0x7ff00000
    s_sub_u32 s54, 0, s54
    v_and_b32 v29, s54, v28
    v_add_u32 v29, v29, v27
    s_add_u32 m0, s71, 0
    s_nop 0
    buffer_load_dwordx4 v29, s[72:75], s53 offen lds
    s_add_u32 s80, s70, 256
    s_mul_i32 s51, s80, 745
    s_lshr_b32 s51, s51, 16
    s_mul_i32 s52, s51, 88
    s_sub_u32 s52, s80, s52
    s_lshl_b32 s51, s51, 6
    s_lshr_b32 s53, s52, 1
    s_mul_i32 s53, s53, 28
    s_and_b32 s54, s52, 1
    s_lshl_b32 s55, s54, 4
    s_add_u32 s53, s53, s55
    s_sub_u32 s55, s52, 32
    s_lshl_b32 s55, s55, 4
    s_cmp_lt_u32 s52, 32
    s_cselect_b32 s53, s53, s55
    s_cselect_b32 s72, s66, s68
    s_cselect_b32 s73, s67, s69
    s_cselect_b32 s74, s81, s82
    s_mov_b32 s75, 0x00020000
    s_cselect_b32 s54, s54, 0
    s_mul_i32 s53, s53, 896
    s_add_u32 s53, s53, s51
    s_cmp_lt_u32 s80, 1232
    s_cselect_b32 s53, s53, 0x7ff00000
    s_sub_u32 s54, 0, s54
    v_and_b32 v29, s54, v28
    v_add_u32 v29, v29, v27
    s_add_u32 m0, s71, 1024
    s_nop 0
    buffer_load_dwordx4 v29, s[72:75], s53 offen lds
    s_add_u32 s80, s70, 512
    s_mul_i32 s51, s80, 745
    s_lshr_b32 s51, s51, 16
    s_mul_i32 s52, s51, 88
    s_sub_u32 s52, s80, s52
    s_lshl_b32 s51, s51, 6
    s_lshr_b32 s53, s52, 1
    s_mul_i32 s53, s53, 28
    s_and_b32 s54, s52, 1
    s_lshl_b32 s55, s54, 4
    s_add_u32 s53, s53, s55
    s_sub_u32 s55, s52, 32
    s_lshl_b32 s55, s55, 4
    s_cmp_lt_u32 s52, 32
    s_cselect_b32 s53, s53, s55
    s_cselect_b32 s72, s66, s68
    s_cselect_b32 s73, s67, s69
    s_cselect_b32 s74, s81, s82
    s_mov_b32 s75, 0x00020000
    s_cselect_b32 s54, s54, 0
    s_mul_i32 s53, s53, 896
    s_add_u32 s53, s53, s51
    s_cmp_lt_u32 s80, 1232
    s_cselect_b32 s53, s53, 0x7ff00000
    s_sub_u32 s54, 0, s54
    v_and_b32 v29, s54, v28
    v_add_u32 v29, v29, v27
    s_add_u32 m0, s71, 2048
    s_nop 0
    buffer_load_dwordx4 v29, s[72:75], s53 offen lds
    s_add_u32 s80, s70, 768
    s_mul_i32 s51, s80, 745
    s_lshr_b32 s51, s51, 16
    s_mul_i32 s52, s51, 88
    s_sub_u32 s52, s80, s52
    s_lshl_b32 s51, s51, 6
    s_lshr_b32 s53, s52, 1
    s_mul_i32 s53, s53, 28
    s_and_b32 s54, s52, 1
    s_lshl_b32 s55, s54, 4
    s_add_u32 s53, s53, s55
    s_sub_u32 s55, s52, 32
    s_lshl_b32 s55, s55, 4
    s_cmp_lt_u32 s52, 32
    s_cselect_b32 s53, s53, s55
    s_cselect_b32 s72, s66, s68
    s_cselect_b32 s73, s67, s69
    s_cselect_b32 s74, s81, s82
    s_mov_b32 s75, 0x00020000
    s_cselect_b32 s54, s54, 0
    s_mul_i32 s53, s53, 896
    s_add_u32 s53, s53, s51
    s_cmp_lt_u32 s80, 1232
    s_cselect_b32 s53, s53, 0x7ff00000
    s_sub_u32 s54, 0, s54
    v_and_b32 v29, s54, v28
    v_add_u32 v29, v29, v27
    s_add_u32 m0, s71, 3072
    s_nop 0
    buffer_load_dwordx4 v29, s[72:75], s53 offen lds
    s_add_u32 s80, s70, 1024
    s_mul_i32 s51, s80, 745
    s_lshr_b32 s51, s51, 16
    s_mul_i32 s52, s51, 88
    s_sub_u32 s52, s80, s52
    s_lshl_b32 s51, s51, 6
    s_lshr_b32 s53, s52, 1
    s_mul_i32 s53, s53, 28
    s_and_b32 s54, s52, 1
    s_lshl_b32 s55, s54, 4
    s_add_u32 s53, s53, s55
    s_sub_u32 s55, s52, 32
    s_lshl_b32 s55, s55, 4
    s_cmp_lt_u32 s52, 32
    s_cselect_b32 s53, s53, s55
    s_cselect_b32 s72, s66, s68
    s_cselect_b32 s73, s67, s69
    s_cselect_b32 s74, s81, s82
    s_mov_b32 s75, 0x00020000
    s_cselect_b32 s54, s54, 0
    s_mul_i32 s53, s53, 896
    s_add_u32 s53, s53, s51
    s_cmp_lt_u32 s80, 1232
    s_cselect_b32 s53, s53, 0x7ff00000
    s_sub_u32 s54, 0, s54
    v_and_b32 v29, s54, v28
    v_add_u32 v29, v29, v27
    s_add_u32 m0, s71, 4096
    s_nop 0
    buffer_load_dwordx4 v29, s[72:75], s53 offen lds
    v_add_u32 v250, 56, v15
    s_mul_i32 s51, s17, 3072
    v_add_u32 v251, s51, v250
    v_add_u32 v252, 43008, v250
    v_add_u32 v253, 43008, v251
    ds_read_b64_tr_b16 v[48:49], v250 offset:0
    ds_read_b64_tr_b16 v[50:51], v250 offset:768
    ds_read_b64_tr_b16 v[52:53], v250 offset:3072
    ds_read_b64_tr_b16 v[54:55], v250 offset:3840
    ds_read_b64_tr_b16 v[56:57], v250 offset:6144
    ds_read_b64_tr_b16 v[58:59], v250 offset:6912
    ds_read_b64_tr_b16 v[60:61], v250 offset:9216
    ds_read_b64_tr_b16 v[62:63], v250 offset:9984
    ds_read_b64_tr_b16 v[64:65], v250 offset:12288
    ds_read_b64_tr_b16 v[66:67], v250 offset:13056
    ds_read_b64_tr_b16 v[26:27], v251 offset:0
    ds_read_b64_tr_b16 v[28:29], v251 offset:768
    s_barrier
KB_JOIN:
    v_mov_b32 v124, 0
    v_mov_b32 v125, 0
    v_mov_b32 v126, 0
    v_mov_b32 v127, 0
    s_waitcnt lgkmcnt(10)
    v_mfma_f32_32x32x16_bf16 v[96:111], v[48:51], v[128:131], 0
    ds_read_b64_tr_b16 v[68:69], v250 offset:15360
    ds_read_b64_tr_b16 v[70:71], v250 offset:16128
    s_waitcnt lgkmcnt(10)
    v_mfma_f32_32x32x16_bf16 v[96:111], v[52:55], v[132:135], v[96:111]
    ds_read_b64_tr_b16 v[72:73], v250 offset:18432
    ds_read_b64_tr_b16 v[74:75], v250 offset:19200
    s_waitcnt lgkmcnt(5)
    v_mfma_f32_4x4x4_16b_bf16 v[124:127], v[244:245], v[26:27], v[124:127]
    s_waitcnt lgkmcnt(4)
    s_nop 0
    v_mfma_f32_4x4x4_16b_bf16 v[124:127], v[244:245], v[28:29], v[124:127]
    ds_read_b64_tr_b16 v[30:31], v251 offset:12288
    ds_read_b64_tr_b16 v[32:33], v251 offset:13056
    v_mfma_f32_32x32x16_bf16 v[96:111], v[56:59], v[136:139], v[96:111]
    ds_read_b64_tr_b16 v[76:77], v250 offset:21504
    ds_read_b64_tr_b16 v[78:79], v250 offset:22272
    s_mul_i32 s90, s22, 7168
    s_add_u32 s90, s90, 23068672
    s_add_u32 s91, s90, 0
    buffer_load_dwordx4 v[112:115], v1, s[24:27], s91 offen sc1
    v_mfma_f32_32x32x16_bf16 v[96:111], v[60:63], v[140:143], v[96:111]
    ds_read_b64_tr_b16 v[48:49], v250 offset:24576
    ds_read_b64_tr_b16 v[50:51], v250 offset:25344
    v_mfma_f32_32x32x16_bf16 v[96:111], v[64:67], v[144:147], v[96:111]
    ds_read_b64_tr_b16 v[52:53], v250 offset:27648
    ds_read_b64_tr_b16 v[54:55], v250 offset:28416
    s_waitcnt lgkmcnt(7)
    v_mfma_f32_4x4x4_16b_bf16 v[124:127], v[244:245], v[30:31], v[124:127]
    s_waitcnt lgkmcnt(6)
    s_nop 0
    v_mfma_f32_4x4x4_16b_bf16 v[124:127], v[244:245], v[32:33], v[124:127]
    ds_read_b64_tr_b16 v[26:27], v251 offset:24576
    ds_read_b64_tr_b16 v[28:29], v251 offset:25344
    v_mfma_f32_32x32x16_bf16 v[96:111], v[68:71], v[148:151], v[96:111]
    ds_read_b64_tr_b16 v[56:57], v250 offset:30720
    ds_read_b64_tr_b16 v[58:59], v250 offset:31488
    s_add_u32 s91, s90, 1024
    buffer_load_dwordx4 v[116:119], v1, s[24:27], s91 offen sc1
    v_mfma_f32_32x32x16_bf16 v[96:111], v[72:75], v[152:155], v[96:111]
    ds_read_b64_tr_b16 v[60:61], v250 offset:33792
    ds_read_b64_tr_b16 v[62:63], v250 offset:34560
    s_waitcnt lgkmcnt(10)
    v_mfma_f32_32x32x16_bf16 v[96:111], v[76:79], v[156:159], v[96:111]
    ds_read_b64_tr_b16 v[64:65], v250 offset:36864
    ds_read_b64_tr_b16 v[66:67], v250 offset:37632
    s_waitcnt lgkmcnt(7)
    v_mfma_f32_4x4x4_16b_bf16 v[124:127], v[244:245], v[26:27], v[124:127]
    s_waitcnt lgkmcnt(6)
    s_nop 0
    v_mfma_f32_4x4x4_16b_bf16 v[124:127], v[244:245], v[28:29], v[124:127]
    ds_read_b64_tr_b16 v[30:31], v251 offset:36864
    ds_read_b64_tr_b16 v[32:33], v251 offset:37632
    v_mfma_f32_32x32x16_bf16 v[96:111], v[48:51], v[160:163], v[96:111]
    ds_read_b64_tr_b16 v[68:69], v250 offset:39936
    ds_read_b64_tr_b16 v[70:71], v250 offset:40704
    s_add_u32 s91, s90, 2048
    buffer_load_dwordx4 v[120:123], v1, s[24:27], s91 offen sc1
    v_mfma_f32_32x32x16_bf16 v[96:111], v[52:55], v[164:167], v[96:111]
    ds_read_b64_tr_b16 v[72:73], v252 offset:0
    ds_read_b64_tr_b16 v[74:75], v252 offset:768
    s_waitcnt lgkmcnt(10)
    v_mfma_f32_32x32x16_bf16 v[96:111], v[56:59], v[168:171], v[96:111]
    ds_read_b64_tr_b16 v[76:77], v252 offset:3072
    ds_read_b64_tr_b16 v[78:79], v252 offset:3840
    s_waitcnt lgkmcnt(7)
    v_mfma_f32_4x4x4_16b_bf16 v[124:127], v[244:245], v[30:31], v[124:127]
    s_waitcnt lgkmcnt(6)
    s_nop 0
    v_mfma_f32_4x4x4_16b_bf16 v[124:127], v[244:245], v[32:33], v[124:127]
    ds_read_b64_tr_b16 v[26:27], v253 offset:6144
    ds_read_b64_tr_b16 v[28:29], v253 offset:6912
    v_mfma_f32_32x32x16_bf16 v[96:111], v[60:63], v[172:175], v[96:111]
    ds_read_b64_tr_b16 v[48:49], v252 offset:6144
    ds_read_b64_tr_b16 v[50:51], v252 offset:6912
    s_add_u32 s91, s90, 3072
    buffer_load_dwordx4 v[18:21], v1, s[24:27], s91 offen sc1
    v_mfma_f32_32x32x16_bf16 v[96:111], v[64:67], v[176:179], v[96:111]
    ds_read_b64_tr_b16 v[52:53], v252 offset:9216
    ds_read_b64_tr_b16 v[54:55], v252 offset:9984
    s_waitcnt lgkmcnt(10)
    v_mfma_f32_32x32x16_bf16 v[96:111], v[68:71], v[180:183], v[96:111]
    ds_read_b64_tr_b16 v[56:57], v252 offset:12288
    ds_read_b64_tr_b16 v[58:59], v252 offset:13056
    s_waitcnt lgkmcnt(7)
    v_mfma_f32_4x4x4_16b_bf16 v[124:127], v[244:245], v[26:27], v[124:127]
    s_waitcnt lgkmcnt(6)
    s_nop 0
    v_mfma_f32_4x4x4_16b_bf16 v[124:127], v[244:245], v[28:29], v[124:127]
    ds_read_b64_tr_b16 v[30:31], v253 offset:18432
    ds_read_b64_tr_b16 v[32:33], v253 offset:19200
    v_mfma_f32_32x32x16_bf16 v[96:111], v[72:75], v[184:187], v[96:111]
    ds_read_b64_tr_b16 v[60:61], v252 offset:15360
    ds_read_b64_tr_b16 v[62:63], v252 offset:16128
    s_add_u32 s91, s90, 4096
    buffer_load_dwordx4 v[22:25], v1, s[24:27], s91 offen sc1
    v_mfma_f32_32x32x16_bf16 v[96:111], v[76:79], v[188:191], v[96:111]
    ds_read_b64_tr_b16 v[64:65], v252 offset:18432
    ds_read_b64_tr_b16 v[66:67], v252 offset:19200
    s_waitcnt lgkmcnt(10)
    v_mfma_f32_32x32x16_bf16 v[96:111], v[48:51], v[192:195], v[96:111]
    ds_read_b64_tr_b16 v[68:69], v252 offset:21504
    ds_read_b64_tr_b16 v[70:71], v252 offset:22272
    s_waitcnt lgkmcnt(7)
    v_mfma_f32_4x4x4_16b_bf16 v[124:127], v[244:245], v[30:31], v[124:127]
    s_waitcnt lgkmcnt(6)
    s_nop 0
    v_mfma_f32_4x4x4_16b_bf16 v[124:127], v[244:245], v[32:33], v[124:127]
    ds_read_b64_tr_b16 v[26:27], v253 offset:30720
    ds_read_b64_tr_b16 v[28:29], v253 offset:31488
    v_mfma_f32_32x32x16_bf16 v[96:111], v[52:55], v[196:199], v[96:111]
    ds_read_b64_tr_b16 v[72:73], v252 offset:24576
    ds_read_b64_tr_b16 v[74:75], v252 offset:25344
    s_add_u32 s91, s90, 5120
    buffer_load_dwordx4 v[34:37], v1, s[24:27], s91 offen sc1
    v_mfma_f32_32x32x16_bf16 v[96:111], v[56:59], v[200:203], v[96:111]
    ds_read_b64_tr_b16 v[76:77], v252 offset:27648
    ds_read_b64_tr_b16 v[78:79], v252 offset:28416
    s_waitcnt lgkmcnt(10)
    v_mfma_f32_32x32x16_bf16 v[96:111], v[60:63], v[204:207], v[96:111]
    ds_read_b64_tr_b16 v[48:49], v252 offset:30720
    ds_read_b64_tr_b16 v[50:51], v252 offset:31488
    s_waitcnt lgkmcnt(7)
    v_mfma_f32_4x4x4_16b_bf16 v[124:127], v[244:245], v[26:27], v[124:127]
    s_waitcnt lgkmcnt(6)
    s_nop 0
    v_mfma_f32_4x4x4_16b_bf16 v[124:127], v[244:245], v[28:29], v[124:127]
    v_mfma_f32_32x32x16_bf16 v[96:111], v[64:67], v[208:211], v[96:111]
    ds_read_b64_tr_b16 v[52:53], v252 offset:33792
    ds_read_b64_tr_b16 v[54:55], v252 offset:34560
    s_add_u32 s91, s90, 6144
    buffer_load_dwordx4 v[38:41], v1, s[24:27], s91 offen sc1
    v_mfma_f32_32x32x16_bf16 v[96:111], v[68:71], v[212:215], v[96:111]
    ds_read_b64_tr_b16 v[56:57], v252 offset:36864
    ds_read_b64_tr_b16 v[58:59], v252 offset:37632
    s_waitcnt lgkmcnt(8)
    v_mfma_f32_32x32x16_bf16 v[96:111], v[72:75], v[216:219], v[96:111]
    ds_read_b64_tr_b16 v[60:61], v252 offset:39936
    ds_read_b64_tr_b16 v[62:63], v252 offset:40704
    s_waitcnt lgkmcnt(8)
    v_mfma_f32_32x32x16_bf16 v[96:111], v[76:79], v[220:223], v[96:111]
    v_mov_b32 v46, v124
    v_mov_b32 v33, v124
    s_nop 1
    v_permlane32_swap_b32 v46, v33
    v_add_f32 v46, v46, v33
    ds_write_b32 v249, v46
    s_waitcnt lgkmcnt(7)
    v_mfma_f32_32x32x16_bf16 v[96:111], v[48:51], v[224:227], v[96:111]
    s_waitcnt lgkmcnt(5)
    v_mfma_f32_32x32x16_bf16 v[96:111], v[52:55], v[228:231], v[96:111]
    s_waitcnt lgkmcnt(3)
    v_mfma_f32_32x32x16_bf16 v[96:111], v[56:59], v[232:235], v[96:111]
    s_waitcnt lgkmcnt(1)
    v_mfma_f32_32x32x16_bf16 v[96:111], v[60:63], v[236:239], v[96:111]
    s_waitcnt lgkmcnt(0)
    s_barrier
    s_cmp_ge_u32 s20, 14
    s_cbranch_scc1 KB_NOST
    s_mov_b32 s52, 0
    s_waitcnt vmcnt(0)
KB_CHECK:
    v_xor_b32 v26, s21, v113
    v_xor_b32 v28, s21, v115
    v_or_b32 v30, v26, v28
    v_xor_b32 v27, s21, v117
    v_xor_b32 v29, s21, v119
    v_or_b32 v31, v27, v29
    v_xor_b32 v26, s21, v121
    v_xor_b32 v28, s21, v123
    v_or3_b32 v30, v30, v26, v28
    v_xor_b32 v27, s21, v19
    v_xor_b32 v29, s21, v21
    v_or3_b32 v31, v31, v27, v29
    v_xor_b32 v26, s21, v23
    v_xor_b32 v28, s21, v25
    v_or3_b32 v30, v30, v26, v28
    v_xor_b32 v27, s21, v35
    v_xor_b32 v29, s21, v37
    v_or3_b32 v31, v31, v27, v29
    v_xor_b32 v26, s21, v39
    v_xor_b32 v28, s21, v41
    v_or3_b32 v30, v30, v26, v28
    v_or_b32 v30, v30, v31
    v_cmp_ne_u32 vcc, 0, v30
    s_nop 0
    s_cmp_eq_u64 vcc, 0
    s_cbranch_scc1 KB_POLLDONE
    s_add_u32 s52, s52, 1
    s_cmp_gt_u32 s52, 0x40000
    s_cbranch_scc1 KB_POLLDONE
    s_mul_i32 s90, s22, 7168
    s_add_u32 s90, s90, 23068672
    s_add_u32 s53, s90, 0
    buffer_load_dwordx4 v[112:115], v1, s[24:27], s53 offen sc1
    s_add_u32 s53, s90, 1024
    buffer_load_dwordx4 v[116:119], v1, s[24:27], s53 offen sc1
    s_add_u32 s53, s90, 2048
    buffer_load_dwordx4 v[120:123], v1, s[24:27], s53 offen sc1
    s_add_u32 s53, s90, 3072
    buffer_load_dwordx4 v[18:21], v1, s[24:27], s53 offen sc1
    s_add_u32 s53, s90, 4096
    buffer_load_dwordx4 v[22:25], v1, s[24:27], s53 offen sc1
    s_add_u32 s53, s90, 5120
    buffer_load_dwordx4 v[34:37], v1, s[24:27], s53 offen sc1
    s_add_u32 s53, s90, 6144
    buffer_load_dwordx4 v[38:41], v1, s[24:27], s53 offen sc1
    s_waitcnt vmcnt(0)
    s_branch KB_CHECK
KB_POLLDONE:
    v_add_f32 v30, v112, v116
    v_add_f32 v31, v114, v118
    v_add_f32 v30, v30, v120
    v_add_f32 v31, v31, v122
    v_add_f32 v30, v30, v18
    v_add_f32 v31, v31, v20
    v_add_f32 v30, v30, v22
    v_add_f32 v31, v31, v24
    v_add_f32 v30, v30, v34
    v_add_f32 v31, v31, v36
    v_add_f32 v30, v30, v38
    v_add_f32 v31, v31, v40
    v_mov_b32 v34, v30
    v_mov_b32 v35, v31
    s_nop 0
    v_permlane32_swap_b32 v30, v34
    v_permlane32_swap_b32 v31, v35
    v_add_f32 v34, v34, v30
    v_add_f32 v35, v35, v31
    v_mul_f32 v34, 0x3a924925, v34
    v_mul_f32 v35, 0x3a924925, v35
    v_fma_f32 v35, -v34, v34, v35
    v_max_f32 v35, 0, v35
    v_add_f32 v35, 0x3727c5ac, v35
    v_rsq_f32 v35, v35
    v_add_u32 v18, 162816, v246
    v_mul_f32 v34, v34, v35
    ds_write_b64 v18, v[34:35]
    s_sub_u32 s53, s16, 4
    s_or_b32 s53, s53, s20
    s_cmp_lg_u32 s53, 0
    s_cbranch_scc1 KB_NOBUMP
    v_mov_b32 v18, s21
    s_mov_b64 exec, 1
    buffer_store_dword v18, v248, s[24:27], s50 offen sc1
    s_mov_b64 exec, -1
KB_NOBUMP:
KB_NOST:
    s_mul_i32 s62, s20, 3
    s_add_u32 s62, s62, 1
    s_lshr_b32 s52, s62, 4
    s_and_b32 s53, s62, 15
    v_mov_b32 v46, v17
    s_cmp_lg_u32 s52, 0
    s_cbranch_scc1 KBH1_NQ
    v_mul_f32 v46, 0x3e8b97f6, v46
KBH1_NQ:
    ds_read_b32 v26, v247
    ds_read_b32 v27, v247 offset:128
    s_waitcnt lgkmcnt(1)
    v_and_b32 v32, 0xffff0000, v26
    v_sub_f32 v33, v26, v32
    v_lshrrev_b32 v29, 16, v32
    v_and_or_b32 v28, v33, s60, v29
    s_waitcnt lgkmcnt(0)
    v_and_b32 v32, 0xffff0000, v27
    v_sub_f32 v33, v27, v32
    v_lshrrev_b32 v31, 16, v32
    v_and_or_b32 v30, v33, s60, v31
    s_nop 1
    v_mfma_f32_32x32x16_bf16 v[96:111], v[28:31], v[42:45], v[96:111]
    s_nop 11
    v_mul_f32 v96, v96, v46
    v_mul_f32 v97, v97, v46
    v_mul_f32 v98, v98, v46
    v_mul_f32 v99, v99, v46
    v_mul_f32 v100, v100, v46
    v_mul_f32 v101, v101, v46
    v_mul_f32 v102, v102, v46
    v_mul_f32 v103, v103, v46
    v_mul_f32 v104, v104, v46
    v_mul_f32 v105, v105, v46
    v_mul_f32 v106, v106, v46
    v_mul_f32 v107, v107, v46
    v_mul_f32 v108, v108, v46
    v_mul_f32 v109, v109, v46
    v_mul_f32 v110, v110, v46
    v_mul_f32 v111, v111, v46
    s_cmp_eq_u32 s52, 0
    s_cselect_b32 s54, 0, 1.0
    s_cmp_eq_u32 s52, 1
    s_cselect_b32 s55, 1.0, 0
    s_mov_b64 exec, s[58:59]
    v_mov_b32 v108, s54
    v_mov_b32 v109, s55
    v_mov_b32 v110, 0
    v_mov_b32 v111, 0
    s_mov_b64 exec, -1
    s_waitcnt vmcnt(1)
    v_cvt_pk_bf16_f32 v34, v96, v97
    v_cvt_pk_bf16_f32 v35, v98, v99
    v_cvt_pk_bf16_f32 v36, v100, v101
    v_cvt_pk_bf16_f32 v37, v102, v103
    s_waitcnt vmcnt(0)
    v_cvt_pk_bf16_f32 v38, v104, v105
    v_cvt_pk_bf16_f32 v39, v106, v107
    v_cvt_pk_bf16_f32 v40, v108, v109
    v_cvt_pk_bf16_f32 v41, v110, v111
    s_lshl_b32 s54, s53, 6
    s_add_u32 s54, s54, s22
    s_cmp_eq_u32 s52, 2
    s_cbranch_scc1 KBH1_V
    s_lshl_b32 s55, s54, 11
    s_add_u32 s55, s55, 0
    s_lshl_b32 s54, s54, 12
    s_add_u32 s54, s54, 2097152
    s_cmp_eq_u32 s52, 0
    s_cselect_b32 s54, s55, s54
    buffer_store_dwordx4 v[34:37], v1, s[24:27], s54 offen offset:0 sc1
    buffer_store_dwordx4 v[38:41], v1, s[24:27], s54 offen offset:1024 sc1
    s_branch KBH1_D
KBH1_V:
    ds_write_b64 v241, v[34:35] offset:0
    ds_write_b64 v241, v[36:37] offset:16
    ds_write_b64 v241, v[38:39] offset:32
    ds_write_b64 v241, v[40:41] offset:48
    s_waitcnt lgkmcnt(0)
    ds_read_b64_tr_b16 v[20:21], v242 offset:0
    ds_read_b64_tr_b16 v[22:23], v242 offset:576
    ds_read_b64_tr_b16 v[24:25], v242 offset:1152
    ds_read_b64_tr_b16 v[26:27], v242 offset:1728
    s_lshl_b32 s54, s54, 12
    s_add_u32 s54, s54, 2099200
    s_waitcnt lgkmcnt(2)
    buffer_store_dwordx4 v[20:23], v1, s[24:27], s54 offen offset:0 sc1
    s_waitcnt lgkmcnt(0)
    buffer_store_dwordx4 v[24:27], v1, s[24:27], s54 offen offset:1024 sc1
KBH1_D:
    s_barrier
    s_cmp_ge_u32 s20, 14
    s_cbranch_scc1 KB_NOFIN
    v_add_u32 v18, 162816, v246
    ds_read_b64 v[34:35], v18
    s_waitcnt lgkmcnt(0)
    v_fma_f32 v80, v80, v35, -v34
    v_fma_f32 v81, v81, v35, -v34
    v_fma_f32 v82, v82, v35, -v34
    v_fma_f32 v83, v83, v35, -v34
    v_fma_f32 v84, v84, v35, -v34
    v_fma_f32 v85, v85, v35, -v34
    v_fma_f32 v86, v86, v35, -v34
    v_fma_f32 v87, v87, v35, -v34
    v_fma_f32 v88, v88, v35, -v34
    v_fma_f32 v89, v89, v35, -v34
    v_fma_f32 v90, v90, v35, -v34
    v_fma_f32 v91, v91, v35, -v34
    v_fma_f32 v92, v92, v35, -v34
    v_fma_f32 v93, v93, v35, -v34
    v_fma_f32 v94, v94, v35, -v34
    v_fma_f32 v95, v95, v35, -v34
    v_cvt_pk_bf16_f32 v36, v80, v81
    v_cvt_pk_bf16_f32 v37, v82, v83
    v_cvt_pk_bf16_f32 v38, v84, v85
    v_cvt_pk_bf16_f32 v39, v86, v87
    v_cvt_pk_bf16_f32 v40, v88, v89
    v_cvt_pk_bf16_f32 v41, v90, v91
    v_cvt_pk_bf16_f32 v42, v92, v93
    v_cvt_pk_bf16_f32 v43, v94, v95
    ds_write_b64 v241, v[36:37] offset:0
    ds_write_b64 v241, v[38:39] offset:16
    ds_write_b64 v241, v[40:41] offset:32
    ds_write_b64 v241, v[42:43] offset:48
    s_waitcnt lgkmcnt(0)
    ds_read_b64_tr_b16 v[20:21], v243 offset:0
    ds_read_b64_tr_b16 v[22:23], v243 offset:288
    ds_read_b64_tr_b16 v[24:25], v243 offset:1152
    ds_read_b64_tr_b16 v[26:27], v243 offset:1440
    s_lshl_b32 s51, s20, 7
    s_lshl_b32 s52, s22, 1
    s_add_u32 s51, s51, s52
    s_lshl_b32 s51, s51, 11
    s_lshl_b32 s52, s18, 10
    s_add_u32 s51, s51, s52
    s_add_u32 s51, s51, 10485760
    s_waitcnt lgkmcnt(2)
    buffer_store_dwordx4 v[20:23], v1, s[24:27], s51 offen sc1
    s_waitcnt lgkmcnt(0)
    buffer_store_dwordx4 v[24:27], v1, s[24:27], s51 offen offset:2048 sc1
KB_NOFIN:
    s_sub_u32 s57, s20, 2
    s_cmp_lt_u32 s57, 12
    s_cbranch_scc1 KB_NOPREP
    v_lshrrev_b32 v26, 4, v0
    v_and_b32 v27, 1, v26
    v_lshrrev_b32 v26, 1, v26
    v_lshrrev_b32 v28, 2, v0
    v_and_b32 v28, 3, v28
    v_lshl_add_u32 v26, v26, 2, v28
    v_lshlrev_b32 v26, 6, v26
    v_lshl_add_u32 v26, v27, 5, v26
    v_and_b32 v27, 3, v0
    v_lshl_add_u32 v26, v27, 3, v26
    v_add_u32 v26, s71, v26
    s_waitcnt vmcnt(0)
    ds_read_b64_tr_b16 v[96:97], v26 offset:0
    ds_read_b64_tr_b16 v[98:99], v26 offset:512
    ds_read_b64_tr_b16 v[100:101], v26 offset:1024
    ds_read_b64_tr_b16 v[102:103], v26 offset:1536
    ds_read_b64_tr_b16 v[104:105], v26 offset:2048
    ds_read_b64_tr_b16 v[106:107], v26 offset:2560
    ds_read_b64_tr_b16 v[108:109], v26 offset:3072
    ds_read_b64_tr_b16 v[110:111], v26 offset:3584
    ds_read_b64_tr_b16 v[112:113], v26 offset:4096
    ds_read_b64_tr_b16 v[114:115], v26 offset:4608
    s_add_u32 s80, s70, 0
    s_lshl_b32 s51, s80, 10
    s_add_u32 s51, s51, 20971520
    s_cmp_lt_u32 s80, 1232
    s_cselect_b32 s51, s51, 0x7ff00000
    s_waitcnt lgkmcnt(8)
    buffer_store_dwordx4 v[96:99], v1, s[24:27], s51 offen sc1
    s_add_u32 s80, s70, 256
    s_lshl_b32 s51, s80, 10
    s_add_u32 s51, s51, 20971520
    s_cmp_lt_u32 s80, 1232
    s_cselect_b32 s51, s51, 0x7ff00000
    s_waitcnt lgkmcnt(6)
    buffer_store_dwordx4 v[100:103], v1, s[24:27], s51 offen sc1
    s_add_u32 s80, s70, 512
    s_lshl_b32 s51, s80, 10
    s_add_u32 s51, s51, 20971520
    s_cmp_lt_u32 s80, 1232
    s_cselect_b32 s51, s51, 0x7ff00000
    s_waitcnt lgkmcnt(4)
    buffer_store_dwordx4 v[104:107], v1, s[24:27], s51 offen sc1
    s_add_u32 s80, s70, 768
    s_lshl_b32 s51, s80, 10
    s_add_u32 s51, s51, 20971520
    s_cmp_lt_u32 s80, 1232
    s_cselect_b32 s51, s51, 0x7ff00000
    s_waitcnt lgkmcnt(2)
    buffer_store_dwordx4 v[108:111], v1, s[24:27], s51 offen sc1
    s_add_u32 s80, s70, 1024
    s_lshl_b32 s51, s80, 10
    s_add_u32 s51, s51, 20971520
    s_cmp_lt_u32 s80, 1232
    s_cselect_b32 s51, s51, 0x7ff00000
    s_waitcnt lgkmcnt(0)
    buffer_store_dwordx4 v[112:115], v1, s[24:27], s51 offen sc1
KB_NOPREP:
K1_END:
    s_endpgm
.globl k2_kernel
.p2align 8
.type k2_kernel,@function
k2_kernel:
    s_cmp_ge_u32 s2, 256
    s_cbranch_scc1 K2_END
    s_load_dwordx2 s[4:5], s[0:1], 80
    s_load_dwordx2 s[6:7], s[0:1], 40
    s_load_dwordx2 s[8:9], s[0:1], 48
    s_load_dwordx2 s[10:11], s[0:1], 0
    s_load_dwordx2 s[12:13], s[0:1], 64
    v_lshrrev_b32 v1, 6, v0
    v_and_b32 v0, 63, v0
    v_readfirstlane_b32 s23, v1
    s_and_b32 s22, s2, 7
    s_lshr_b32 s21, s2, 3
    s_and_b32 s16, s23, 3
    v_lshlrev_b32 v1, 4, v0
    s_cmp_ge_u32 s23, 4
    s_cbranch_scc1 K2_ROLEB
    s_mov_b32 s48, 0
    s_mov_b32 s49, -1
    s_lshr_b32 s40, s21, 4
    s_lshl_b32 s41, s22, 1
    s_add_u32 s17, s40, s41
    s_and_b32 s18, s21, 15
    s_lshl_b32 s40, s17, 17
    s_lshl_b32 s41, s18, 13
    s_add_u32 s47, s40, s41
    s_add_u32 s54, s16, 0
    s_and_b32 s54, s54, 3
    s_lshl_b32 s54, s54, 11
    s_add_u32 s54, s54, s47
    s_add_u32 s55, s16, 1
    s_and_b32 s55, s55, 3
    s_lshl_b32 s55, s55, 11
    s_add_u32 s55, s55, s47
    s_add_u32 s56, s16, 2
    s_and_b32 s56, s56, 3
    s_lshl_b32 s56, s56, 11
    s_add_u32 s56, s56, s47
    s_add_u32 s57, s16, 3
    s_and_b32 s57, s57, 3
    s_lshl_b32 s57, s57, 11
    s_add_u32 s57, s57, s47
    s_lshl_b32 s40, s17, 18
    s_lshl_b32 s41, s16, 16
    s_add_u32 s40, s40, s41
    s_add_u32 s40, s40, 2097152
    s_waitcnt lgkmcnt(0)
    s_mov_b32 s24, s4
    s_mov_b32 s25, s5
    s_mov_b32 s26, 25165824
    s_mov_b32 s27, 0x00020000
    s_mov_b32 s63, 24117248
    v_mov_b32 v14, 0
    buffer_load_dword v14, v14, s[24:27], s63 offen sc1
    v_mov_b32 v12, 151552
    v_mov_b32 v13, 0
    ds_write_b32 v12, v13
    ds_write_b32 v12, v13 offset:4
    ds_write_b32 v12, v13 offset:8
    ds_write_b32 v12, v13 offset:16
    ds_write_b32 v12, v13 offset:20
    ds_write_b32 v12, v13 offset:24
    ds_write_b32 v12, v13 offset:28
    s_waitcnt lgkmcnt(0)
    s_barrier
    buffer_load_dwordx4 v[16:19], v1, s[24:27], s54 offen
    buffer_load_dwordx4 v[20:23], v1, s[24:27], s54 offen offset:1024
    buffer_load_dwordx4 v[24:27], v1, s[24:27], s55 offen
    buffer_load_dwordx4 v[28:31], v1, s[24:27], s55 offen offset:1024
    buffer_load_dwordx4 v[32:35], v1, s[24:27], s56 offen
    buffer_load_dwordx4 v[36:39], v1, s[24:27], s56 offen offset:1024
    buffer_load_dwordx4 v[40:43], v1, s[24:27], s57 offen
    buffer_load_dwordx4 v[44:47], v1, s[24:27], s57 offen offset:1024
    s_mov_b32 s58, 1
    s_mov_b32 s42, 1
    s_mov_b32 s43, 0x42800000
A_RETRY:
    v_mov_b32 v224, 0xff7fffff
    v_mov_b32 v225, 0xff7fffff
    v_mov_b32 v226, 0xff7fffff
    v_mov_b32 v227, 0xff7fffff
    s_mov_b32 s45, s42
    buffer_load_dwordx4 v[160:163], v1, s[24:27], s40 offen offset:0
    buffer_load_dwordx4 v[164:167], v1, s[24:27], s40 offen offset:1024
    buffer_load_dwordx4 v[168:171], v1, s[24:27], s40 offen offset:2048
    buffer_load_dwordx4 v[172:175], v1, s[24:27], s40 offen offset:3072
    s_add_u32 s44, s40, 4096
    buffer_load_dwordx4 v[176:179], v1, s[24:27], s44 offen offset:0
    buffer_load_dwordx4 v[180:183], v1, s[24:27], s44 offen offset:1024
    buffer_load_dwordx4 v[184:187], v1, s[24:27], s44 offen offset:2048
    buffer_load_dwordx4 v[188:191], v1, s[24:27], s44 offen offset:3072
    s_add_u32 s44, s44, 4096
    buffer_load_dwordx4 v[192:195], v1, s[24:27], s44 offen offset:0
    buffer_load_dwordx4 v[196:199], v1, s[24:27], s44 offen offset:1024
    buffer_load_dwordx4 v[200:203], v1, s[24:27], s44 offen offset:2048
    buffer_load_dwordx4 v[204:207], v1, s[24:27], s44 offen offset:3072
    s_add_u32 s44, s44, 4096
    s_mov_b32 s62, s40
    v_mov_b32 v48, 0
    v_mov_b32 v49, 0
    v_mov_b32 v50, 0
    v_mov_b32 v51, 0
    v_mov_b32 v52, 0
    v_mov_b32 v53, 0
    v_mov_b32 v54, 0
    v_mov_b32 v55, 0
    v_mov_b32 v56, 0
    v_mov_b32 v57, 0
    v_mov_b32 v58, 0
    v_mov_b32 v59, 0
    v_mov_b32 v60, 0
    v_mov_b32 v61, 0
    v_mov_b32 v62, 0
    v_mov_b32 v63, 0
    v_mov_b32 v64, 0
    v_mov_b32 v65, 0
    v_mov_b32 v66, 0
    v_mov_b32 v67, 0
    v_mov_b32 v68, 0
    v_mov_b32 v69, 0
    v_mov_b32 v70, 0
    v_mov_b32 v71, 0
    v_mov_b32 v72, 0
    v_mov_b32 v73, 0
    v_mov_b32 v74, 0
    v_mov_b32 v75, 0
    v_mov_b32 v76, 0
    v_mov_b32 v77, 0
    v_mov_b32 v78, 0
    v_mov_b32 v79, 0
    v_mov_b32 v80, 0
    v_mov_b32 v81, 0
    v_mov_b32 v82, 0
    v_mov_b32 v83, 0
    v_mov_b32 v84, 0
    v_mov_b32 v85, 0
    v_mov_b32 v86, 0
    v_mov_b32 v87, 0
    v_mov_b32 v88, 0
    v_mov_b32 v89, 0
    v_mov_b32 v90, 0
    v_mov_b32 v91, 0
    v_mov_b32 v92, 0
    v_mov_b32 v93, 0
    v_mov_b32 v94, 0
    v_mov_b32 v95, 0
    v_mov_b32 v96, 0
    v_mov_b32 v97, 0
    v_mov_b32 v98, 0
    v_mov_b32 v99, 0
    v_mov_b32 v100, 0
    v_mov_b32 v101, 0
    v_mov_b32 v102, 0
    v_mov_b32 v103, 0
    v_mov_b32 v104, 0
    v_mov_b32 v105, 0
    v_mov_b32 v106, 0
    v_mov_b32 v107, 0
    v_mov_b32 v108, 0
    v_mov_b32 v109, 0
    v_mov_b32 v110, 0
    v_mov_b32 v111, 0
    v_mov_b32 v152, 0
    v_mov_b32 v153, 0
    v_mov_b32 v154, 0
    v_mov_b32 v155, 0
    v_mov_b32 v156, 0
    v_mov_b32 v157, 0
    v_mov_b32 v158, 0
    v_mov_b32 v159, 0
    v_mov_b32 v216, 0
    v_mov_b32 v217, 0
    v_mov_b32 v218, 0
    v_mov_b32 v219, 0
    v_mov_b32 v220, 0
    v_mov_b32 v221, 0
    v_mov_b32 v222, 0
    v_mov_b32 v223, 0
    s_cmp_eq_u32 s58, 1
    s_cbranch_scc0 A_MAXLOOP
    s_mov_b32 s58, 0
A_MAXLOOP:
    s_waitcnt vmcnt(11)
    v_mfma_f32_32x32x16_bf16 v[112:127], v[160:163], v[16:19], 0
    s_waitcnt vmcnt(10)
    v_mfma_f32_32x32x16_bf16 v[112:127], v[164:167], v[20:23], v[112:127]
    v_mfma_f32_32x32x16_bf16 v[128:143], v[160:163], v[24:27], 0
    v_mfma_f32_32x32x16_bf16 v[128:143], v[164:167], v[28:31], v[128:143]
    s_nop 9
    v_max3_f32 v228, v112, v113, v114
    v_max3_f32 v229, v116, v117, v118
    v_max3_f32 v230, v120, v121, v122
    v_max3_f32 v231, v124, v125, v126
    v_max3_f32 v228, v228, v115, v119
    v_max3_f32 v229, v229, v123, v127
    v_max3_f32 v228, v228, v230, v231
    v_max3_f32 v224, v224, v228, v229
    v_mfma_f32_32x32x16_bf16 v[112:127], v[160:163], v[32:35], 0
    v_mfma_f32_32x32x16_bf16 v[112:127], v[164:167], v[36:39], v[112:127]
    v_max3_f32 v228, v128, v129, v130
    v_max3_f32 v229, v132, v133, v134
    v_max3_f32 v230, v136, v137, v138
    v_max3_f32 v231, v140, v141, v142
    v_max3_f32 v228, v228, v131, v135
    v_max3_f32 v229, v229, v139, v143
    v_max3_f32 v228, v228, v230, v231
    v_max3_f32 v225, v225, v228, v229
    v_mfma_f32_32x32x16_bf16 v[128:143], v[160:163], v[40:43], 0
    v_mfma_f32_32x32x16_bf16 v[128:143], v[164:167], v[44:47], v[128:143]
    s_nop 1
    v_max3_f32 v228, v112, v113, v114
    v_max3_f32 v229, v116, v117, v118
    v_max3_f32 v230, v120, v121, v122
    v_max3_f32 v231, v124, v125, v126
    v_max3_f32 v228, v228, v115, v119
    v_max3_f32 v229, v229, v123, v127
    v_max3_f32 v228, v228, v230, v231
    v_max3_f32 v226, v226, v228, v229
    s_nop 1
    v_max3_f32 v228, v128, v129, v130
    v_max3_f32 v229, v132, v133, v134
    v_max3_f32 v230, v136, v137, v138
    v_max3_f32 v231, v140, v141, v142
    v_max3_f32 v228, v228, v131, v135
    v_max3_f32 v229, v229, v139, v143
    v_max3_f32 v228, v228, v230, v231
    v_max3_f32 v227, v227, v228, v229
    s_sub_u32 s45, s45, 1
    s_cmp_eq_u32 s45, 0
    s_cbranch_scc1 A_MAXDONE
    s_add_u32 s62, s62, 4096
    buffer_load_dwordx4 v[160:163], v1, s[24:27], s62 offen offset:0
    buffer_load_dwordx4 v[164:167], v1, s[24:27], s62 offen offset:1024
    s_waitcnt vmcnt(0)
    s_branch A_MAXLOOP
A_MAXDONE:
    s_cmp_eq_u32 s42, 1
    s_cbranch_scc1 A_KEEPK
    buffer_load_dwordx4 v[160:163], v1, s[24:27], s40 offen offset:0
    buffer_load_dwordx4 v[164:167], v1, s[24:27], s40 offen offset:1024
A_KEEPK:
    v_mov_b32 v228, v224
    s_nop 1
    v_permlane32_swap_b32 v228, v224
    v_max_f32 v224, v228, v224
    v_add_f32 v224, s43, v224
    v_sub_f32 v228, 0, v224
    v_and_b32 v229, 0xffff0000, v228
    v_sub_f32 v230, v228, v229
    v_and_b32 v230, 0xffff0000, v230
    v_add_f32 v231, v229, v230
    v_sub_f32 v224, 0, v231
    v_lshrrev_b32 v229, 16, v229
    v_or_b32 v229, v229, v230
    s_mov_b64 exec, s[48:49]
    v_mov_b32 v22, v229
    s_mov_b64 exec, -1
    v_mov_b32 v228, v225
    s_nop 1
    v_permlane32_swap_b32 v228, v225
    v_max_f32 v225, v228, v225
    v_add_f32 v225, s43, v225
    v_sub_f32 v228, 0, v225
    v_and_b32 v229, 0xffff0000, v228
    v_sub_f32 v230, v228, v229
    v_and_b32 v230, 0xffff0000, v230
    v_add_f32 v231, v229, v230
    v_sub_f32 v225, 0, v231
    v_lshrrev_b32 v229, 16, v229
    v_or_b32 v229, v229, v230
    s_mov_b64 exec, s[48:49]
    v_mov_b32 v30, v229
    s_mov_b64 exec, -1
    v_mov_b32 v228, v226
    s_nop 1
    v_permlane32_swap_b32 v228, v226
    v_max_f32 v226, v228, v226
    v_add_f32 v226, s43, v226
    v_sub_f32 v228, 0, v226
    v_and_b32 v229, 0xffff0000, v228
    v_sub_f32 v230, v228, v229
    v_and_b32 v230, 0xffff0000, v230
    v_add_f32 v231, v229, v230
    v_sub_f32 v226, 0, v231
    v_lshrrev_b32 v229, 16, v229
    v_or_b32 v229, v229, v230
    s_mov_b64 exec, s[48:49]
    v_mov_b32 v38, v229
    s_mov_b64 exec, -1
    v_mov_b32 v228, v227
    s_nop 1
    v_permlane32_swap_b32 v228, v227
    v_max_f32 v227, v228, v227
    v_add_f32 v227, s43, v227
    v_sub_f32 v228, 0, v227
    v_and_b32 v229, 0xffff0000, v228
    v_sub_f32 v230, v228, v229
    v_and_b32 v230, 0xffff0000, v230
    v_add_f32 v231, v229, v230
    v_sub_f32 v227, 0, v231
    v_lshrrev_b32 v229, 16, v229
    v_or_b32 v229, v229, v230
    s_mov_b64 exec, s[48:49]
    v_mov_b32 v46, v229
    s_mov_b64 exec, -1
    s_waitcnt vmcnt(1)
    v_mfma_f32_32x32x16_bf16 v[112:127], v[160:163], v[16:19], 0
    s_waitcnt vmcnt(0)
    v_mfma_f32_32x32x16_bf16 v[112:127], v[164:167], v[20:23], v[112:127]
    s_mov_b32 s46, 3
A_LOOP:
    v_mfma_f32_32x32x16_bf16 v[128:143], v[160:163], v[24:27], 0
    s_nop 9
    v_exp_f32 v112, v112
    v_exp_f32 v113, v113
    v_exp_f32 v114, v114
    v_exp_f32 v115, v115
    v_cvt_pk_bf16_f32 v144, v112, v113
    v_mfma_f32_32x32x16_bf16 v[96:111], v[216:219], v[152:155], v[96:111]
    v_exp_f32 v116, v116
    v_exp_f32 v117, v117
    v_cvt_pk_bf16_f32 v145, v114, v115
    v_exp_f32 v118, v118
    v_exp_f32 v119, v119
    v_cvt_pk_bf16_f32 v146, v116, v117
    v_mfma_f32_32x32x16_bf16 v[128:143], v[164:167], v[28:31], v[128:143]
    buffer_load_dwordx4 v[208:211], v1, s[24:27], s44 offen offset:0
    v_exp_f32 v120, v120
    v_exp_f32 v121, v121
    v_cvt_pk_bf16_f32 v147, v118, v119
    v_exp_f32 v122, v122
    v_exp_f32 v123, v123
    v_cvt_pk_bf16_f32 v148, v120, v121
    v_mfma_f32_32x32x16_bf16 v[96:111], v[220:223], v[156:159], v[96:111]
    buffer_load_dwordx4 v[212:215], v1, s[24:27], s44 offen offset:1024
    v_exp_f32 v124, v124
    v_exp_f32 v125, v125
    v_cvt_pk_bf16_f32 v149, v122, v123
    v_exp_f32 v126, v126
    v_exp_f32 v127, v127
    v_cvt_pk_bf16_f32 v150, v124, v125
    v_cvt_pk_bf16_f32 v151, v126, v127
    v_mfma_f32_32x32x16_bf16 v[112:127], v[160:163], v[32:35], 0
    buffer_load_dwordx4 v[216:219], v1, s[24:27], s44 offen offset:2048
    v_exp_f32 v128, v128
    v_exp_f32 v129, v129
    v_exp_f32 v130, v130
    v_exp_f32 v131, v131
    v_cvt_pk_bf16_f32 v152, v128, v129
    s_waitcnt vmcnt(12)
    v_mfma_f32_32x32x16_bf16 v[48:63], v[168:171], v[144:147], v[48:63]
    buffer_load_dwordx4 v[220:223], v1, s[24:27], s44 offen offset:3072
    s_add_u32 s44, s44, 4096
    v_exp_f32 v132, v132
    v_exp_f32 v133, v133
    v_cvt_pk_bf16_f32 v153, v130, v131
    v_exp_f32 v134, v134
    v_exp_f32 v135, v135
    v_cvt_pk_bf16_f32 v154, v132, v133
    v_mfma_f32_32x32x16_bf16 v[112:127], v[164:167], v[36:39], v[112:127]
    v_exp_f32 v136, v136
    v_exp_f32 v137, v137
    v_cvt_pk_bf16_f32 v155, v134, v135
    v_exp_f32 v138, v138
    v_exp_f32 v139, v139
    v_cvt_pk_bf16_f32 v156, v136, v137
    s_waitcnt vmcnt(12)
    v_mfma_f32_32x32x16_bf16 v[48:63], v[172:175], v[148:151], v[48:63]
    v_exp_f32 v140, v140
    v_exp_f32 v141, v141
    v_cvt_pk_bf16_f32 v157, v138, v139
    v_exp_f32 v142, v142
    v_exp_f32 v143, v143
    v_cvt_pk_bf16_f32 v158, v140, v141
    v_cvt_pk_bf16_f32 v159, v142, v143
    v_mfma_f32_32x32x16_bf16 v[128:143], v[160:163], v[40:43], 0
    v_exp_f32 v112, v112
    v_exp_f32 v113, v113
    v_exp_f32 v114, v114
    v_exp_f32 v115, v115
    v_cvt_pk_bf16_f32 v144, v112, v113
    v_mfma_f32_32x32x16_bf16 v[64:79], v[168:171], v[152:155], v[64:79]
    v_exp_f32 v116, v116
    v_exp_f32 v117, v117
    v_cvt_pk_bf16_f32 v145, v114, v115
    v_exp_f32 v118, v118
    v_exp_f32 v119, v119
    v_cvt_pk_bf16_f32 v146, v116, v117
    v_mfma_f32_32x32x16_bf16 v[128:143], v[164:167], v[44:47], v[128:143]
    v_exp_f32 v120, v120
    v_exp_f32 v121, v121
    v_cvt_pk_bf16_f32 v147, v118, v119
    v_exp_f32 v122, v122
    v_exp_f32 v123, v123
    v_cvt_pk_bf16_f32 v148, v120, v121
    v_mfma_f32_32x32x16_bf16 v[64:79], v[172:175], v[156:159], v[64:79]
    v_exp_f32 v124, v124
    v_exp_f32 v125, v125
    v_cvt_pk_bf16_f32 v149, v122, v123
    v_exp_f32 v126, v126
    v_exp_f32 v127, v127
    v_cvt_pk_bf16_f32 v150, v124, v125
    v_cvt_pk_bf16_f32 v151, v126, v127
    s_waitcnt vmcnt(11)
    v_mfma_f32_32x32x16_bf16 v[112:127], v[176:179], v[16:19], 0
    v_exp_f32 v128, v128
    v_exp_f32 v129, v129
    v_exp_f32 v130, v130
    v_exp_f32 v131, v131
    v_cvt_pk_bf16_f32 v152, v128, v129
    v_mfma_f32_32x32x16_bf16 v[80:95], v[168:171], v[144:147], v[80:95]
    v_exp_f32 v132, v132
    v_exp_f32 v133, v133
    v_cvt_pk_bf16_f32 v153, v130, v131
    v_exp_f32 v134, v134
    v_exp_f32 v135, v135
    v_cvt_pk_bf16_f32 v154, v132, v133
    s_waitcnt vmcnt(10)
    v_mfma_f32_32x32x16_bf16 v[112:127], v[180:183], v[20:23], v[112:127]
    v_exp_f32 v136, v136
    v_exp_f32 v137, v137
    v_cvt_pk_bf16_f32 v155, v134, v135
    v_exp_f32 v138, v138
    v_exp_f32 v139, v139
    v_cvt_pk_bf16_f32 v156, v136, v137
    v_mfma_f32_32x32x16_bf16 v[80:95], v[172:175], v[148:151], v[80:95]
    v_exp_f32 v140, v140
    v_exp_f32 v141, v141
    v_cvt_pk_bf16_f32 v157, v138, v139
    v_exp_f32 v142, v142
    v_exp_f32 v143, v143
    v_cvt_pk_bf16_f32 v158, v140, v141
    v_cvt_pk_bf16_f32 v159, v142, v143
    v_mfma_f32_32x32x16_bf16 v[128:143], v[176:179], v[24:27], 0
    v_exp_f32 v112, v112
    v_exp_f32 v113, v113
    v_exp_f32 v114, v114
    v_exp_f32 v115, v115
    v_cvt_pk_bf16_f32 v144, v112, v113
    v_mfma_f32_32x32x16_bf16 v[96:111], v[168:171], v[152:155], v[96:111]
    v_exp_f32 v116, v116
    v_exp_f32 v117, v117
    v_cvt_pk_bf16_f32 v145, v114, v115
    v_exp_f32 v118, v118
    v_exp_f32 v119, v119
    v_cvt_pk_bf16_f32 v146, v116, v117
    v_mfma_f32_32x32x16_bf16 v[128:143], v[180:183], v[28:31], v[128:143]
    buffer_load_dwordx4 v[160:163], v1, s[24:27], s44 offen offset:0
    v_exp_f32 v120, v120
    v_exp_f32 v121, v121
    v_cvt_pk_bf16_f32 v147, v118, v119
    v_exp_f32 v122, v122
    v_exp_f32 v123, v123
    v_cvt_pk_bf16_f32 v148, v120, v121
    v_mfma_f32_32x32x16_bf16 v[96:111], v[172:175], v[156:159], v[96:111]
    buffer_load_dwordx4 v[164:167], v1, s[24:27], s44 offen offset:1024
    v_exp_f32 v124, v124
    v_exp_f32 v125, v125
    v_cvt_pk_bf16_f32 v149, v122, v123
    v_exp_f32 v126, v126
    v_exp_f32 v127, v127
    v_cvt_pk_bf16_f32 v150, v124, v125
    v_cvt_pk_bf16_f32 v151, v126, v127
    v_mfma_f32_32x32x16_bf16 v[112:127], v[176:179], v[32:35], 0
    buffer_load_dwordx4 v[168:171], v1, s[24:27], s44 offen offset:2048
    v_exp_f32 v128, v128
    v_exp_f32 v129, v129
    v_exp_f32 v130, v130
    v_exp_f32 v131, v131
    v_cvt_pk_bf16_f32 v152, v128, v129
    s_waitcnt vmcnt(12)
    v_mfma_f32_32x32x16_bf16 v[48:63], v[184:187], v[144:147], v[48:63]
    buffer_load_dwordx4 v[172:175], v1, s[24:27], s44 offen offset:3072
    s_add_u32 s44, s44, 4096
    v_exp_f32 v132, v132
    v_exp_f32 v133, v133
    v_cvt_pk_bf16_f32 v153, v130, v131
    v_exp_f32 v134, v134
    v_exp_f32 v135, v135
    v_cvt_pk_bf16_f32 v154, v132, v133
    v_mfma_f32_32x32x16_bf16 v[112:127], v[180:183], v[36:39], v[112:127]
    v_exp_f32 v136, v136
    v_exp_f32 v137, v137
    v_cvt_pk_bf16_f32 v155, v134, v135
    v_exp_f32 v138, v138
    v_exp_f32 v139, v139
    v_cvt_pk_bf16_f32 v156, v136, v137
    s_waitcnt vmcnt(12)
    v_mfma_f32_32x32x16_bf16 v[48:63], v[188:191], v[148:151], v[48:63]
    v_exp_f32 v140, v140
    v_exp_f32 v141, v141
    v_cvt_pk_bf16_f32 v157, v138, v139
    v_exp_f32 v142, v142
    v_exp_f32 v143, v143
    v_cvt_pk_bf16_f32 v158, v140, v141
    v_cvt_pk_bf16_f32 v159, v142, v143
    v_mfma_f32_32x32x16_bf16 v[128:143], v[176:179], v[40:43], 0
    v_exp_f32 v112, v112
    v_exp_f32 v113, v113
    v_exp_f32 v114, v114
    v_exp_f32 v115, v115
    v_cvt_pk_bf16_f32 v144, v112, v113
    v_mfma_f32_32x32x16_bf16 v[64:79], v[184:187], v[152:155], v[64:79]
    v_exp_f32 v116, v116
    v_exp_f32 v117, v117
    v_cvt_pk_bf16_f32 v145, v114, v115
    v_exp_f32 v118, v118
    v_exp_f32 v119, v119
    v_cvt_pk_bf16_f32 v146, v116, v117
    v_mfma_f32_32x32x16_bf16 v[128:143], v[180:183], v[44:47], v[128:143]
    v_exp_f32 v120, v120
    v_exp_f32 v121, v121
    v_cvt_pk_bf16_f32 v147, v118, v119
    v_exp_f32 v122, v122
    v_exp_f32 v123, v123
    v_cvt_pk_bf16_f32 v148, v120, v121
    v_mfma_f32_32x32x16_bf16 v[64:79], v[188:191], v[156:159], v[64:79]
    v_exp_f32 v124, v124
    v_exp_f32 v125, v125
    v_cvt_pk_bf16_f32 v149, v122, v123
    v_exp_f32 v126, v126
    v_exp_f32 v127, v127
    v_cvt_pk_bf16_f32 v150, v124, v125
    v_cvt_pk_bf16_f32 v151, v126, v127
    s_waitcnt vmcnt(11)
    v_mfma_f32_32x32x16_bf16 v[112:127], v[192:195], v[16:19], 0
    v_exp_f32 v128, v128
    v_exp_f32 v129, v129
    v_exp_f32 v130, v130
    v_exp_f32 v131, v131
    v_cvt_pk_bf16_f32 v152, v128, v129
    v_mfma_f32_32x32x16_bf16 v[80:95], v[184:187], v[144:147], v[80:95]
    v_exp_f32 v132, v132
    v_exp_f32 v133, v133
    v_cvt_pk_bf16_f32 v153, v130, v131
    v_exp_f32 v134, v134
    v_exp_f32 v135, v135
    v_cvt_pk_bf16_f32 v154, v132, v133
    s_waitcnt vmcnt(10)
    v_mfma_f32_32x32x16_bf16 v[112:127], v[196:199], v[20:23], v[112:127]
    v_exp_f32 v136, v136
    v_exp_f32 v137, v137
    v_cvt_pk_bf16_f32 v155, v134, v135
    v_exp_f32 v138, v138
    v_exp_f32 v139, v139
    v_cvt_pk_bf16_f32 v156, v136, v137
    v_mfma_f32_32x32x16_bf16 v[80:95], v[188:191], v[148:151], v[80:95]
    v_exp_f32 v140, v140
    v_exp_f32 v141, v141
    v_cvt_pk_bf16_f32 v157, v138, v139
    v_exp_f32 v142, v142
    v_exp_f32 v143, v143
    v_cvt_pk_bf16_f32 v158, v140, v141
    v_cvt_pk_bf16_f32 v159, v142, v143
    v_mfma_f32_32x32x16_bf16 v[128:143], v[192:195], v[24:27], 0
    v_exp_f32 v112, v112
    v_exp_f32 v113, v113
    v_exp_f32 v114, v114
    v_exp_f32 v115, v115
    v_cvt_pk_bf16_f32 v144, v112, v113
    v_mfma_f32_32x32x16_bf16 v[96:111], v[184:187], v[152:155], v[96:111]
    v_exp_f32 v116, v116
    v_exp_f32 v117, v117
    v_cvt_pk_bf16_f32 v145, v114, v115
    v_exp_f32 v118, v118
    v_exp_f32 v119, v119
    v_cvt_pk_bf16_f32 v146, v116, v117
    v_mfma_f32_32x32x16_bf16 v[128:143], v[196:199], v[28:31], v[128:143]
    buffer_load_dwordx4 v[176:179], v1, s[24:27], s44 offen offset:0
    v_exp_f32 v120, v120
    v_exp_f32 v121, v121
    v_cvt_pk_bf16_f32 v147, v118, v119
    v_exp_f32 v122, v122
    v_exp_f32 v123, v123
    v_cvt_pk_bf16_f32 v148, v120, v121
    v_mfma_f32_32x32x16_bf16 v[96:111], v[188:191], v[156:159], v[96:111]
    buffer_load_dwordx4 v[180:183], v1, s[24:27], s44 offen offset:1024
    v_exp_f32 v124, v124
    v_exp_f32 v125, v125
    v_cvt_pk_bf16_f32 v149, v122, v123
    v_exp_f32 v126, v126
    v_exp_f32 v127, v127
    v_cvt_pk_bf16_f32 v150, v124, v125
    v_cvt_pk_bf16_f32 v151, v126, v127
    v_mfma_f32_32x32x16_bf16 v[112:127], v[192:195], v[32:35], 0
    buffer_load_dwordx4 v[184:187], v1, s[24:27], s44 offen offset:2048
    v_exp_f32 v128, v128
    v_exp_f32 v129, v129
    v_exp_f32 v130, v130
    v_exp_f32 v131, v131
    v_cvt_pk_bf16_f32 v152, v128, v129
    s_waitcnt vmcnt(12)
    v_mfma_f32_32x32x16_bf16 v[48:63], v[200:203], v[144:147], v[48:63]
    buffer_load_dwordx4 v[188:191], v1, s[24:27], s44 offen offset:3072
    s_add_u32 s44, s44, 4096
    v_exp_f32 v132, v132
    v_exp_f32 v133, v133
    v_cvt_pk_bf16_f32 v153, v130, v131
    v_exp_f32 v134, v134
    v_exp_f32 v135, v135
    v_cvt_pk_bf16_f32 v154, v132, v133
    v_mfma_f32_32x32x16_bf16 v[112:127], v[196:199], v[36:39], v[112:127]
    v_exp_f32 v136, v136
    v_exp_f32 v137, v137
    v_cvt_pk_bf16_f32 v155, v134, v135
    v_exp_f32 v138, v138
    v_exp_f32 v139, v139
    v_cvt_pk_bf16_f32 v156, v136, v137
    s_waitcnt vmcnt(12)
    v_mfma_f32_32x32x16_bf16 v[48:63], v[204:207], v[148:151], v[48:63]
    v_exp_f32 v140, v140
    v_exp_f32 v141, v141
    v_cvt_pk_bf16_f32 v157, v138, v139
    v_exp_f32 v142, v142
    v_exp_f32 v143, v143
    v_cvt_pk_bf16_f32 v158, v140, v141
    v_cvt_pk_bf16_f32 v159, v142, v143
    v_mfma_f32_32x32x16_bf16 v[128:143], v[192:195], v[40:43], 0
    v_exp_f32 v112, v112
    v_exp_f32 v113, v113
    v_exp_f32 v114, v114
    v_exp_f32 v115, v115
    v_cvt_pk_bf16_f32 v144, v112, v113
    v_mfma_f32_32x32x16_bf16 v[64:79], v[200:203], v[152:155], v[64:79]
    v_exp_f32 v116, v116
    v_exp_f32 v117, v117
    v_cvt_pk_bf16_f32 v145, v114, v115
    v_exp_f32 v118, v118
    v_exp_f32 v119, v119
    v_cvt_pk_bf16_f32 v146, v116, v117
    v_mfma_f32_32x32x16_bf16 v[128:143], v[196:199], v[44:47], v[128:143]
    v_exp_f32 v120, v120
    v_exp_f32 v121, v121
    v_cvt_pk_bf16_f32 v147, v118, v119
    v_exp_f32 v122, v122
    v_exp_f32 v123, v123
    v_cvt_pk_bf16_f32 v148, v120, v121
    v_mfma_f32_32x32x16_bf16 v[64:79], v[204:207], v[156:159], v[64:79]
    v_exp_f32 v124, v124
    v_exp_f32 v125, v125
    v_cvt_pk_bf16_f32 v149, v122, v123
    v_exp_f32 v126, v126
    v_exp_f32 v127, v127
    v_cvt_pk_bf16_f32 v150, v124, v125
    v_cvt_pk_bf16_f32 v151, v126, v127
    s_waitcnt vmcnt(11)
    v_mfma_f32_32x32x16_bf16 v[112:127], v[208:211], v[16:19], 0
    v_exp_f32 v128, v128
    v_exp_f32 v129, v129
    v_exp_f32 v130, v130
    v_exp_f32 v131, v131
    v_cvt_pk_bf16_f32 v152, v128, v129
    v_mfma_f32_32x32x16_bf16 v[80:95], v[200:203], v[144:147], v[80:95]
    v_exp_f32 v132, v132
    v_exp_f32 v133, v133
    v_cvt_pk_bf16_f32 v153, v130, v131
    v_exp_f32 v134, v134
    v_exp_f32 v135, v135
    v_cvt_pk_bf16_f32 v154, v132, v133
    s_waitcnt vmcnt(10)
    v_mfma_f32_32x32x16_bf16 v[112:127], v[212:215], v[20:23], v[112:127]
    v_exp_f32 v136, v136
    v_exp_f32 v137, v137
    v_cvt_pk_bf16_f32 v155, v134, v135
    v_exp_f32 v138, v138
    v_exp_f32 v139, v139
    v_cvt_pk_bf16_f32 v156, v136, v137
    v_mfma_f32_32x32x16_bf16 v[80:95], v[204:207], v[148:151], v[80:95]
    v_exp_f32 v140, v140
    v_exp_f32 v141, v141
    v_cvt_pk_bf16_f32 v157, v138, v139
    v_exp_f32 v142, v142
    v_exp_f32 v143, v143
    v_cvt_pk_bf16_f32 v158, v140, v141
    v_cvt_pk_bf16_f32 v159, v142, v143
    v_mfma_f32_32x32x16_bf16 v[128:143], v[208:211], v[24:27], 0
    v_exp_f32 v112, v112
    v_exp_f32 v113, v113
    v_exp_f32 v114, v114
    v_exp_f32 v115, v115
    v_cvt_pk_bf16_f32 v144, v112, v113
    v_mfma_f32_32x32x16_bf16 v[96:111], v[200:203], v[152:155], v[96:111]
    v_exp_f32 v116, v116
    v_exp_f32 v117, v117
    v_cvt_pk_bf16_f32 v145, v114, v115
    v_exp_f32 v118, v118
    v_exp_f32 v119, v119
    v_cvt_pk_bf16_f32 v146, v116, v117
    v_mfma_f32_32x32x16_bf16 v[128:143], v[212:215], v[28:31], v[128:143]
    buffer_load_dwordx4 v[192:195], v1, s[24:27], s44 offen offset:0
    v_exp_f32 v120, v120
    v_exp_f32 v121, v121
    v_cvt_pk_bf16_f32 v147, v118, v119
    v_exp_f32 v122, v122
    v_exp_f32 v123, v123
    v_cvt_pk_bf16_f32 v148, v120, v121
    v_mfma_f32_32x32x16_bf16 v[96:111], v[204:207], v[156:159], v[96:111]
    buffer_load_dwordx4 v[196:199], v1, s[24:27], s44 offen offset:1024
    v_exp_f32 v124, v124
    v_exp_f32 v125, v125
    v_cvt_pk_bf16_f32 v149, v122, v123
    v_exp_f32 v126, v126
    v_exp_f32 v127, v127
    v_cvt_pk_bf16_f32 v150, v124, v125
    v_cvt_pk_bf16_f32 v151, v126, v127
    v_mfma_f32_32x32x16_bf16 v[112:127], v[208:211], v[32:35], 0
    buffer_load_dwordx4 v[200:203], v1, s[24:27], s44 offen offset:2048
    v_exp_f32 v128, v128
    v_exp_f32 v129, v129
    v_exp_f32 v130, v130
    v_exp_f32 v131, v131
    v_cvt_pk_bf16_f32 v152, v128, v129
    s_waitcnt vmcnt(12)
    v_mfma_f32_32x32x16_bf16 v[48:63], v[216:219], v[144:147], v[48:63]
    buffer_load_dwordx4 v[204:207], v1, s[24:27], s44 offen offset:3072
    s_add_u32 s44, s44, 4096
    v_exp_f32 v132, v132
    v_exp_f32 v133, v133
    v_cvt_pk_bf16_f32 v153, v130, v131
    v_exp_f32 v134, v134
    v_exp_f32 v135, v135
    v_cvt_pk_bf16_f32 v154, v132, v133
    v_mfma_f32_32x32x16_bf16 v[112:127], v[212:215], v[36:39], v[112:127]
    v_exp_f32 v136, v136
    v_exp_f32 v137, v137
    v_cvt_pk_bf16_f32 v155, v134, v135
    v_exp_f32 v138, v138
    v_exp_f32 v139, v139
    v_cvt_pk_bf16_f32 v156, v136, v137
    s_waitcnt vmcnt(12)
    v_mfma_f32_32x32x16_bf16 v[48:63], v[220:223], v[148:151], v[48:63]
    v_exp_f32 v140, v140
    v_exp_f32 v141, v141
    v_cvt_pk_bf16_f32 v157, v138, v139
    v_exp_f32 v142, v142
    v_exp_f32 v143, v143
    v_cvt_pk_bf16_f32 v158, v140, v141
    v_cvt_pk_bf16_f32 v159, v142, v143
    v_mfma_f32_32x32x16_bf16 v[128:143], v[208:211], v[40:43], 0
    v_exp_f32 v112, v112
    v_exp_f32 v113, v113
    v_exp_f32 v114, v114
    v_exp_f32 v115, v115
    v_cvt_pk_bf16_f32 v144, v112, v113
    v_mfma_f32_32x32x16_bf16 v[64:79], v[216:219], v[152:155], v[64:79]
    v_exp_f32 v116, v116
    v_exp_f32 v117, v117
    v_cvt_pk_bf16_f32 v145, v114, v115
    v_exp_f32 v118, v118
    v_exp_f32 v119, v119
    v_cvt_pk_bf16_f32 v146, v116, v117
    v_mfma_f32_32x32x16_bf16 v[128:143], v[212:215], v[44:47], v[128:143]
    v_exp_f32 v120, v120
    v_exp_f32 v121, v121
    v_cvt_pk_bf16_f32 v147, v118, v119
    v_exp_f32 v122, v122
    v_exp_f32 v123, v123
    v_cvt_pk_bf16_f32 v148, v120, v121
    v_mfma_f32_32x32x16_bf16 v[64:79], v[220:223], v[156:159], v[64:79]
    v_exp_f32 v124, v124
    v_exp_f32 v125, v125
    v_cvt_pk_bf16_f32 v149, v122, v123
    v_exp_f32 v126, v126
    v_exp_f32 v127, v127
    v_cvt_pk_bf16_f32 v150, v124, v125
    v_cvt_pk_bf16_f32 v151, v126, v127
    s_waitcnt vmcnt(11)
    v_mfma_f32_32x32x16_bf16 v[112:127], v[160:163], v[16:19], 0
    v_exp_f32 v128, v128
    v_exp_f32 v129, v129
    v_exp_f32 v130, v130
    v_exp_f32 v131, v131
    v_cvt_pk_bf16_f32 v152, v128, v129
    v_mfma_f32_32x32x16_bf16 v[80:95], v[216:219], v[144:147], v[80:95]
    v_exp_f32 v132, v132
    v_exp_f32 v133, v133
    v_cvt_pk_bf16_f32 v153, v130, v131
    v_exp_f32 v134, v134
    v_exp_f32 v135, v135
    v_cvt_pk_bf16_f32 v154, v132, v133
    s_waitcnt vmcnt(10)
    v_mfma_f32_32x32x16_bf16 v[112:127], v[164:167], v[20:23], v[112:127]
    v_exp_f32 v136, v136
    v_exp_f32 v137, v137
    v_cvt_pk_bf16_f32 v155, v134, v135
    v_exp_f32 v138, v138
    v_exp_f32 v139, v139
    v_cvt_pk_bf16_f32 v156, v136, v137
    v_mfma_f32_32x32x16_bf16 v[80:95], v[220:223], v[148:151], v[80:95]
    v_exp_f32 v140, v140
    v_exp_f32 v141, v141
    v_cvt_pk_bf16_f32 v157, v138, v139
    v_exp_f32 v142, v142
    v_exp_f32 v143, v143
    v_cvt_pk_bf16_f32 v158, v140, v141
    v_cvt_pk_bf16_f32 v159, v142, v143
    s_sub_u32 s46, s46, 1
    s_cmp_lg_u32 s46, 0
    s_cbranch_scc1 A_LOOP
    v_mfma_f32_32x32x16_bf16 v[128:143], v[160:163], v[24:27], 0
    v_exp_f32 v112, v112
    v_exp_f32 v113, v113
    v_exp_f32 v114, v114
    v_exp_f32 v115, v115
    v_cvt_pk_bf16_f32 v144, v112, v113
    v_mfma_f32_32x32x16_bf16 v[96:111], v[216:219], v[152:155], v[96:111]
    v_exp_f32 v116, v116
    v_exp_f32 v117, v117
    v_cvt_pk_bf16_f32 v145, v114, v115
    v_exp_f32 v118, v118
    v_exp_f32 v119, v119
    v_cvt_pk_bf16_f32 v146, v116, v117
    v_mfma_f32_32x32x16_bf16 v[128:143], v[164:167], v[28:31], v[128:143]
    buffer_load_dwordx4 v[208:211], v1, s[24:27], s44 offen offset:0
    v_exp_f32 v120, v120
    v_exp_f32 v121, v121
    v_cvt_pk_bf16_f32 v147, v118, v119
    v_exp_f32 v122, v122
    v_exp_f32 v123, v123
    v_cvt_pk_bf16_f32 v148, v120, v121
    v_mfma_f32_32x32x16_bf16 v[96:111], v[220:223], v[156:159], v[96:111]
    buffer_load_dwordx4 v[212:215], v1, s[24:27], s44 offen offset:1024
    v_exp_f32 v124, v124
    v_exp_f32 v125, v125
    v_cvt_pk_bf16_f32 v149, v122, v123
    v_exp_f32 v126, v126
    v_exp_f32 v127, v127
    v_cvt_pk_bf16_f32 v150, v124, v125
    v_cvt_pk_bf16_f32 v151, v126, v127
    v_mfma_f32_32x32x16_bf16 v[112:127], v[160:163], v[32:35], 0
    buffer_load_dwordx4 v[216:219], v1, s[24:27], s44 offen offset:2048
    v_exp_f32 v128, v128
    v_exp_f32 v129, v129
    v_exp_f32 v130, v130
    v_exp_f32 v131, v131
    v_cvt_pk_bf16_f32 v152, v128, v129
    s_waitcnt vmcnt(12)
    v_mfma_f32_32x32x16_bf16 v[48:63], v[168:171], v[144:147], v[48:63]
    buffer_load_dwordx4 v[220:223], v1, s[24:27], s44 offen offset:3072
    s_add_u32 s44, s44, 4096
    v_exp_f32 v132, v132
    v_exp_f32 v133, v133
    v_cvt_pk_bf16_f32 v153, v130, v131
    v_exp_f32 v134, v134
    v_exp_f32 v135, v135
    v_cvt_pk_bf16_f32 v154, v132, v133
    v_mfma_f32_32x32x16_bf16 v[112:127], v[164:167], v[36:39], v[112:127]
    v_exp_f32 v136, v136
    v_exp_f32 v137, v137
    v_cvt_pk_bf16_f32 v155, v134, v135
    v_exp_f32 v138, v138
    v_exp_f32 v139, v139
    v_cvt_pk_bf16_f32 v156, v136, v137
    s_waitcnt vmcnt(12)
    v_mfma_f32_32x32x16_bf16 v[48:63], v[172:175], v[148:151], v[48:63]
    v_exp_f32 v140, v140
    v_exp_f32 v141, v141
    v_cvt_pk_bf16_f32 v157, v138, v139
    v_exp_f32 v142, v142
    v_exp_f32 v143, v143
    v_cvt_pk_bf16_f32 v158, v140, v141
    v_cvt_pk_bf16_f32 v159, v142, v143
    v_mfma_f32_32x32x16_bf16 v[128:143], v[160:163], v[40:43], 0
    v_exp_f32 v112, v112
    v_exp_f32 v113, v113
    v_exp_f32 v114, v114
    v_exp_f32 v115, v115
    v_cvt_pk_bf16_f32 v144, v112, v113
    v_mfma_f32_32x32x16_bf16 v[64:79], v[168:171], v[152:155], v[64:79]
    v_exp_f32 v116, v116
    v_exp_f32 v117, v117
    v_cvt_pk_bf16_f32 v145, v114, v115
    v_exp_f32 v118, v118
    v_exp_f32 v119, v119
    v_cvt_pk_bf16_f32 v146, v116, v117
    v_mfma_f32_32x32x16_bf16 v[128:143], v[164:167], v[44:47], v[128:143]
    v_exp_f32 v120, v120
    v_exp_f32 v121, v121
    v_cvt_pk_bf16_f32 v147, v118, v119
    v_exp_f32 v122, v122
    v_exp_f32 v123, v123
    v_cvt_pk_bf16_f32 v148, v120, v121
    v_mfma_f32_32x32x16_bf16 v[64:79], v[172:175], v[156:159], v[64:79]
    v_exp_f32 v124, v124
    v_exp_f32 v125, v125
    v_cvt_pk_bf16_f32 v149, v122, v123
    v_exp_f32 v126, v126
    v_exp_f32 v127, v127
    v_cvt_pk_bf16_f32 v150, v124, v125
    v_cvt_pk_bf16_f32 v151, v126, v127
    s_waitcnt vmcnt(11)
    v_mfma_f32_32x32x16_bf16 v[112:127], v[176:179], v[16:19], 0
    v_exp_f32 v128, v128
    v_exp_f32 v129, v129
    v_exp_f32 v130, v130
    v_exp_f32 v131, v131
    v_cvt_pk_bf16_f32 v152, v128, v129
    v_mfma_f32_32x32x16_bf16 v[80:95], v[168:171], v[144:147], v[80:95]
    v_exp_f32 v132, v132
    v_exp_f32 v133, v133
    v_cvt_pk_bf16_f32 v153, v130, v131
    v_exp_f32 v134, v134
    v_exp_f32 v135, v135
    v_cvt_pk_bf16_f32 v154, v132, v133
    s_waitcnt vmcnt(10)
    v_mfma_f32_32x32x16_bf16 v[112:127], v[180:183], v[20:23], v[112:127]
    v_exp_f32 v136, v136
    v_exp_f32 v137, v137
    v_cvt_pk_bf16_f32 v155, v134, v135
    v_exp_f32 v138, v138
    v_exp_f32 v139, v139
    v_cvt_pk_bf16_f32 v156, v136, v137
    v_mfma_f32_32x32x16_bf16 v[80:95], v[172:175], v[148:151], v[80:95]
    v_exp_f32 v140, v140
    v_exp_f32 v141, v141
    v_cvt_pk_bf16_f32 v157, v138, v139
    v_exp_f32 v142, v142
    v_exp_f32 v143, v143
    v_cvt_pk_bf16_f32 v158, v140, v141
    v_cvt_pk_bf16_f32 v159, v142, v143
    v_mfma_f32_32x32x16_bf16 v[128:143], v[176:179], v[24:27], 0
    v_exp_f32 v112, v112
    v_exp_f32 v113, v113
    v_exp_f32 v114, v114
    v_exp_f32 v115, v115
    v_cvt_pk_bf16_f32 v144, v112, v113
    v_mfma_f32_32x32x16_bf16 v[96:111], v[168:171], v[152:155], v[96:111]
    v_exp_f32 v116, v116
    v_exp_f32 v117, v117
    v_cvt_pk_bf16_f32 v145, v114, v115
    v_exp_f32 v118, v118
    v_exp_f32 v119, v119
    v_cvt_pk_bf16_f32 v146, v116, v117
    v_mfma_f32_32x32x16_bf16 v[128:143], v[180:183], v[28:31], v[128:143]
    v_exp_f32 v120, v120
    v_exp_f32 v121, v121
    v_cvt_pk_bf16_f32 v147, v118, v119
    v_exp_f32 v122, v122
    v_exp_f32 v123, v123
    v_cvt_pk_bf16_f32 v148, v120, v121
    v_mfma_f32_32x32x16_bf16 v[96:111], v[172:175], v[156:159], v[96:111]
    v_exp_f32 v124, v124
    v_exp_f32 v125, v125
    v_cvt_pk_bf16_f32 v149, v122, v123
    v_exp_f32 v126, v126
    v_exp_f32 v127, v127
    v_cvt_pk_bf16_f32 v150, v124, v125
    v_cvt_pk_bf16_f32 v151, v126, v127
    v_mfma_f32_32x32x16_bf16 v[112:127], v[176:179], v[32:35], 0
    v_exp_f32 v128, v128
    v_exp_f32 v129, v129
    v_exp_f32 v130, v130
    v_exp_f32 v131, v131
    v_cvt_pk_bf16_f32 v152, v128, v129
    s_waitcnt vmcnt(9)
    v_mfma_f32_32x32x16_bf16 v[48:63], v[184:187], v[144:147], v[48:63]
    v_exp_f32 v132, v132
    v_exp_f32 v133, v133
    v_cvt_pk_bf16_f32 v153, v130, v131
    v_exp_f32 v134, v134
    v_exp_f32 v135, v135
    v_cvt_pk_bf16_f32 v154, v132, v133
    v_mfma_f32_32x32x16_bf16 v[112:127], v[180:183], v[36:39], v[112:127]
    v_exp_f32 v136, v136
    v_exp_f32 v137, v137
    v_cvt_pk_bf16_f32 v155, v134, v135
    v_exp_f32 v138, v138
    v_exp_f32 v139, v139
    v_cvt_pk_bf16_f32 v156, v136, v137
    s_waitcnt vmcnt(8)
    v_mfma_f32_32x32x16_bf16 v[48:63], v[188:191], v[148:151], v[48:63]
    v_exp_f32 v140, v140
    v_exp_f32 v141, v141
    v_cvt_pk_bf16_f32 v157, v138, v139
    v_exp_f32 v142, v142
    v_exp_f32 v143, v143
    v_cvt_pk_bf16_f32 v158, v140, v141
    v_cvt_pk_bf16_f32 v159, v142, v143
    v_mfma_f32_32x32x16_bf16 v[128:143], v[176:179], v[40:43], 0
    v_exp_f32 v112, v112
    v_exp_f32 v113, v113
    v_exp_f32 v114, v114
    v_exp_f32 v115, v115
    v_cvt_pk_bf16_f32 v144, v112, v113
    v_mfma_f32_32x32x16_bf16 v[64:79], v[184:187], v[152:155], v[64:79]
    v_exp_f32 v116, v116
    v_exp_f32 v117, v117
    v_cvt_pk_bf16_f32 v145, v114, v115
    v_exp_f32 v118, v118
    v_exp_f32 v119, v119
    v_cvt_pk_bf16_f32 v146, v116, v117
    v_mfma_f32_32x32x16_bf16 v[128:143], v[180:183], v[44:47], v[128:143]
    v_exp_f32 v120, v120
    v_exp_f32 v121, v121
    v_cvt_pk_bf16_f32 v147, v118, v119
    v_exp_f32 v122, v122
    v_exp_f32 v123, v123
    v_cvt_pk_bf16_f32 v148, v120, v121
    v_mfma_f32_32x32x16_bf16 v[64:79], v[188:191], v[156:159], v[64:79]
    v_exp_f32 v124, v124
    v_exp_f32 v125, v125
    v_cvt_pk_bf16_f32 v149, v122, v123
    v_exp_f32 v126, v126
    v_exp_f32 v127, v127
    v_cvt_pk_bf16_f32 v150, v124, v125
    v_cvt_pk_bf16_f32 v151, v126, v127
    s_waitcnt vmcnt(7)
    v_mfma_f32_32x32x16_bf16 v[112:127], v[192:195], v[16:19], 0
    v_exp_f32 v128, v128
    v_exp_f32 v129, v129
    v_exp_f32 v130, v130
    v_exp_f32 v131, v131
    v_cvt_pk_bf16_f32 v152, v128, v129
    v_mfma_f32_32x32x16_bf16 v[80:95], v[184:187], v[144:147], v[80:95]
    v_exp_f32 v132, v132
    v_exp_f32 v133, v133
    v_cvt_pk_bf16_f32 v153, v130, v131
    v_exp_f32 v134, v134
    v_exp_f32 v135, v135
    v_cvt_pk_bf16_f32 v154, v132, v133
    s_waitcnt vmcnt(6)
    v_mfma_f32_32x32x16_bf16 v[112:127], v[196:199], v[20:23], v[112:127]
    v_exp_f32 v136, v136
    v_exp_f32 v137, v137
    v_cvt_pk_bf16_f32 v155, v134, v135
    v_exp_f32 v138, v138
    v_exp_f32 v139, v139
    v_cvt_pk_bf16_f32 v156, v136, v137
    v_mfma_f32_32x32x16_bf16 v[80:95], v[188:191], v[148:151], v[80:95]
    v_exp_f32 v140, v140
    v_exp_f32 v141, v141
    v_cvt_pk_bf16_f32 v157, v138, v139
    v_exp_f32 v142, v142
    v_exp_f32 v143, v143
    v_cvt_pk_bf16_f32 v158, v140, v141
    v_cvt_pk_bf16_f32 v159, v142, v143
    v_mfma_f32_32x32x16_bf16 v[128:143], v[192:195], v[24:27], 0
    v_exp_f32 v112, v112
    v_exp_f32 v113, v113
    v_exp_f32 v114, v114
    v_exp_f32 v115, v115
    v_cvt_pk_bf16_f32 v144, v112, v113
    v_mfma_f32_32x32x16_bf16 v[96:111], v[184:187], v[152:155], v[96:111]
    v_exp_f32 v116, v116
    v_exp_f32 v117, v117
    v_cvt_pk_bf16_f32 v145, v114, v115
    v_exp_f32 v118, v118
    v_exp_f32 v119, v119
    v_cvt_pk_bf16_f32 v146, v116, v117
    v_mfma_f32_32x32x16_bf16 v[128:143], v[196:199], v[28:31], v[128:143]
    v_exp_f32 v120, v120
    v_exp_f32 v121, v121
    v_cvt_pk_bf16_f32 v147, v118, v119
    v_exp_f32 v122, v122
    v_exp_f32 v123, v123
    v_cvt_pk_bf16_f32 v148, v120, v121
    v_mfma_f32_32x32x16_bf16 v[96:111], v[188:191], v[156:159], v[96:111]
    v_exp_f32 v124, v124
    v_exp_f32 v125, v125
    v_cvt_pk_bf16_f32 v149, v122, v123
    v_exp_f32 v126, v126
    v_exp_f32 v127, v127
    v_cvt_pk_bf16_f32 v150, v124, v125
    v_cvt_pk_bf16_f32 v151, v126, v127
    v_mfma_f32_32x32x16_bf16 v[112:127], v[192:195], v[32:35], 0
    v_exp_f32 v128, v128
    v_exp_f32 v129, v129
    v_exp_f32 v130, v130
    v_exp_f32 v131, v131
    v_cvt_pk_bf16_f32 v152, v128, v129
    s_waitcnt vmcnt(5)
    v_mfma_f32_32x32x16_bf16 v[48:63], v[200:203], v[144:147], v[48:63]
    v_exp_f32 v132, v132
    v_exp_f32 v133, v133
    v_cvt_pk_bf16_f32 v153, v130, v131
    v_exp_f32 v134, v134
    v_exp_f32 v135, v135
    v_cvt_pk_bf16_f32 v154, v132, v133
    v_mfma_f32_32x32x16_bf16 v[112:127], v[196:199], v[36:39], v[112:127]
    v_exp_f32 v136, v136
    v_exp_f32 v137, v137
    v_cvt_pk_bf16_f32 v155, v134, v135
    v_exp_f32 v138, v138
    v_exp_f32 v139, v139
    v_cvt_pk_bf16_f32 v156, v136, v137
    s_waitcnt vmcnt(4)
    v_mfma_f32_32x32x16_bf16 v[48:63], v[204:207], v[148:151], v[48:63]
    v_exp_f32 v140, v140
    v_exp_f32 v141, v141
    v_cvt_pk_bf16_f32 v157, v138, v139
    v_exp_f32 v142, v142
    v_exp_f32 v143, v143
    v_cvt_pk_bf16_f32 v158, v140, v141
    v_cvt_pk_bf16_f32 v159, v142, v143
    v_mfma_f32_32x32x16_bf16 v[128:143], v[192:195], v[40:43], 0
    v_exp_f32 v112, v112
    v_exp_f32 v113, v113
    v_exp_f32 v114, v114
    v_exp_f32 v115, v115
    v_cvt_pk_bf16_f32 v144, v112, v113
    v_mfma_f32_32x32x16_bf16 v[64:79], v[200:203], v[152:155], v[64:79]
    v_exp_f32 v116, v116
    v_exp_f32 v117, v117
    v_cvt_pk_bf16_f32 v145, v114, v115
    v_exp_f32 v118, v118
    v_exp_f32 v119, v119
    v_cvt_pk_bf16_f32 v146, v116, v117
    v_mfma_f32_32x32x16_bf16 v[128:143], v[196:199], v[44:47], v[128:143]
    v_exp_f32 v120, v120
    v_exp_f32 v121, v121
    v_cvt_pk_bf16_f32 v147, v118, v119
    v_exp_f32 v122, v122
    v_exp_f32 v123, v123
    v_cvt_pk_bf16_f32 v148, v120, v121
    v_mfma_f32_32x32x16_bf16 v[64:79], v[204:207], v[156:159], v[64:79]
    v_exp_f32 v124, v124
    v_exp_f32 v125, v125
    v_cvt_pk_bf16_f32 v149, v122, v123
    v_exp_f32 v126, v126
    v_exp_f32 v127, v127
    v_cvt_pk_bf16_f32 v150, v124, v125
    v_cvt_pk_bf16_f32 v151, v126, v127
    s_waitcnt vmcnt(3)
    v_mfma_f32_32x32x16_bf16 v[112:127], v[208:211], v[16:19], 0
    v_exp_f32 v128, v128
    v_exp_f32 v129, v129
    v_exp_f32 v130, v130
    v_exp_f32 v131, v131
    v_cvt_pk_bf16_f32 v152, v128, v129
    v_mfma_f32_32x32x16_bf16 v[80:95], v[200:203], v[144:147], v[80:95]
    v_exp_f32 v132, v132
    v_exp_f32 v133, v133
    v_cvt_pk_bf16_f32 v153, v130, v131
    v_exp_f32 v134, v134
    v_exp_f32 v135, v135
    v_cvt_pk_bf16_f32 v154, v132, v133
    s_waitcnt vmcnt(2)
    v_mfma_f32_32x32x16_bf16 v[112:127], v[212:215], v[20:23], v[112:127]
    v_exp_f32 v136, v136
    v_exp_f32 v137, v137
    v_cvt_pk_bf16_f32 v155, v134, v135
    v_exp_f32 v138, v138
    v_exp_f32 v139, v139
    v_cvt_pk_bf16_f32 v156, v136, v137
    v_mfma_f32_32x32x16_bf16 v[80:95], v[204:207], v[148:151], v[80:95]
    v_exp_f32 v140, v140
    v_exp_f32 v141, v141
    v_cvt_pk_bf16_f32 v157, v138, v139
    v_exp_f32 v142, v142
    v_exp_f32 v143, v143
    v_cvt_pk_bf16_f32 v158, v140, v141
    v_cvt_pk_bf16_f32 v159, v142, v143
    v_mfma_f32_32x32x16_bf16 v[128:143], v[208:211], v[24:27], 0
    v_exp_f32 v112, v112
    v_exp_f32 v113, v113
    v_exp_f32 v114, v114
    v_exp_f32 v115, v115
    v_cvt_pk_bf16_f32 v144, v112, v113
    v_mfma_f32_32x32x16_bf16 v[96:111], v[200:203], v[152:155], v[96:111]
    v_exp_f32 v116, v116
    v_exp_f32 v117, v117
    v_cvt_pk_bf16_f32 v145, v114, v115
    v_exp_f32 v118, v118
    v_exp_f32 v119, v119
    v_cvt_pk_bf16_f32 v146, v116, v117
    v_mfma_f32_32x32x16_bf16 v[128:143], v[212:215], v[28:31], v[128:143]
    v_exp_f32 v120, v120
    v_exp_f32 v121, v121
    v_cvt_pk_bf16_f32 v147, v118, v119
    v_exp_f32 v122, v122
    v_exp_f32 v123, v123
    v_cvt_pk_bf16_f32 v148, v120, v121
    v_mfma_f32_32x32x16_bf16 v[96:111], v[204:207], v[156:159], v[96:111]
    v_exp_f32 v124, v124
    v_exp_f32 v125, v125
    v_cvt_pk_bf16_f32 v149, v122, v123
    v_exp_f32 v126, v126
    v_exp_f32 v127, v127
    v_cvt_pk_bf16_f32 v150, v124, v125
    v_cvt_pk_bf16_f32 v151, v126, v127
    v_mfma_f32_32x32x16_bf16 v[112:127], v[208:211], v[32:35], 0
    v_exp_f32 v128, v128
    v_exp_f32 v129, v129
    v_exp_f32 v130, v130
    v_exp_f32 v131, v131
    v_cvt_pk_bf16_f32 v152, v128, v129
    s_waitcnt vmcnt(1)
    v_mfma_f32_32x32x16_bf16 v[48:63], v[216:219], v[144:147], v[48:63]
    v_exp_f32 v132, v132
    v_exp_f32 v133, v133
    v_cvt_pk_bf16_f32 v153, v130, v131
    v_exp_f32 v134, v134
    v_exp_f32 v135, v135
    v_cvt_pk_bf16_f32 v154, v132, v133
    v_mfma_f32_32x32x16_bf16 v[112:127], v[212:215], v[36:39], v[112:127]
    v_exp_f32 v136, v136
    v_exp_f32 v137, v137
    v_cvt_pk_bf16_f32 v155, v134, v135
    v_exp_f32 v138, v138
    v_exp_f32 v139, v139
    v_cvt_pk_bf16_f32 v156, v136, v137
    s_waitcnt vmcnt(0)
    v_mfma_f32_32x32x16_bf16 v[48:63], v[220:223], v[148:151], v[48:63]
    v_exp_f32 v140, v140
    v_exp_f32 v141, v141
    v_cvt_pk_bf16_f32 v157, v138, v139
    v_exp_f32 v142, v142
    v_exp_f32 v143, v143
    v_cvt_pk_bf16_f32 v158, v140, v141
    v_cvt_pk_bf16_f32 v159, v142, v143
    v_mfma_f32_32x32x16_bf16 v[128:143], v[208:211], v[40:43], 0
    v_exp_f32 v112, v112
    v_exp_f32 v113, v113
    v_exp_f32 v114, v114
    v_exp_f32 v115, v115
    v_cvt_pk_bf16_f32 v144, v112, v113
    v_mfma_f32_32x32x16_bf16 v[64:79], v[216:219], v[152:155], v[64:79]
    v_exp_f32 v116, v116
    v_exp_f32 v117, v117
    v_cvt_pk_bf16_f32 v145, v114, v115
    v_exp_f32 v118, v118
    v_exp_f32 v119, v119
    v_cvt_pk_bf16_f32 v146, v116, v117
    v_mfma_f32_32x32x16_bf16 v[128:143], v[212:215], v[44:47], v[128:143]
    v_exp_f32 v120, v120
    v_exp_f32 v121, v121
    v_cvt_pk_bf16_f32 v147, v118, v119
    v_exp_f32 v122, v122
    v_exp_f32 v123, v123
    v_cvt_pk_bf16_f32 v148, v120, v121
    v_mfma_f32_32x32x16_bf16 v[64:79], v[220:223], v[156:159], v[64:79]
    v_exp_f32 v124, v124
    v_exp_f32 v125, v125
    v_cvt_pk_bf16_f32 v149, v122, v123
    v_exp_f32 v126, v126
    v_exp_f32 v127, v127
    v_cvt_pk_bf16_f32 v150, v124, v125
    v_cvt_pk_bf16_f32 v151, v126, v127
    v_mfma_f32_32x32x16_bf16 v[112:127], v[160:163], v[16:19], 0
    v_exp_f32 v128, v128
    v_exp_f32 v129, v129
    v_exp_f32 v130, v130
    v_exp_f32 v131, v131
    v_cvt_pk_bf16_f32 v152, v128, v129
    v_mfma_f32_32x32x16_bf16 v[80:95], v[216:219], v[144:147], v[80:95]
    v_exp_f32 v132, v132
    v_exp_f32 v133, v133
    v_cvt_pk_bf16_f32 v153, v130, v131
    v_exp_f32 v134, v134
    v_exp_f32 v135, v135
    v_cvt_pk_bf16_f32 v154, v132, v133
    v_mfma_f32_32x32x16_bf16 v[112:127], v[164:167], v[20:23], v[112:127]
    v_exp_f32 v136, v136
    v_exp_f32 v137, v137
    v_cvt_pk_bf16_f32 v155, v134, v135
    v_exp_f32 v138, v138
    v_exp_f32 v139, v139
    v_cvt_pk_bf16_f32 v156, v136, v137
    v_mfma_f32_32x32x16_bf16 v[80:95], v[220:223], v[148:151], v[80:95]
    v_exp_f32 v140, v140
    v_exp_f32 v141, v141
    v_cvt_pk_bf16_f32 v157, v138, v139
    v_exp_f32 v142, v142
    v_exp_f32 v143, v143
    v_cvt_pk_bf16_f32 v158, v140, v141
    v_cvt_pk_bf16_f32 v159, v142, v143
    v_mfma_f32_32x32x16_bf16 v[96:111], v[216:219], v[152:155], v[96:111]
    s_nop 0
    v_mfma_f32_32x32x16_bf16 v[96:111], v[220:223], v[156:159], v[96:111]
    s_mov_b32 s50, 0x67800000
    s_mov_b64 s[52:53], 0
    v_cmp_ngt_f32 vcc, s50, v60
    s_nop 0
    s_or_b64 s[52:53], s[52:53], vcc
    v_cmp_ngt_f32 vcc, s50, v76
    s_nop 0
    s_or_b64 s[52:53], s[52:53], vcc
    v_cmp_ngt_f32 vcc, s50, v92
    s_nop 0
    s_or_b64 s[52:53], s[52:53], vcc
    s_nop 0
    v_cmp_ngt_f32 vcc, s50, v108
    s_nop 0
    s_or_b64 s[52:53], s[52:53], vcc
    s_cmp_eq_u32 s53, 0
    s_cbranch_scc1 A_OK
    s_cmp_eq_u32 s42, 16
    s_cbranch_scc1 A_OK
    s_mov_b32 s42, 16
    s_mov_b32 s43, 0
    s_mov_b64 exec, s[48:49]
    v_mov_b32 v22, 0
    v_mov_b32 v30, 0
    v_mov_b32 v38, 0
    v_mov_b32 v46, 0
    s_mov_b64 exec, -1
    s_branch A_RETRY
A_OK:
    s_mul_i32 s40, s16, 12288
    s_add_u32 s40, s40, 98304
    v_add_u32 v2, s40, v1
    ds_write_b128 v2, v[64:67] offset:0
    ds_write_b128 v2, v[68:71] offset:1024
    ds_write_b128 v2, v[72:75] offset:2048
    ds_write_b128 v2, v[76:79] offset:3072
    ds_write_b128 v2, v[80:83] offset:4096
    ds_write_b128 v2, v[84:87] offset:5120
    ds_write_b128 v2, v[88:91] offset:6144
    ds_write_b128 v2, v[92:95] offset:7168
    ds_write_b128 v2, v[96:99] offset:8192
    ds_write_b128 v2, v[100:103] offset:9216
    ds_write_b128 v2, v[104:107] offset:10240
    ds_write_b128 v2, v[108:111] offset:11264
    v_and_b32 v3, 31, v0
    v_lshlrev_b32 v3, 2, v3
    s_lshl_b32 s40, s16, 10
    s_add_u32 s40, s40, 147456
    v_add_u32 v4, s40, v3
    v_log_f32 v228, v60
    v_log_f32 v229, v76
    v_log_f32 v230, v92
    v_log_f32 v231, v108
    v_add_f32 v228, v228, v224
    v_add_f32 v229, v229, v225
    v_add_f32 v230, v230, v226
    v_add_f32 v231, v231, v227
    s_mov_b64 exec, s[48:49]
    ds_write_b32 v4, v224 offset:0
    ds_write_b32 v4, v228 offset:128
    ds_write_b32 v4, v225 offset:256
    ds_write_b32 v4, v229 offset:384
    ds_write_b32 v4, v226 offset:512
    ds_write_b32 v4, v230 offset:640
    ds_write_b32 v4, v227 offset:768
    ds_write_b32 v4, v231 offset:896
    s_mov_b64 exec, -1
    s_waitcnt lgkmcnt(0)
    v_mov_b32 v12, 151552
    v_mov_b32 v13, 1
    s_mov_b64 exec, 1
    ds_add_u32 v12, v13
    s_mov_b64 exec, -1
A_SYNC:
    ds_read_b32 v13, v12
    s_waitcnt lgkmcnt(0)
    v_readfirstlane_b32 s61, v13
    s_nop 0
    s_cmp_lt_u32 s61, 4
    s_cbranch_scc1 A_SYNC
    s_sub_u32 s40, s16, 0
    s_and_b32 s40, s40, 3
    s_lshl_b32 s41, s40, 10
    s_add_u32 s41, s41, 147456
    v_add_u32 v4, s41, v3
    ds_read_b32 v160, v4
    ds_read_b32 v164, v4 offset:128
    s_sub_u32 s40, s16, 1
    s_and_b32 s40, s40, 3
    s_lshl_b32 s41, s40, 10
    s_add_u32 s41, s41, 147712
    v_add_u32 v4, s41, v3
    ds_read_b32 v161, v4
    ds_read_b32 v165, v4 offset:128
    s_mul_i32 s41, s40, 12288
    s_add_u32 s41, s41, 98304
    v_add_u32 v2, s41, v1
    ds_read_b128 v[112:115], v2 offset:0
    ds_read_b128 v[116:119], v2 offset:1024
    ds_read_b128 v[120:123], v2 offset:2048
    ds_read_b128 v[124:127], v2 offset:3072
    s_sub_u32 s40, s16, 2
    s_and_b32 s40, s40, 3
    s_lshl_b32 s41, s40, 10
    s_add_u32 s41, s41, 147968
    v_add_u32 v4, s41, v3
    ds_read_b32 v162, v4
    ds_read_b32 v166, v4 offset:128
    s_mul_i32 s41, s40, 12288
    s_add_u32 s41, s41, 102400
    v_add_u32 v2, s41, v1
    ds_read_b128 v[128:131], v2 offset:0
    ds_read_b128 v[132:135], v2 offset:1024
    ds_read_b128 v[136:139], v2 offset:2048
    ds_read_b128 v[140:143], v2 offset:3072
    s_sub_u32 s40, s16, 3
    s_and_b32 s40, s40, 3
    s_lshl_b32 s41, s40, 10
    s_add_u32 s41, s41, 148224
    v_add_u32 v4, s41, v3
    ds_read_b32 v163, v4
    ds_read_b32 v167, v4 offset:128
    s_mul_i32 s41, s40, 12288
    s_add_u32 s41, s41, 106496
    v_add_u32 v2, s41, v1
    ds_read_b128 v[144:147], v2 offset:0
    ds_read_b128 v[148:151], v2 offset:1024
    ds_read_b128 v[152:155], v2 offset:2048
    ds_read_b128 v[156:159], v2 offset:3072
    s_waitcnt lgkmcnt(10)
    v_max3_f32 v228, v164, v165, v166
    s_waitcnt lgkmcnt(4)
    v_max_f32 v228, v228, v167
    v_sub_f32 v164, v164, v228
    v_sub_f32 v160, v160, v228
    v_sub_f32 v165, v165, v228
    v_sub_f32 v161, v161, v228
    v_sub_f32 v166, v166, v228
    v_sub_f32 v162, v162, v228
    v_sub_f32 v167, v167, v228
    v_sub_f32 v163, v163, v228
    v_exp_f32 v164, v164
    v_exp_f32 v160, v160
    v_exp_f32 v165, v165
    v_exp_f32 v161, v161
    v_exp_f32 v166, v166
    v_exp_f32 v162, v162
    v_exp_f32 v167, v167
    v_exp_f32 v163, v163
    v_add_f32 v164, v164, v165
    v_add_f32 v166, v166, v167
    v_add_f32 v164, v164, v166
    v_rcp_f32 v164, v164
    s_nop 0
    v_mul_f32 v160, v160, v164
    v_mul_f32 v161, v161, v164
    v_mul_f32 v162, v162, v164
    v_mul_f32 v163, v163, v164
    v_mul_f32 v48, v48, v160
    v_mul_f32 v49, v49, v160
    v_mul_f32 v50, v50, v160
    v_mul_f32 v51, v51, v160
    v_mul_f32 v52, v52, v160
    v_mul_f32 v53, v53, v160
    v_mul_f32 v54, v54, v160
    v_mul_f32 v55, v55, v160
    v_mul_f32 v56, v56, v160
    v_mul_f32 v57, v57, v160
    v_mul_f32 v58, v58, v160
    v_mul_f32 v59, v59, v160
    v_mul_f32 v60, v60, v160
    v_mul_f32 v61, v61, v160
    v_mul_f32 v62, v62, v160
    v_mul_f32 v63, v63, v160
    v_fmac_f32 v48, v112, v161
    v_fmac_f32 v49, v113, v161
    v_fmac_f32 v50, v114, v161
    v_fmac_f32 v51, v115, v161
    v_fmac_f32 v52, v116, v161
    v_fmac_f32 v53, v117, v161
    v_fmac_f32 v54, v118, v161
    v_fmac_f32 v55, v119, v161
    v_fmac_f32 v56, v120, v161
    v_fmac_f32 v57, v121, v161
    v_fmac_f32 v58, v122, v161
    v_fmac_f32 v59, v123, v161
    v_fmac_f32 v60, v124, v161
    v_fmac_f32 v61, v125, v161
    v_fmac_f32 v62, v126, v161
    v_fmac_f32 v63, v127, v161
    v_fmac_f32 v48, v128, v162
    v_fmac_f32 v49, v129, v162
    v_fmac_f32 v50, v130, v162
    v_fmac_f32 v51, v131, v162
    v_fmac_f32 v52, v132, v162
    v_fmac_f32 v53, v133, v162
    v_fmac_f32 v54, v134, v162
    v_fmac_f32 v55, v135, v162
    v_fmac_f32 v56, v136, v162
    v_fmac_f32 v57, v137, v162
    v_fmac_f32 v58, v138, v162
    v_fmac_f32 v59, v139, v162
    v_fmac_f32 v60, v140, v162
    v_fmac_f32 v61, v141, v162
    v_fmac_f32 v62, v142, v162
    v_fmac_f32 v63, v143, v162
    s_waitcnt lgkmcnt(3)
    v_fmac_f32 v48, v144, v163
    v_fmac_f32 v49, v145, v163
    v_fmac_f32 v50, v146, v163
    v_fmac_f32 v51, v147, v163
    s_waitcnt lgkmcnt(2)
    v_fmac_f32 v52, v148, v163
    v_fmac_f32 v53, v149, v163
    v_fmac_f32 v54, v150, v163
    v_fmac_f32 v55, v151, v163
    s_waitcnt lgkmcnt(1)
    v_fmac_f32 v56, v152, v163
    v_fmac_f32 v57, v153, v163
    v_fmac_f32 v58, v154, v163
    v_fmac_f32 v59, v155, v163
    s_waitcnt lgkmcnt(0)
    v_fmac_f32 v60, v156, v163
    v_fmac_f32 v61, v157, v163
    v_fmac_f32 v62, v158, v163
    v_fmac_f32 v63, v159, v163
    s_mov_b64 exec, s[48:49]
    v_mov_b32 v60, 0
    v_mov_b32 v61, 0
    v_mov_b32 v62, 0
    v_mov_b32 v63, 0
    s_mov_b64 exec, -1
    v_cvt_pk_bf16_f32 v112, v48, v49
    v_cvt_pk_bf16_f32 v113, v50, v51
    v_cvt_pk_bf16_f32 v114, v52, v53
    v_cvt_pk_bf16_f32 v115, v54, v55
    v_cvt_pk_bf16_f32 v116, v56, v57
    v_cvt_pk_bf16_f32 v117, v58, v59
    v_cvt_pk_bf16_f32 v118, v60, v61
    v_cvt_pk_bf16_f32 v119, v62, v63
    s_lshl_b32 s40, s18, 2
    s_add_u32 s40, s40, s16
    s_mul_i32 s40, s40, 90112
    s_lshl_b32 s41, s17, 11
    s_add_u32 s40, s40, s41
    s_add_u32 s40, s40, 14680064
    buffer_store_dwordx4 v[112:115], v1, s[24:27], s40 offen sc1
    buffer_store_dwordx4 v[116:119], v1, s[24:27], s40 offen offset:1024 sc1
    s_lshl_b32 s62, s18, 2
    s_add_u32 s62, s62, s16
    s_waitcnt vmcnt(0)
    v_readfirstlane_b32 s15, v14
    s_lshl_b32 s64, s62, 9
    s_lshl_b32 s65, s17, 4
    s_add_u32 s64, s64, s65
    s_add_u32 s64, s64, 24182784
    v_mov_b32 v12, s15
    v_mov_b32 v13, 0
    s_mov_b64 exec, 1
    buffer_store_dword v12, v13, s[24:27], s64 offen sc1
    s_mov_b64 exec, -1
    s_cmp_ge_u32 s21, 28
    s_cbranch_scc1 K2_AEXIT
    s_mov_b32 s88, s10
    s_mov_b32 s89, s11
    s_mov_b32 s90, 1835008
    s_mov_b32 s91, 0x00020000
    s_mov_b32 s92, s12
    s_mov_b32 s93, s13
    s_mov_b32 s94, 1835008
    s_mov_b32 s95, 0x00020000
    s_mul_i32 s72, s21, 37
    s_lshr_b32 s72, s72, 8
    s_mul_i32 s73, s72, 7
    s_sub_u32 s67, s21, s73
    s_lshl_b32 s73, s22, 2
    s_add_u32 s66, s73, s72
    s_mul_i32 s80, s72, 3
    s_add_u32 s80, s80, s67
    s_sub_u32 s81, s80, 11
    s_cmp_ge_u32 s80, 11
    s_cselect_b32 s80, s81, s80
    s_mul_i32 s72, s67, 180224
    s_add_u32 s68, s72, 20971520
    s_mul_i32 s72, s66, 180224
    s_add_u32 s69, s72, 14680064
    v_mov_b32 v12, 151556
K2_AWAIT:
    ds_read_b32 v13, v12
    s_waitcnt lgkmcnt(0)
    v_readfirstlane_b32 s61, v13
    s_nop 0
    s_cmp_lt_u32 s61, 4
    s_cbranch_scc1 K2_AWAIT
    s_mul_i32 s77, s23, 11
    s_lshl_b32 s72, s77, 10
    s_add_u32 s73, s68, s72
    s_mov_b32 s70, s73
    s_add_u32 s71, s70, 90112
    buffer_load_dwordx4 v[16:19], v1, s[24:27], s70 offen offset:0
    buffer_load_dwordx4 v[20:23], v1, s[24:27], s71 offen offset:0
    buffer_load_dwordx4 v[24:27], v1, s[24:27], s70 offen offset:1024
    buffer_load_dwordx4 v[28:31], v1, s[24:27], s71 offen offset:1024
    buffer_load_dwordx4 v[32:35], v1, s[24:27], s70 offen offset:2048
    buffer_load_dwordx4 v[36:39], v1, s[24:27], s71 offen offset:2048
    buffer_load_dwordx4 v[40:43], v1, s[24:27], s70 offen offset:3072
    buffer_load_dwordx4 v[44:47], v1, s[24:27], s71 offen offset:3072
    s_add_u32 s70, s70, 4096
    s_add_u32 s71, s71, 4096
    buffer_load_dwordx4 v[48:51], v1, s[24:27], s70 offen offset:0
    buffer_load_dwordx4 v[52:55], v1, s[24:27], s71 offen offset:0
    buffer_load_dwordx4 v[56:59], v1, s[24:27], s70 offen offset:1024
    buffer_load_dwordx4 v[60:63], v1, s[24:27], s71 offen offset:1024
    buffer_load_dwordx4 v[64:67], v1, s[24:27], s70 offen offset:2048
    buffer_load_dwordx4 v[68:71], v1, s[24:27], s71 offen offset:2048
    buffer_load_dwordx4 v[72:75], v1, s[24:27], s70 offen offset:3072
    buffer_load_dwordx4 v[76:79], v1, s[24:27], s71 offen offset:3072
    s_add_u32 s70, s70, 4096
    s_add_u32 s71, s71, 4096
    buffer_load_dwordx4 v[80:83], v1, s[24:27], s70 offen offset:0
    buffer_load_dwordx4 v[84:87], v1, s[24:27], s71 offen offset:0
    buffer_load_dwordx4 v[88:91], v1, s[24:27], s70 offen offset:1024
    buffer_load_dwordx4 v[92:95], v1, s[24:27], s71 offen offset:1024
    buffer_load_dwordx4 v[96:99], v1, s[24:27], s70 offen offset:2048
    buffer_load_dwordx4 v[100:103], v1, s[24:27], s71 offen offset:2048
    s_branch K2_FH
K2_ROLEB:
    s_cmp_ge_u32 s21, 28
    s_cbranch_scc1 K2_WPF
    s_mul_i32 s46, s21, 37
    s_lshr_b32 s46, s46, 8
    s_mul_i32 s47, s46, 7
    s_sub_u32 s47, s21, s47
    s_lshr_b32 s48, s22, 1
    s_lshl_b32 s48, s48, 2
    s_add_u32 s19, s48, s46
    s_and_b32 s48, s22, 1
    s_mul_i32 s48, s48, 7
    s_add_u32 s20, s48, s47
    s_add_u32 s46, s16, 0
    s_and_b32 s46, s46, 3
    s_lshl_b32 s46, s46, 5
    s_lshl_b32 s47, s19, 7
    s_add_u32 s46, s46, s47
    s_lshl_b32 s46, s46, 12
    s_lshl_b32 s47, s16, 7
    s_add_u32 s40, s46, s47
    s_add_u32 s46, s16, 1
    s_and_b32 s46, s46, 3
    s_lshl_b32 s46, s46, 5
    s_lshl_b32 s47, s19, 7
    s_add_u32 s46, s46, s47
    s_lshl_b32 s46, s46, 12
    s_lshl_b32 s47, s16, 7
    s_add_u32 s41, s46, s47
    s_add_u32 s46, s16, 2
    s_and_b32 s46, s46, 3
    s_lshl_b32 s46, s46, 5
    s_lshl_b32 s47, s19, 7
    s_add_u32 s46, s46, s47
    s_lshl_b32 s46, s46, 12
    s_lshl_b32 s47, s16, 7
    s_add_u32 s42, s46, s47
    s_add_u32 s46, s16, 3
    s_and_b32 s46, s46, 3
    s_lshl_b32 s46, s46, 5
    s_lshl_b32 s47, s19, 7
    s_add_u32 s46, s46, s47
    s_lshl_b32 s46, s46, 12
    s_lshl_b32 s47, s16, 7
    s_add_u32 s43, s46, s47
    s_mul_i32 s44, s16, 24576
    s_lshl_b32 s46, s20, 7
    s_lshl_b32 s47, s16, 2
    s_add_u32 s46, s46, s47
    s_lshl_b32 s46, s46, 11
    s_add_u32 s45, s46, 10485760
    v_lshrrev_b32 v8, 3, v0
    v_lshlrev_b32 v8, 12, v8
    v_lshrrev_b32 v9, 4, v0
    v_and_b32 v10, 7, v0
    v_xor_b32 v11, v10, v9
    v_lshl_add_u32 v2, v11, 4, v8
    v_xor_b32 v11, 4, v11
    v_lshl_add_u32 v3, v11, 4, v8
    v_and_b32 v8, 31, v0
    v_lshrrev_b32 v9, 5, v0
    v_lshrrev_b32 v10, 1, v8
    v_and_b32 v10, 7, v10
    v_xor_b32 v10, v10, v9
    v_lshlrev_b32 v8, 7, v8
    v_add_u32 v8, s44, v8
    v_xor_b32 v11, 0, v10
    v_lshl_add_u32 v4, v11, 4, v8
    v_xor_b32 v11, 2, v10
    v_lshl_add_u32 v5, v11, 4, v8
    v_xor_b32 v11, 4, v10
    v_lshl_add_u32 v6, v11, 4, v8
    v_xor_b32 v11, 6, v10
    v_lshl_add_u32 v7, v11, 4, v8
    s_and_b32 s52, s20, 1
    s_lshl_b32 s52, s52, 2
    s_waitcnt lgkmcnt(0)
    s_mov_b32 s24, s4
    s_mov_b32 s25, s5
    s_mov_b32 s26, 25165824
    s_mov_b32 s27, 0x00020000
    s_mov_b32 s63, 24117248
    v_mov_b32 v14, 0
    buffer_load_dword v14, v14, s[24:27], s63 offen sc1
    v_mov_b32 v12, 151552
    v_mov_b32 v13, 0
    ds_write_b32 v12, v13
    ds_write_b32 v12, v13 offset:4
    ds_write_b32 v12, v13 offset:8
    ds_write_b32 v12, v13 offset:16
    ds_write_b32 v12, v13 offset:20
    ds_write_b32 v12, v13 offset:24
    ds_write_b32 v12, v13 offset:28
    s_waitcnt lgkmcnt(0)
    s_barrier
    s_mov_b32 s28, s6
    s_mov_b32 s29, s7
    s_mov_b32 s30, 8388608
    s_mov_b32 s31, 0x00020000
    s_mov_b32 s32, s8
    s_mov_b32 s33, s9
    s_mov_b32 s34, 4096
    s_mov_b32 s35, 0x00020000
    s_add_u32 s57, s52, 0
    s_and_b32 s57, s57, 7
    s_lshl_b32 s53, s57, 9
    s_lshl_b32 s57, s57, 15
    s_add_u32 s55, s57, s45
    s_add_u32 m0, s44, 0
    s_add_u32 s46, s42, s53
    buffer_load_dwordx4 v2, s[28:31], s46 offen lds
    s_add_u32 m0, s44, 1024
    s_add_u32 s46, s42, s53
    s_add_u32 s46, s46, 32768
    buffer_load_dwordx4 v3, s[28:31], s46 offen lds
    s_add_u32 m0, s44, 2048
    s_add_u32 s46, s42, s53
    s_add_u32 s46, s46, 65536
    buffer_load_dwordx4 v2, s[28:31], s46 offen lds
    s_add_u32 m0, s44, 3072
    s_add_u32 s46, s42, s53
    s_add_u32 s46, s46, 98304
    buffer_load_dwordx4 v3, s[28:31], s46 offen lds
    s_add_u32 m0, s44, 4096
    s_add_u32 s46, s43, s53
    buffer_load_dwordx4 v2, s[28:31], s46 offen lds
    s_add_u32 m0, s44, 5120
    s_add_u32 s46, s43, s53
    s_add_u32 s46, s46, 32768
    buffer_load_dwordx4 v3, s[28:31], s46 offen lds
    s_add_u32 m0, s44, 6144
    s_add_u32 s46, s43, s53
    s_add_u32 s46, s46, 65536
    buffer_load_dwordx4 v2, s[28:31], s46 offen lds
    s_add_u32 m0, s44, 7168
    s_add_u32 s46, s43, s53
    s_add_u32 s46, s46, 98304
    buffer_load_dwordx4 v3, s[28:31], s46 offen lds
    s_add_u32 s47, s55, 0
    buffer_load_dwordx4 v[64:67], v1, s[24:27], s47 offen offset:0
    buffer_load_dwordx4 v[68:71], v1, s[24:27], s47 offen offset:1024
    buffer_load_dwordx4 v[72:75], v1, s[24:27], s47 offen offset:2048
    buffer_load_dwordx4 v[76:79], v1, s[24:27], s47 offen offset:3072
    s_add_u32 m0, s44, 8192
    s_add_u32 s46, s40, s53
    buffer_load_dwordx4 v2, s[28:31], s46 offen lds
    s_add_u32 m0, s44, 9216
    s_add_u32 s46, s40, s53
    s_add_u32 s46, s46, 32768
    buffer_load_dwordx4 v3, s[28:31], s46 offen lds
    s_add_u32 m0, s44, 10240
    s_add_u32 s46, s40, s53
    s_add_u32 s46, s46, 65536
    buffer_load_dwordx4 v2, s[28:31], s46 offen lds
    s_add_u32 m0, s44, 11264
    s_add_u32 s46, s40, s53
    s_add_u32 s46, s46, 98304
    buffer_load_dwordx4 v3, s[28:31], s46 offen lds
    s_add_u32 m0, s44, 12288
    s_add_u32 s46, s41, s53
    buffer_load_dwordx4 v2, s[28:31], s46 offen lds
    s_add_u32 m0, s44, 13312
    s_add_u32 s46, s41, s53
    s_add_u32 s46, s46, 32768
    buffer_load_dwordx4 v3, s[28:31], s46 offen lds
    s_add_u32 m0, s44, 14336
    s_add_u32 s46, s41, s53
    s_add_u32 s46, s46, 65536
    buffer_load_dwordx4 v2, s[28:31], s46 offen lds
    s_add_u32 m0, s44, 15360
    s_add_u32 s46, s41, s53
    s_add_u32 s46, s46, 98304
    buffer_load_dwordx4 v3, s[28:31], s46 offen lds
    s_add_u32 s47, s55, 4096
    buffer_load_dwordx4 v[80:83], v1, s[24:27], s47 offen offset:0
    buffer_load_dwordx4 v[84:87], v1, s[24:27], s47 offen offset:1024
    buffer_load_dwordx4 v[88:91], v1, s[24:27], s47 offen offset:2048
    buffer_load_dwordx4 v[92:95], v1, s[24:27], s47 offen offset:3072
    s_waitcnt vmcnt(16)
    ds_read_b128 v[48:51], v4 offset:0
    ds_read_b128 v[52:55], v4 offset:4096
    s_waitcnt vmcnt(15) lgkmcnt(1)
    v_mfma_f32_32x32x16_bf16 v[192:207], v[64:67], v[48:51], 0
    ds_read_b128 v[56:59], v5 offset:0
    ds_read_b128 v[60:63], v5 offset:4096
    s_add_u32 s57, s52, 1
    s_and_b32 s57, s57, 7
    s_lshl_b32 s54, s57, 9
    s_lshl_b32 s57, s57, 15
    s_add_u32 s56, s57, s45
    s_add_u32 m0, s44, 16384
    s_add_u32 s46, s42, s54
    buffer_load_dwordx4 v2, s[28:31], s46 offen lds
    s_waitcnt vmcnt(15)
    v_mfma_f32_32x32x16_bf16 v[208:223], v[68:71], v[48:51], 0
    s_add_u32 m0, s44, 17408
    s_add_u32 s46, s42, s54
    s_add_u32 s46, s46, 32768
    buffer_load_dwordx4 v3, s[28:31], s46 offen lds
    s_waitcnt lgkmcnt(2)
    v_mfma_f32_32x32x16_bf16 v[224:239], v[64:67], v[52:55], 0
    s_add_u32 m0, s44, 18432
    s_add_u32 s46, s42, s54
    s_add_u32 s46, s46, 65536
    buffer_load_dwordx4 v2, s[28:31], s46 offen lds
    v_mfma_f32_32x32x16_bf16 v[240:255], v[68:71], v[52:55], 0
    s_add_u32 m0, s44, 19456
    s_add_u32 s46, s42, s54
    s_add_u32 s46, s46, 98304
    buffer_load_dwordx4 v3, s[28:31], s46 offen lds
    s_waitcnt vmcnt(17) lgkmcnt(1)
    v_mfma_f32_32x32x16_bf16 v[192:207], v[72:75], v[56:59], v[192:207]
    ds_read_b128 v[48:51], v6 offset:0
    ds_read_b128 v[52:55], v6 offset:4096
    s_add_u32 m0, s44, 20480
    s_add_u32 s46, s43, s54
    buffer_load_dwordx4 v2, s[28:31], s46 offen lds
    s_waitcnt vmcnt(17)
    v_mfma_f32_32x32x16_bf16 v[208:223], v[76:79], v[56:59], v[208:223]
    s_add_u32 m0, s44, 21504
    s_add_u32 s46, s43, s54
    s_add_u32 s46, s46, 32768
    buffer_load_dwordx4 v3, s[28:31], s46 offen lds
    s_waitcnt lgkmcnt(2)
    v_mfma_f32_32x32x16_bf16 v[224:239], v[72:75], v[60:63], v[224:239]
    s_add_u32 m0, s44, 22528
    s_add_u32 s46, s43, s54
    s_add_u32 s46, s46, 65536
    buffer_load_dwordx4 v2, s[28:31], s46 offen lds
    v_mfma_f32_32x32x16_bf16 v[240:255], v[76:79], v[60:63], v[240:255]
    s_add_u32 m0, s44, 23552
    s_add_u32 s46, s43, s54
    s_add_u32 s46, s46, 98304
    buffer_load_dwordx4 v3, s[28:31], s46 offen lds
    s_waitcnt vmcnt(11) lgkmcnt(1)
    v_mfma_f32_32x32x16_bf16 v[192:207], v[80:83], v[48:51], v[192:207]
    ds_read_b128 v[56:59], v7 offset:0
    ds_read_b128 v[60:63], v7 offset:4096
    s_waitcnt vmcnt(10)
    v_mfma_f32_32x32x16_bf16 v[208:223], v[84:87], v[48:51], v[208:223]
    s_add_u32 s47, s56, 0
    buffer_load_dwordx4 v[96:99], v1, s[24:27], s47 offen offset:0
    s_waitcnt lgkmcnt(2)
    v_mfma_f32_32x32x16_bf16 v[224:239], v[80:83], v[52:55], v[224:239]
    v_mfma_f32_32x32x16_bf16 v[240:255], v[84:87], v[52:55], v[240:255]
    s_add_u32 s47, s56, 0
    buffer_load_dwordx4 v[100:103], v1, s[24:27], s47 offen offset:1024
    s_waitcnt vmcnt(11) lgkmcnt(1)
    v_mfma_f32_32x32x16_bf16 v[192:207], v[88:91], v[56:59], v[192:207]
    ds_read_b128 v[48:51], v4 offset:8192
    ds_read_b128 v[52:55], v4 offset:12288
    s_waitcnt vmcnt(10)
    v_mfma_f32_32x32x16_bf16 v[208:223], v[92:95], v[56:59], v[208:223]
    s_add_u32 s47, s56, 0
    buffer_load_dwordx4 v[104:107], v1, s[24:27], s47 offen offset:2048
    s_waitcnt lgkmcnt(2)
    v_mfma_f32_32x32x16_bf16 v[224:239], v[88:91], v[60:63], v[224:239]
    v_mfma_f32_32x32x16_bf16 v[240:255], v[92:95], v[60:63], v[240:255]
    s_add_u32 s47, s56, 0
    buffer_load_dwordx4 v[108:111], v1, s[24:27], s47 offen offset:3072
    s_waitcnt lgkmcnt(1)
    v_mfma_f32_32x32x16_bf16 v[128:143], v[64:67], v[48:51], 0
    ds_read_b128 v[56:59], v5 offset:8192
    ds_read_b128 v[60:63], v5 offset:12288
    s_add_u32 m0, s44, 0
    s_add_u32 s46, s40, s54
    buffer_load_dwordx4 v2, s[28:31], s46 offen lds
    v_mfma_f32_32x32x16_bf16 v[144:159], v[68:71], v[48:51], 0
    s_add_u32 m0, s44, 1024
    s_add_u32 s46, s40, s54
    s_add_u32 s46, s46, 32768
    buffer_load_dwordx4 v3, s[28:31], s46 offen lds
    s_waitcnt lgkmcnt(2)
    v_mfma_f32_32x32x16_bf16 v[160:175], v[64:67], v[52:55], 0
    s_add_u32 m0, s44, 2048
    s_add_u32 s46, s40, s54
    s_add_u32 s46, s46, 65536
    buffer_load_dwordx4 v2, s[28:31], s46 offen lds
    v_mfma_f32_32x32x16_bf16 v[176:191], v[68:71], v[52:55], 0
    s_add_u32 m0, s44, 3072
    s_add_u32 s46, s40, s54
    s_add_u32 s46, s46, 98304
    buffer_load_dwordx4 v3, s[28:31], s46 offen lds
    s_waitcnt lgkmcnt(1)
    v_mfma_f32_32x32x16_bf16 v[128:143], v[72:75], v[56:59], v[128:143]
    ds_read_b128 v[48:51], v6 offset:8192
    ds_read_b128 v[52:55], v6 offset:12288
    s_add_u32 m0, s44, 4096
    s_add_u32 s46, s41, s54
    buffer_load_dwordx4 v2, s[28:31], s46 offen lds
    v_mfma_f32_32x32x16_bf16 v[144:159], v[76:79], v[56:59], v[144:159]
    s_add_u32 m0, s44, 5120
    s_add_u32 s46, s41, s54
    s_add_u32 s46, s46, 32768
    buffer_load_dwordx4 v3, s[28:31], s46 offen lds
    s_waitcnt lgkmcnt(2)
    v_mfma_f32_32x32x16_bf16 v[160:175], v[72:75], v[60:63], v[160:175]
    s_add_u32 m0, s44, 6144
    s_add_u32 s46, s41, s54
    s_add_u32 s46, s46, 65536
    buffer_load_dwordx4 v2, s[28:31], s46 offen lds
    v_mfma_f32_32x32x16_bf16 v[176:191], v[76:79], v[60:63], v[176:191]
    s_add_u32 m0, s44, 7168
    s_add_u32 s46, s41, s54
    s_add_u32 s46, s46, 98304
    buffer_load_dwordx4 v3, s[28:31], s46 offen lds
    s_waitcnt lgkmcnt(1)
    v_mfma_f32_32x32x16_bf16 v[128:143], v[80:83], v[48:51], v[128:143]
    ds_read_b128 v[56:59], v7 offset:8192
    ds_read_b128 v[60:63], v7 offset:12288
    v_mfma_f32_32x32x16_bf16 v[144:159], v[84:87], v[48:51], v[144:159]
    s_add_u32 s47, s56, 4096
    buffer_load_dwordx4 v[112:115], v1, s[24:27], s47 offen offset:0
    s_waitcnt lgkmcnt(2)
    v_mfma_f32_32x32x16_bf16 v[160:175], v[80:83], v[52:55], v[160:175]
    v_mfma_f32_32x32x16_bf16 v[176:191], v[84:87], v[52:55], v[176:191]
    s_add_u32 s47, s56, 4096
    buffer_load_dwordx4 v[116:119], v1, s[24:27], s47 offen offset:1024
    s_waitcnt lgkmcnt(1)
    v_mfma_f32_32x32x16_bf16 v[128:143], v[88:91], v[56:59], v[128:143]
    s_waitcnt vmcnt(14)
    ds_read_b128 v[48:51], v4 offset:16384
    ds_read_b128 v[52:55], v4 offset:20480
    v_mfma_f32_32x32x16_bf16 v[144:159], v[92:95], v[56:59], v[144:159]
    s_add_u32 s47, s56, 4096
    buffer_load_dwordx4 v[120:123], v1, s[24:27], s47 offen offset:2048
    s_waitcnt lgkmcnt(2)
    v_mfma_f32_32x32x16_bf16 v[160:175], v[88:91], v[60:63], v[160:175]
    v_mfma_f32_32x32x16_bf16 v[176:191], v[92:95], v[60:63], v[176:191]
    s_add_u32 s47, s56, 4096
    buffer_load_dwordx4 v[124:127], v1, s[24:27], s47 offen offset:3072
    s_waitcnt vmcnt(15) lgkmcnt(1)
    v_mfma_f32_32x32x16_bf16 v[192:207], v[96:99], v[48:51], v[192:207]
    ds_read_b128 v[56:59], v5 offset:16384
    ds_read_b128 v[60:63], v5 offset:20480
    s_add_u32 s57, s52, 2
    s_and_b32 s57, s57, 7
    s_lshl_b32 s53, s57, 9
    s_lshl_b32 s57, s57, 15
    s_add_u32 s55, s57, s45
    s_add_u32 m0, s44, 8192
    s_add_u32 s46, s42, s53
    buffer_load_dwordx4 v2, s[28:31], s46 offen lds
    s_waitcnt vmcnt(15)
    v_mfma_f32_32x32x16_bf16 v[208:223], v[100:103], v[48:51], v[208:223]
    s_add_u32 m0, s44, 9216
    s_add_u32 s46, s42, s53
    s_add_u32 s46, s46, 32768
    buffer_load_dwordx4 v3, s[28:31], s46 offen lds
    s_waitcnt lgkmcnt(2)
    v_mfma_f32_32x32x16_bf16 v[224:239], v[96:99], v[52:55], v[224:239]
    s_add_u32 m0, s44, 10240
    s_add_u32 s46, s42, s53
    s_add_u32 s46, s46, 65536
    buffer_load_dwordx4 v2, s[28:31], s46 offen lds
    v_mfma_f32_32x32x16_bf16 v[240:255], v[100:103], v[52:55], v[240:255]
    s_add_u32 m0, s44, 11264
    s_add_u32 s46, s42, s53
    s_add_u32 s46, s46, 98304
    buffer_load_dwordx4 v3, s[28:31], s46 offen lds
    s_waitcnt vmcnt(17) lgkmcnt(1)
    v_mfma_f32_32x32x16_bf16 v[192:207], v[104:107], v[56:59], v[192:207]
    ds_read_b128 v[48:51], v6 offset:16384
    ds_read_b128 v[52:55], v6 offset:20480
    s_add_u32 m0, s44, 12288
    s_add_u32 s46, s43, s53
    buffer_load_dwordx4 v2, s[28:31], s46 offen lds
    s_waitcnt vmcnt(17)
    v_mfma_f32_32x32x16_bf16 v[208:223], v[108:111], v[56:59], v[208:223]
    s_add_u32 m0, s44, 13312
    s_add_u32 s46, s43, s53
    s_add_u32 s46, s46, 32768
    buffer_load_dwordx4 v3, s[28:31], s46 offen lds
    s_waitcnt lgkmcnt(2)
    v_mfma_f32_32x32x16_bf16 v[224:239], v[104:107], v[60:63], v[224:239]
    s_add_u32 m0, s44, 14336
    s_add_u32 s46, s43, s53
    s_add_u32 s46, s46, 65536
    buffer_load_dwordx4 v2, s[28:31], s46 offen lds
    v_mfma_f32_32x32x16_bf16 v[240:255], v[108:111], v[60:63], v[240:255]
    s_add_u32 m0, s44, 15360
    s_add_u32 s46, s43, s53
    s_add_u32 s46, s46, 98304
    buffer_load_dwordx4 v3, s[28:31], s46 offen lds
    s_waitcnt vmcnt(11) lgkmcnt(1)
    v_mfma_f32_32x32x16_bf16 v[192:207], v[112:115], v[48:51], v[192:207]
    ds_read_b128 v[56:59], v7 offset:16384
    ds_read_b128 v[60:63], v7 offset:20480
    s_waitcnt vmcnt(10)
    v_mfma_f32_32x32x16_bf16 v[208:223], v[116:119], v[48:51], v[208:223]
    s_add_u32 s47, s55, 0
    buffer_load_dwordx4 v[64:67], v1, s[24:27], s47 offen offset:0
    s_waitcnt lgkmcnt(2)
    v_mfma_f32_32x32x16_bf16 v[224:239], v[112:115], v[52:55], v[224:239]
    v_mfma_f32_32x32x16_bf16 v[240:255], v[116:119], v[52:55], v[240:255]
    s_add_u32 s47, s55, 0
    buffer_load_dwordx4 v[68:71], v1, s[24:27], s47 offen offset:1024
    s_waitcnt vmcnt(11) lgkmcnt(1)
    v_mfma_f32_32x32x16_bf16 v[192:207], v[120:123], v[56:59], v[192:207]
    ds_read_b128 v[48:51], v4 offset:0
    ds_read_b128 v[52:55], v4 offset:4096
    s_waitcnt vmcnt(10)
    v_mfma_f32_32x32x16_bf16 v[208:223], v[124:127], v[56:59], v[208:223]
    s_add_u32 s47, s55, 0
    buffer_load_dwordx4 v[72:75], v1, s[24:27], s47 offen offset:2048
    s_waitcnt lgkmcnt(2)
    v_mfma_f32_32x32x16_bf16 v[224:239], v[120:123], v[60:63], v[224:239]
    v_mfma_f32_32x32x16_bf16 v[240:255], v[124:127], v[60:63], v[240:255]
    s_add_u32 s47, s55, 0
    buffer_load_dwordx4 v[76:79], v1, s[24:27], s47 offen offset:3072
    s_waitcnt lgkmcnt(1)
    v_mfma_f32_32x32x16_bf16 v[128:143], v[96:99], v[48:51], v[128:143]
    ds_read_b128 v[56:59], v5 offset:0
    ds_read_b128 v[60:63], v5 offset:4096
    s_add_u32 m0, s44, 16384
    s_add_u32 s46, s40, s53
    buffer_load_dwordx4 v2, s[28:31], s46 offen lds
    v_mfma_f32_32x32x16_bf16 v[144:159], v[100:103], v[48:51], v[144:159]
    s_add_u32 m0, s44, 17408
    s_add_u32 s46, s40, s53
    s_add_u32 s46, s46, 32768
    buffer_load_dwordx4 v3, s[28:31], s46 offen lds
    s_waitcnt lgkmcnt(2)
    v_mfma_f32_32x32x16_bf16 v[160:175], v[96:99], v[52:55], v[160:175]
    s_add_u32 m0, s44, 18432
    s_add_u32 s46, s40, s53
    s_add_u32 s46, s46, 65536
    buffer_load_dwordx4 v2, s[28:31], s46 offen lds
    v_mfma_f32_32x32x16_bf16 v[176:191], v[100:103], v[52:55], v[176:191]
    s_add_u32 m0, s44, 19456
    s_add_u32 s46, s40, s53
    s_add_u32 s46, s46, 98304
    buffer_load_dwordx4 v3, s[28:31], s46 offen lds
    s_waitcnt lgkmcnt(1)
    v_mfma_f32_32x32x16_bf16 v[128:143], v[104:107], v[56:59], v[128:143]
    ds_read_b128 v[48:51], v6 offset:0
    ds_read_b128 v[52:55], v6 offset:4096
    s_add_u32 m0, s44, 20480
    s_add_u32 s46, s41, s53
    buffer_load_dwordx4 v2, s[28:31], s46 offen lds
    v_mfma_f32_32x32x16_bf16 v[144:159], v[108:111], v[56:59], v[144:159]
    s_add_u32 m0, s44, 21504
    s_add_u32 s46, s41, s53
    s_add_u32 s46, s46, 32768
    buffer_load_dwordx4 v3, s[28:31], s46 offen lds
    s_waitcnt lgkmcnt(2)
    v_mfma_f32_32x32x16_bf16 v[160:175], v[104:107], v[60:63], v[160:175]
    s_add_u32 m0, s44, 22528
    s_add_u32 s46, s41, s53
    s_add_u32 s46, s46, 65536
    buffer_load_dwordx4 v2, s[28:31], s46 offen lds
    v_mfma_f32_32x32x16_bf16 v[176:191], v[108:111], v[60:63], v[176:191]
    s_add_u32 m0, s44, 23552
    s_add_u32 s46, s41, s53
    s_add_u32 s46, s46, 98304
    buffer_load_dwordx4 v3, s[28:31], s46 offen lds
    s_waitcnt lgkmcnt(1)
    v_mfma_f32_32x32x16_bf16 v[128:143], v[112:115], v[48:51], v[128:143]
    ds_read_b128 v[56:59], v7 offset:0
    ds_read_b128 v[60:63], v7 offset:4096
    v_mfma_f32_32x32x16_bf16 v[144:159], v[116:119], v[48:51], v[144:159]
    s_add_u32 s47, s55, 4096
    buffer_load_dwordx4 v[80:83], v1, s[24:27], s47 offen offset:0
    s_waitcnt lgkmcnt(2)
    v_mfma_f32_32x32x16_bf16 v[160:175], v[112:115], v[52:55], v[160:175]
    v_mfma_f32_32x32x16_bf16 v[176:191], v[116:119], v[52:55], v[176:191]
    s_add_u32 s47, s55, 4096
    buffer_load_dwordx4 v[84:87], v1, s[24:27], s47 offen offset:1024
    s_waitcnt lgkmcnt(1)
    v_mfma_f32_32x32x16_bf16 v[128:143], v[120:123], v[56:59], v[128:143]
    s_waitcnt vmcnt(14)
    ds_read_b128 v[48:51], v4 offset:8192
    ds_read_b128 v[52:55], v4 offset:12288
    v_mfma_f32_32x32x16_bf16 v[144:159], v[124:127], v[56:59], v[144:159]
    s_add_u32 s47, s55, 4096
    buffer_load_dwordx4 v[88:91], v1, s[24:27], s47 offen offset:2048
    s_waitcnt lgkmcnt(2)
    v_mfma_f32_32x32x16_bf16 v[160:175], v[120:123], v[60:63], v[160:175]
    v_mfma_f32_32x32x16_bf16 v[176:191], v[124:127], v[60:63], v[176:191]
    s_add_u32 s47, s55, 4096
    buffer_load_dwordx4 v[92:95], v1, s[24:27], s47 offen offset:3072
    s_waitcnt vmcnt(15) lgkmcnt(1)
    v_mfma_f32_32x32x16_bf16 v[192:207], v[64:67], v[48:51], v[192:207]
    ds_read_b128 v[56:59], v5 offset:8192
    ds_read_b128 v[60:63], v5 offset:12288
    s_add_u32 s57, s52, 3
    s_and_b32 s57, s57, 7
    s_lshl_b32 s54, s57, 9
    s_lshl_b32 s57, s57, 15
    s_add_u32 s56, s57, s45
    s_add_u32 m0, s44, 0
    s_add_u32 s46, s42, s54
    buffer_load_dwordx4 v2, s[28:31], s46 offen lds
    s_waitcnt vmcnt(15)
    v_mfma_f32_32x32x16_bf16 v[208:223], v[68:71], v[48:51], v[208:223]
    s_add_u32 m0, s44, 1024
    s_add_u32 s46, s42, s54
    s_add_u32 s46, s46, 32768
    buffer_load_dwordx4 v3, s[28:31], s46 offen lds
    s_waitcnt lgkmcnt(2)
    v_mfma_f32_32x32x16_bf16 v[224:239], v[64:67], v[52:55], v[224:239]
    s_add_u32 m0, s44, 2048
    s_add_u32 s46, s42, s54
    s_add_u32 s46, s46, 65536
    buffer_load_dwordx4 v2, s[28:31], s46 offen lds
    v_mfma_f32_32x32x16_bf16 v[240:255], v[68:71], v[52:55], v[240:255]
    s_add_u32 m0, s44, 3072
    s_add_u32 s46, s42, s54
    s_add_u32 s46, s46, 98304
    buffer_load_dwordx4 v3, s[28:31], s46 offen lds
    s_waitcnt vmcnt(17) lgkmcnt(1)
    v_mfma_f32_32x32x16_bf16 v[192:207], v[72:75], v[56:59], v[192:207]
    ds_read_b128 v[48:51], v6 offset:8192
    ds_read_b128 v[52:55], v6 offset:12288
    s_add_u32 m0, s44, 4096
    s_add_u32 s46, s43, s54
    buffer_load_dwordx4 v2, s[28:31], s46 offen lds
    s_waitcnt vmcnt(17)
    v_mfma_f32_32x32x16_bf16 v[208:223], v[76:79], v[56:59], v[208:223]
    s_add_u32 m0, s44, 5120
    s_add_u32 s46, s43, s54
    s_add_u32 s46, s46, 32768
    buffer_load_dwordx4 v3, s[28:31], s46 offen lds
    s_waitcnt lgkmcnt(2)
    v_mfma_f32_32x32x16_bf16 v[224:239], v[72:75], v[60:63], v[224:239]
    s_add_u32 m0, s44, 6144
    s_add_u32 s46, s43, s54
    s_add_u32 s46, s46, 65536
    buffer_load_dwordx4 v2, s[28:31], s46 offen lds
    v_mfma_f32_32x32x16_bf16 v[240:255], v[76:79], v[60:63], v[240:255]
    s_add_u32 m0, s44, 7168
    s_add_u32 s46, s43, s54
    s_add_u32 s46, s46, 98304
    buffer_load_dwordx4 v3, s[28:31], s46 offen lds
    s_waitcnt vmcnt(11) lgkmcnt(1)
    v_mfma_f32_32x32x16_bf16 v[192:207], v[80:83], v[48:51], v[192:207]
    ds_read_b128 v[56:59], v7 offset:8192
    ds_read_b128 v[60:63], v7 offset:12288
    s_waitcnt vmcnt(10)
    v_mfma_f32_32x32x16_bf16 v[208:223], v[84:87], v[48:51], v[208:223]
    s_add_u32 s47, s56, 0
    buffer_load_dwordx4 v[96:99], v1, s[24:27], s47 offen offset:0
    s_waitcnt lgkmcnt(2)
    v_mfma_f32_32x32x16_bf16 v[224:239], v[80:83], v[52:55], v[224:239]
    v_mfma_f32_32x32x16_bf16 v[240:255], v[84:87], v[52:55], v[240:255]
    s_add_u32 s47, s56, 0
    buffer_load_dwordx4 v[100:103], v1, s[24:27], s47 offen offset:1024
    s_waitcnt vmcnt(11) lgkmcnt(1)
    v_mfma_f32_32x32x16_bf16 v[192:207], v[88:91], v[56:59], v[192:207]
    ds_read_b128 v[48:51], v4 offset:16384
    ds_read_b128 v[52:55], v4 offset:20480
    s_waitcnt vmcnt(10)
    v_mfma_f32_32x32x16_bf16 v[208:223], v[92:95], v[56:59], v[208:223]
    s_add_u32 s47, s56, 0
    buffer_load_dwordx4 v[104:107], v1, s[24:27], s47 offen offset:2048
    s_waitcnt lgkmcnt(2)
    v_mfma_f32_32x32x16_bf16 v[224:239], v[88:91], v[60:63], v[224:239]
    v_mfma_f32_32x32x16_bf16 v[240:255], v[92:95], v[60:63], v[240:255]
    s_add_u32 s47, s56, 0
    buffer_load_dwordx4 v[108:111], v1, s[24:27], s47 offen offset:3072
    s_waitcnt lgkmcnt(1)
    v_mfma_f32_32x32x16_bf16 v[128:143], v[64:67], v[48:51], v[128:143]
    ds_read_b128 v[56:59], v5 offset:16384
    ds_read_b128 v[60:63], v5 offset:20480
    s_add_u32 m0, s44, 8192
    s_add_u32 s46, s40, s54
    buffer_load_dwordx4 v2, s[28:31], s46 offen lds
    v_mfma_f32_32x32x16_bf16 v[144:159], v[68:71], v[48:51], v[144:159]
    s_add_u32 m0, s44, 9216
    s_add_u32 s46, s40, s54
    s_add_u32 s46, s46, 32768
    buffer_load_dwordx4 v3, s[28:31], s46 offen lds
    s_waitcnt lgkmcnt(2)
    v_mfma_f32_32x32x16_bf16 v[160:175], v[64:67], v[52:55], v[160:175]
    s_add_u32 m0, s44, 10240
    s_add_u32 s46, s40, s54
    s_add_u32 s46, s46, 65536
    buffer_load_dwordx4 v2, s[28:31], s46 offen lds
    v_mfma_f32_32x32x16_bf16 v[176:191], v[68:71], v[52:55], v[176:191]
    s_add_u32 m0, s44, 11264
    s_add_u32 s46, s40, s54
    s_add_u32 s46, s46, 98304
    buffer_load_dwordx4 v3, s[28:31], s46 offen lds
    s_waitcnt lgkmcnt(1)
    v_mfma_f32_32x32x16_bf16 v[128:143], v[72:75], v[56:59], v[128:143]
    ds_read_b128 v[48:51], v6 offset:16384
    ds_read_b128 v[52:55], v6 offset:20480
    s_add_u32 m0, s44, 12288
    s_add_u32 s46, s41, s54
    buffer_load_dwordx4 v2, s[28:31], s46 offen lds
    v_mfma_f32_32x32x16_bf16 v[144:159], v[76:79], v[56:59], v[144:159]
    s_add_u32 m0, s44, 13312
    s_add_u32 s46, s41, s54
    s_add_u32 s46, s46, 32768
    buffer_load_dwordx4 v3, s[28:31], s46 offen lds
    s_waitcnt lgkmcnt(2)
    v_mfma_f32_32x32x16_bf16 v[160:175], v[72:75], v[60:63], v[160:175]
    s_add_u32 m0, s44, 14336
    s_add_u32 s46, s41, s54
    s_add_u32 s46, s46, 65536
    buffer_load_dwordx4 v2, s[28:31], s46 offen lds
    v_mfma_f32_32x32x16_bf16 v[176:191], v[76:79], v[60:63], v[176:191]
    s_add_u32 m0, s44, 15360
    s_add_u32 s46, s41, s54
    s_add_u32 s46, s46, 98304
    buffer_load_dwordx4 v3, s[28:31], s46 offen lds
    s_waitcnt lgkmcnt(1)
    v_mfma_f32_32x32x16_bf16 v[128:143], v[80:83], v[48:51], v[128:143]
    ds_read_b128 v[56:59], v7 offset:16384
    ds_read_b128 v[60:63], v7 offset:20480
    v_mfma_f32_32x32x16_bf16 v[144:159], v[84:87], v[48:51], v[144:159]
    s_add_u32 s47, s56, 4096
    buffer_load_dwordx4 v[112:115], v1, s[24:27], s47 offen offset:0
    s_waitcnt lgkmcnt(2)
    v_mfma_f32_32x32x16_bf16 v[160:175], v[80:83], v[52:55], v[160:175]
    v_mfma_f32_32x32x16_bf16 v[176:191], v[84:87], v[52:55], v[176:191]
    s_add_u32 s47, s56, 4096
    buffer_load_dwordx4 v[116:119], v1, s[24:27], s47 offen offset:1024
    s_waitcnt lgkmcnt(1)
    v_mfma_f32_32x32x16_bf16 v[128:143], v[88:91], v[56:59], v[128:143]
    s_waitcnt vmcnt(14)
    ds_read_b128 v[48:51], v4 offset:0
    ds_read_b128 v[52:55], v4 offset:4096
    v_mfma_f32_32x32x16_bf16 v[144:159], v[92:95], v[56:59], v[144:159]
    s_add_u32 s47, s56, 4096
    buffer_load_dwordx4 v[120:123], v1, s[24:27], s47 offen offset:2048
    s_waitcnt lgkmcnt(2)
    v_mfma_f32_32x32x16_bf16 v[160:175], v[88:91], v[60:63], v[160:175]
    v_mfma_f32_32x32x16_bf16 v[176:191], v[92:95], v[60:63], v[176:191]
    s_add_u32 s47, s56, 4096
    buffer_load_dwordx4 v[124:127], v1, s[24:27], s47 offen offset:3072
    s_waitcnt vmcnt(15) lgkmcnt(1)
    v_mfma_f32_32x32x16_bf16 v[192:207], v[96:99], v[48:51], v[192:207]
    ds_read_b128 v[56:59], v5 offset:0
    ds_read_b128 v[60:63], v5 offset:4096
    s_add_u32 s57, s52, 4
    s_and_b32 s57, s57, 7
    s_lshl_b32 s53, s57, 9
    s_lshl_b32 s57, s57, 15
    s_add_u32 s55, s57, s45
    s_add_u32 m0, s44, 16384
    s_add_u32 s46, s42, s53
    buffer_load_dwordx4 v2, s[28:31], s46 offen lds
    s_waitcnt vmcnt(15)
    v_mfma_f32_32x32x16_bf16 v[208:223], v[100:103], v[48:51], v[208:223]
    s_add_u32 m0, s44, 17408
    s_add_u32 s46, s42, s53
    s_add_u32 s46, s46, 32768
    buffer_load_dwordx4 v3, s[28:31], s46 offen lds
    s_waitcnt lgkmcnt(2)
    v_mfma_f32_32x32x16_bf16 v[224:239], v[96:99], v[52:55], v[224:239]
    s_add_u32 m0, s44, 18432
    s_add_u32 s46, s42, s53
    s_add_u32 s46, s46, 65536
    buffer_load_dwordx4 v2, s[28:31], s46 offen lds
    v_mfma_f32_32x32x16_bf16 v[240:255], v[100:103], v[52:55], v[240:255]
    s_add_u32 m0, s44, 19456
    s_add_u32 s46, s42, s53
    s_add_u32 s46, s46, 98304
    buffer_load_dwordx4 v3, s[28:31], s46 offen lds
    s_waitcnt vmcnt(17) lgkmcnt(1)
    v_mfma_f32_32x32x16_bf16 v[192:207], v[104:107], v[56:59], v[192:207]
    ds_read_b128 v[48:51], v6 offset:0
    ds_read_b128 v[52:55], v6 offset:4096
    s_add_u32 m0, s44, 20480
    s_add_u32 s46, s43, s53
    buffer_load_dwordx4 v2, s[28:31], s46 offen lds
    s_waitcnt vmcnt(17)
    v_mfma_f32_32x32x16_bf16 v[208:223], v[108:111], v[56:59], v[208:223]
    s_add_u32 m0, s44, 21504
    s_add_u32 s46, s43, s53
    s_add_u32 s46, s46, 32768
    buffer_load_dwordx4 v3, s[28:31], s46 offen lds
    s_waitcnt lgkmcnt(2)
    v_mfma_f32_32x32x16_bf16 v[224:239], v[104:107], v[60:63], v[224:239]
    s_add_u32 m0, s44, 22528
    s_add_u32 s46, s43, s53
    s_add_u32 s46, s46, 65536
    buffer_load_dwordx4 v2, s[28:31], s46 offen lds
    v_mfma_f32_32x32x16_bf16 v[240:255], v[108:111], v[60:63], v[240:255]
    s_add_u32 m0, s44, 23552
    s_add_u32 s46, s43, s53
    s_add_u32 s46, s46, 98304
    buffer_load_dwordx4 v3, s[28:31], s46 offen lds
    s_waitcnt vmcnt(11) lgkmcnt(1)
    v_mfma_f32_32x32x16_bf16 v[192:207], v[112:115], v[48:51], v[192:207]
    ds_read_b128 v[56:59], v7 offset:0
    ds_read_b128 v[60:63], v7 offset:4096
    s_waitcnt vmcnt(10)
    v_mfma_f32_32x32x16_bf16 v[208:223], v[116:119], v[48:51], v[208:223]
    s_add_u32 s47, s55, 0
    buffer_load_dwordx4 v[64:67], v1, s[24:27], s47 offen offset:0
    s_waitcnt lgkmcnt(2)
    v_mfma_f32_32x32x16_bf16 v[224:239], v[112:115], v[52:55], v[224:239]
    v_mfma_f32_32x32x16_bf16 v[240:255], v[116:119], v[52:55], v[240:255]
    s_add_u32 s47, s55, 0
    buffer_load_dwordx4 v[68:71], v1, s[24:27], s47 offen offset:1024
    s_waitcnt vmcnt(11) lgkmcnt(1)
    v_mfma_f32_32x32x16_bf16 v[192:207], v[120:123], v[56:59], v[192:207]
    ds_read_b128 v[48:51], v4 offset:8192
    ds_read_b128 v[52:55], v4 offset:12288
    s_waitcnt vmcnt(10)
    v_mfma_f32_32x32x16_bf16 v[208:223], v[124:127], v[56:59], v[208:223]
    s_add_u32 s47, s55, 0
    buffer_load_dwordx4 v[72:75], v1, s[24:27], s47 offen offset:2048
    s_waitcnt lgkmcnt(2)
    v_mfma_f32_32x32x16_bf16 v[224:239], v[120:123], v[60:63], v[224:239]
    v_mfma_f32_32x32x16_bf16 v[240:255], v[124:127], v[60:63], v[240:255]
    s_add_u32 s47, s55, 0
    buffer_load_dwordx4 v[76:79], v1, s[24:27], s47 offen offset:3072
    s_waitcnt lgkmcnt(1)
    v_mfma_f32_32x32x16_bf16 v[128:143], v[96:99], v[48:51], v[128:143]
    ds_read_b128 v[56:59], v5 offset:8192
    ds_read_b128 v[60:63], v5 offset:12288
    s_add_u32 m0, s44, 0
    s_add_u32 s46, s40, s53
    buffer_load_dwordx4 v2, s[28:31], s46 offen lds
    v_mfma_f32_32x32x16_bf16 v[144:159], v[100:103], v[48:51], v[144:159]
    s_add_u32 m0, s44, 1024
    s_add_u32 s46, s40, s53
    s_add_u32 s46, s46, 32768
    buffer_load_dwordx4 v3, s[28:31], s46 offen lds
    s_waitcnt lgkmcnt(2)
    v_mfma_f32_32x32x16_bf16 v[160:175], v[96:99], v[52:55], v[160:175]
    s_add_u32 m0, s44, 2048
    s_add_u32 s46, s40, s53
    s_add_u32 s46, s46, 65536
    buffer_load_dwordx4 v2, s[28:31], s46 offen lds
    v_mfma_f32_32x32x16_bf16 v[176:191], v[100:103], v[52:55], v[176:191]
    s_add_u32 m0, s44, 3072
    s_add_u32 s46, s40, s53
    s_add_u32 s46, s46, 98304
    buffer_load_dwordx4 v3, s[28:31], s46 offen lds
    s_waitcnt lgkmcnt(1)
    v_mfma_f32_32x32x16_bf16 v[128:143], v[104:107], v[56:59], v[128:143]
    ds_read_b128 v[48:51], v6 offset:8192
    ds_read_b128 v[52:55], v6 offset:12288
    s_add_u32 m0, s44, 4096
    s_add_u32 s46, s41, s53
    buffer_load_dwordx4 v2, s[28:31], s46 offen lds
    v_mfma_f32_32x32x16_bf16 v[144:159], v[108:111], v[56:59], v[144:159]
    s_add_u32 m0, s44, 5120
    s_add_u32 s46, s41, s53
    s_add_u32 s46, s46, 32768
    buffer_load_dwordx4 v3, s[28:31], s46 offen lds
    s_waitcnt lgkmcnt(2)
    v_mfma_f32_32x32x16_bf16 v[160:175], v[104:107], v[60:63], v[160:175]
    s_add_u32 m0, s44, 6144
    s_add_u32 s46, s41, s53
    s_add_u32 s46, s46, 65536
    buffer_load_dwordx4 v2, s[28:31], s46 offen lds
    v_mfma_f32_32x32x16_bf16 v[176:191], v[108:111], v[60:63], v[176:191]
    s_add_u32 m0, s44, 7168
    s_add_u32 s46, s41, s53
    s_add_u32 s46, s46, 98304
    buffer_load_dwordx4 v3, s[28:31], s46 offen lds
    s_waitcnt lgkmcnt(1)
    v_mfma_f32_32x32x16_bf16 v[128:143], v[112:115], v[48:51], v[128:143]
    ds_read_b128 v[56:59], v7 offset:8192
    ds_read_b128 v[60:63], v7 offset:12288
    v_mfma_f32_32x32x16_bf16 v[144:159], v[116:119], v[48:51], v[144:159]
    s_add_u32 s47, s55, 4096
    buffer_load_dwordx4 v[80:83], v1, s[24:27], s47 offen offset:0
    s_waitcnt lgkmcnt(2)
    v_mfma_f32_32x32x16_bf16 v[160:175], v[112:115], v[52:55], v[160:175]
    v_mfma_f32_32x32x16_bf16 v[176:191], v[116:119], v[52:55], v[176:191]
    s_add_u32 s47, s55, 4096
    buffer_load_dwordx4 v[84:87], v1, s[24:27], s47 offen offset:1024
    s_waitcnt lgkmcnt(1)
    v_mfma_f32_32x32x16_bf16 v[128:143], v[120:123], v[56:59], v[128:143]
    s_waitcnt vmcnt(14)
    ds_read_b128 v[48:51], v4 offset:16384
    ds_read_b128 v[52:55], v4 offset:20480
    v_mfma_f32_32x32x16_bf16 v[144:159], v[124:127], v[56:59], v[144:159]
    s_add_u32 s47, s55, 4096
    buffer_load_dwordx4 v[88:91], v1, s[24:27], s47 offen offset:2048
    s_waitcnt lgkmcnt(2)
    v_mfma_f32_32x32x16_bf16 v[160:175], v[120:123], v[60:63], v[160:175]
    v_mfma_f32_32x32x16_bf16 v[176:191], v[124:127], v[60:63], v[176:191]
    s_add_u32 s47, s55, 4096
    buffer_load_dwordx4 v[92:95], v1, s[24:27], s47 offen offset:3072
    s_waitcnt vmcnt(15) lgkmcnt(1)
    v_mfma_f32_32x32x16_bf16 v[192:207], v[64:67], v[48:51], v[192:207]
    ds_read_b128 v[56:59], v5 offset:16384
    ds_read_b128 v[60:63], v5 offset:20480
    s_add_u32 s57, s52, 5
    s_and_b32 s57, s57, 7
    s_lshl_b32 s54, s57, 9
    s_lshl_b32 s57, s57, 15
    s_add_u32 s56, s57, s45
    s_add_u32 m0, s44, 8192
    s_add_u32 s46, s42, s54
    buffer_load_dwordx4 v2, s[28:31], s46 offen lds
    s_waitcnt vmcnt(15)
    v_mfma_f32_32x32x16_bf16 v[208:223], v[68:71], v[48:51], v[208:223]
    s_add_u32 m0, s44, 9216
    s_add_u32 s46, s42, s54
    s_add_u32 s46, s46, 32768
    buffer_load_dwordx4 v3, s[28:31], s46 offen lds
    s_waitcnt lgkmcnt(2)
    v_mfma_f32_32x32x16_bf16 v[224:239], v[64:67], v[52:55], v[224:239]
    s_add_u32 m0, s44, 10240
    s_add_u32 s46, s42, s54
    s_add_u32 s46, s46, 65536
    buffer_load_dwordx4 v2, s[28:31], s46 offen lds
    v_mfma_f32_32x32x16_bf16 v[240:255], v[68:71], v[52:55], v[240:255]
    s_add_u32 m0, s44, 11264
    s_add_u32 s46, s42, s54
    s_add_u32 s46, s46, 98304
    buffer_load_dwordx4 v3, s[28:31], s46 offen lds
    s_waitcnt vmcnt(17) lgkmcnt(1)
    v_mfma_f32_32x32x16_bf16 v[192:207], v[72:75], v[56:59], v[192:207]
    ds_read_b128 v[48:51], v6 offset:16384
    ds_read_b128 v[52:55], v6 offset:20480
    s_add_u32 m0, s44, 12288
    s_add_u32 s46, s43, s54
    buffer_load_dwordx4 v2, s[28:31], s46 offen lds
    s_waitcnt vmcnt(17)
    v_mfma_f32_32x32x16_bf16 v[208:223], v[76:79], v[56:59], v[208:223]
    s_add_u32 m0, s44, 13312
    s_add_u32 s46, s43, s54
    s_add_u32 s46, s46, 32768
    buffer_load_dwordx4 v3, s[28:31], s46 offen lds
    s_waitcnt lgkmcnt(2)
    v_mfma_f32_32x32x16_bf16 v[224:239], v[72:75], v[60:63], v[224:239]
    s_add_u32 m0, s44, 14336
    s_add_u32 s46, s43, s54
    s_add_u32 s46, s46, 65536
    buffer_load_dwordx4 v2, s[28:31], s46 offen lds
    v_mfma_f32_32x32x16_bf16 v[240:255], v[76:79], v[60:63], v[240:255]
    s_add_u32 m0, s44, 15360
    s_add_u32 s46, s43, s54
    s_add_u32 s46, s46, 98304
    buffer_load_dwordx4 v3, s[28:31], s46 offen lds
    s_waitcnt vmcnt(11) lgkmcnt(1)
    v_mfma_f32_32x32x16_bf16 v[192:207], v[80:83], v[48:51], v[192:207]
    ds_read_b128 v[56:59], v7 offset:16384
    ds_read_b128 v[60:63], v7 offset:20480
    s_waitcnt vmcnt(10)
    v_mfma_f32_32x32x16_bf16 v[208:223], v[84:87], v[48:51], v[208:223]
    s_add_u32 s47, s56, 0
    buffer_load_dwordx4 v[96:99], v1, s[24:27], s47 offen offset:0
    s_waitcnt lgkmcnt(2)
    v_mfma_f32_32x32x16_bf16 v[224:239], v[80:83], v[52:55], v[224:239]
    v_mfma_f32_32x32x16_bf16 v[240:255], v[84:87], v[52:55], v[240:255]
    s_add_u32 s47, s56, 0
    buffer_load_dwordx4 v[100:103], v1, s[24:27], s47 offen offset:1024
    s_waitcnt vmcnt(11) lgkmcnt(1)
    v_mfma_f32_32x32x16_bf16 v[192:207], v[88:91], v[56:59], v[192:207]
    ds_read_b128 v[48:51], v4 offset:0
    ds_read_b128 v[52:55], v4 offset:4096
    s_waitcnt vmcnt(10)
    v_mfma_f32_32x32x16_bf16 v[208:223], v[92:95], v[56:59], v[208:223]
    s_add_u32 s47, s56, 0
    buffer_load_dwordx4 v[104:107], v1, s[24:27], s47 offen offset:2048
    s_waitcnt lgkmcnt(2)
    v_mfma_f32_32x32x16_bf16 v[224:239], v[88:91], v[60:63], v[224:239]
    v_mfma_f32_32x32x16_bf16 v[240:255], v[92:95], v[60:63], v[240:255]
    s_add_u32 s47, s56, 0
    buffer_load_dwordx4 v[108:111], v1, s[24:27], s47 offen offset:3072
    s_waitcnt lgkmcnt(1)
    v_mfma_f32_32x32x16_bf16 v[128:143], v[64:67], v[48:51], v[128:143]
    ds_read_b128 v[56:59], v5 offset:0
    ds_read_b128 v[60:63], v5 offset:4096
    s_add_u32 m0, s44, 16384
    s_add_u32 s46, s40, s54
    buffer_load_dwordx4 v2, s[28:31], s46 offen lds
    v_mfma_f32_32x32x16_bf16 v[144:159], v[68:71], v[48:51], v[144:159]
    s_add_u32 m0, s44, 17408
    s_add_u32 s46, s40, s54
    s_add_u32 s46, s46, 32768
    buffer_load_dwordx4 v3, s[28:31], s46 offen lds
    s_waitcnt lgkmcnt(2)
    v_mfma_f32_32x32x16_bf16 v[160:175], v[64:67], v[52:55], v[160:175]
    s_add_u32 m0, s44, 18432
    s_add_u32 s46, s40, s54
    s_add_u32 s46, s46, 65536
    buffer_load_dwordx4 v2, s[28:31], s46 offen lds
    v_mfma_f32_32x32x16_bf16 v[176:191], v[68:71], v[52:55], v[176:191]
    s_add_u32 m0, s44, 19456
    s_add_u32 s46, s40, s54
    s_add_u32 s46, s46, 98304
    buffer_load_dwordx4 v3, s[28:31], s46 offen lds
    s_waitcnt lgkmcnt(1)
    v_mfma_f32_32x32x16_bf16 v[128:143], v[72:75], v[56:59], v[128:143]
    ds_read_b128 v[48:51], v6 offset:0
    ds_read_b128 v[52:55], v6 offset:4096
    s_add_u32 m0, s44, 20480
    s_add_u32 s46, s41, s54
    buffer_load_dwordx4 v2, s[28:31], s46 offen lds
    v_mfma_f32_32x32x16_bf16 v[144:159], v[76:79], v[56:59], v[144:159]
    s_add_u32 m0, s44, 21504
    s_add_u32 s46, s41, s54
    s_add_u32 s46, s46, 32768
    buffer_load_dwordx4 v3, s[28:31], s46 offen lds
    s_waitcnt lgkmcnt(2)
    v_mfma_f32_32x32x16_bf16 v[160:175], v[72:75], v[60:63], v[160:175]
    s_add_u32 m0, s44, 22528
    s_add_u32 s46, s41, s54
    s_add_u32 s46, s46, 65536
    buffer_load_dwordx4 v2, s[28:31], s46 offen lds
    v_mfma_f32_32x32x16_bf16 v[176:191], v[76:79], v[60:63], v[176:191]
    s_add_u32 m0, s44, 23552
    s_add_u32 s46, s41, s54
    s_add_u32 s46, s46, 98304
    buffer_load_dwordx4 v3, s[28:31], s46 offen lds
    s_waitcnt lgkmcnt(1)
    v_mfma_f32_32x32x16_bf16 v[128:143], v[80:83], v[48:51], v[128:143]
    ds_read_b128 v[56:59], v7 offset:0
    ds_read_b128 v[60:63], v7 offset:4096
    v_mfma_f32_32x32x16_bf16 v[144:159], v[84:87], v[48:51], v[144:159]
    s_add_u32 s47, s56, 4096
    buffer_load_dwordx4 v[112:115], v1, s[24:27], s47 offen offset:0
    s_waitcnt lgkmcnt(2)
    v_mfma_f32_32x32x16_bf16 v[160:175], v[80:83], v[52:55], v[160:175]
    v_mfma_f32_32x32x16_bf16 v[176:191], v[84:87], v[52:55], v[176:191]
    s_add_u32 s47, s56, 4096
    buffer_load_dwordx4 v[116:119], v1, s[24:27], s47 offen offset:1024
    s_waitcnt lgkmcnt(1)
    v_mfma_f32_32x32x16_bf16 v[128:143], v[88:91], v[56:59], v[128:143]
    s_waitcnt vmcnt(14)
    ds_read_b128 v[48:51], v4 offset:8192
    ds_read_b128 v[52:55], v4 offset:12288
    v_mfma_f32_32x32x16_bf16 v[144:159], v[92:95], v[56:59], v[144:159]
    s_add_u32 s47, s56, 4096
    buffer_load_dwordx4 v[120:123], v1, s[24:27], s47 offen offset:2048
    s_waitcnt lgkmcnt(2)
    v_mfma_f32_32x32x16_bf16 v[160:175], v[88:91], v[60:63], v[160:175]
    v_mfma_f32_32x32x16_bf16 v[176:191], v[92:95], v[60:63], v[176:191]
    s_add_u32 s47, s56, 4096
    buffer_load_dwordx4 v[124:127], v1, s[24:27], s47 offen offset:3072
    s_waitcnt vmcnt(15) lgkmcnt(1)
    v_mfma_f32_32x32x16_bf16 v[192:207], v[96:99], v[48:51], v[192:207]
    ds_read_b128 v[56:59], v5 offset:8192
    ds_read_b128 v[60:63], v5 offset:12288
    s_add_u32 s57, s52, 6
    s_and_b32 s57, s57, 7
    s_lshl_b32 s53, s57, 9
    s_lshl_b32 s57, s57, 15
    s_add_u32 s55, s57, s45
    s_add_u32 m0, s44, 0
    s_add_u32 s46, s42, s53
    buffer_load_dwordx4 v2, s[28:31], s46 offen lds
    s_waitcnt vmcnt(15)
    v_mfma_f32_32x32x16_bf16 v[208:223], v[100:103], v[48:51], v[208:223]
    s_add_u32 m0, s44, 1024
    s_add_u32 s46, s42, s53
    s_add_u32 s46, s46, 32768
    buffer_load_dwordx4 v3, s[28:31], s46 offen lds
    s_waitcnt lgkmcnt(2)
    v_mfma_f32_32x32x16_bf16 v[224:239], v[96:99], v[52:55], v[224:239]
    s_add_u32 m0, s44, 2048
    s_add_u32 s46, s42, s53
    s_add_u32 s46, s46, 65536
    buffer_load_dwordx4 v2, s[28:31], s46 offen lds
    v_mfma_f32_32x32x16_bf16 v[240:255], v[100:103], v[52:55], v[240:255]
    s_add_u32 m0, s44, 3072
    s_add_u32 s46, s42, s53
    s_add_u32 s46, s46, 98304
    buffer_load_dwordx4 v3, s[28:31], s46 offen lds
    s_waitcnt vmcnt(17) lgkmcnt(1)
    v_mfma_f32_32x32x16_bf16 v[192:207], v[104:107], v[56:59], v[192:207]
    ds_read_b128 v[48:51], v6 offset:8192
    ds_read_b128 v[52:55], v6 offset:12288
    s_add_u32 m0, s44, 4096
    s_add_u32 s46, s43, s53
    buffer_load_dwordx4 v2, s[28:31], s46 offen lds
    s_waitcnt vmcnt(17)
    v_mfma_f32_32x32x16_bf16 v[208:223], v[108:111], v[56:59], v[208:223]
    s_add_u32 m0, s44, 5120
    s_add_u32 s46, s43, s53
    s_add_u32 s46, s46, 32768
    buffer_load_dwordx4 v3, s[28:31], s46 offen lds
    s_waitcnt lgkmcnt(2)
    v_mfma_f32_32x32x16_bf16 v[224:239], v[104:107], v[60:63], v[224:239]
    s_add_u32 m0, s44, 6144
    s_add_u32 s46, s43, s53
    s_add_u32 s46, s46, 65536
    buffer_load_dwordx4 v2, s[28:31], s46 offen lds
    v_mfma_f32_32x32x16_bf16 v[240:255], v[108:111], v[60:63], v[240:255]
    s_add_u32 m0, s44, 7168
    s_add_u32 s46, s43, s53
    s_add_u32 s46, s46, 98304
    buffer_load_dwordx4 v3, s[28:31], s46 offen lds
    s_waitcnt vmcnt(11) lgkmcnt(1)
    v_mfma_f32_32x32x16_bf16 v[192:207], v[112:115], v[48:51], v[192:207]
    ds_read_b128 v[56:59], v7 offset:8192
    ds_read_b128 v[60:63], v7 offset:12288
    s_waitcnt vmcnt(10)
    v_mfma_f32_32x32x16_bf16 v[208:223], v[116:119], v[48:51], v[208:223]
    s_add_u32 s47, s55, 0
    buffer_load_dwordx4 v[64:67], v1, s[24:27], s47 offen offset:0
    s_waitcnt lgkmcnt(2)
    v_mfma_f32_32x32x16_bf16 v[224:239], v[112:115], v[52:55], v[224:239]
    v_mfma_f32_32x32x16_bf16 v[240:255], v[116:119], v[52:55], v[240:255]
    s_add_u32 s47, s55, 0
    buffer_load_dwordx4 v[68:71], v1, s[24:27], s47 offen offset:1024
    s_waitcnt vmcnt(11) lgkmcnt(1)
    v_mfma_f32_32x32x16_bf16 v[192:207], v[120:123], v[56:59], v[192:207]
    ds_read_b128 v[48:51], v4 offset:16384
    ds_read_b128 v[52:55], v4 offset:20480
    s_waitcnt vmcnt(10)
    v_mfma_f32_32x32x16_bf16 v[208:223], v[124:127], v[56:59], v[208:223]
    s_add_u32 s47, s55, 0
    buffer_load_dwordx4 v[72:75], v1, s[24:27], s47 offen offset:2048
    s_waitcnt lgkmcnt(2)
    v_mfma_f32_32x32x16_bf16 v[224:239], v[120:123], v[60:63], v[224:239]
    v_mfma_f32_32x32x16_bf16 v[240:255], v[124:127], v[60:63], v[240:255]
    s_add_u32 s47, s55, 0
    buffer_load_dwordx4 v[76:79], v1, s[24:27], s47 offen offset:3072
    s_waitcnt lgkmcnt(1)
    v_mfma_f32_32x32x16_bf16 v[128:143], v[96:99], v[48:51], v[128:143]
    ds_read_b128 v[56:59], v5 offset:16384
    ds_read_b128 v[60:63], v5 offset:20480
    s_add_u32 m0, s44, 8192
    s_add_u32 s46, s40, s53
    buffer_load_dwordx4 v2, s[28:31], s46 offen lds
    v_mfma_f32_32x32x16_bf16 v[144:159], v[100:103], v[48:51], v[144:159]
    s_add_u32 m0, s44, 9216
    s_add_u32 s46, s40, s53
    s_add_u32 s46, s46, 32768
    buffer_load_dwordx4 v3, s[28:31], s46 offen lds
    s_waitcnt lgkmcnt(2)
    v_mfma_f32_32x32x16_bf16 v[160:175], v[96:99], v[52:55], v[160:175]
    s_add_u32 m0, s44, 10240
    s_add_u32 s46, s40, s53
    s_add_u32 s46, s46, 65536
    buffer_load_dwordx4 v2, s[28:31], s46 offen lds
    v_mfma_f32_32x32x16_bf16 v[176:191], v[100:103], v[52:55], v[176:191]
    s_add_u32 m0, s44, 11264
    s_add_u32 s46, s40, s53
    s_add_u32 s46, s46, 98304
    buffer_load_dwordx4 v3, s[28:31], s46 offen lds
    s_waitcnt lgkmcnt(1)
    v_mfma_f32_32x32x16_bf16 v[128:143], v[104:107], v[56:59], v[128:143]
    ds_read_b128 v[48:51], v6 offset:16384
    ds_read_b128 v[52:55], v6 offset:20480
    s_add_u32 m0, s44, 12288
    s_add_u32 s46, s41, s53
    buffer_load_dwordx4 v2, s[28:31], s46 offen lds
    v_mfma_f32_32x32x16_bf16 v[144:159], v[108:111], v[56:59], v[144:159]
    s_add_u32 m0, s44, 13312
    s_add_u32 s46, s41, s53
    s_add_u32 s46, s46, 32768
    buffer_load_dwordx4 v3, s[28:31], s46 offen lds
    s_waitcnt lgkmcnt(2)
    v_mfma_f32_32x32x16_bf16 v[160:175], v[104:107], v[60:63], v[160:175]
    s_add_u32 m0, s44, 14336
    s_add_u32 s46, s41, s53
    s_add_u32 s46, s46, 65536
    buffer_load_dwordx4 v2, s[28:31], s46 offen lds
    v_mfma_f32_32x32x16_bf16 v[176:191], v[108:111], v[60:63], v[176:191]
    s_add_u32 m0, s44, 15360
    s_add_u32 s46, s41, s53
    s_add_u32 s46, s46, 98304
    buffer_load_dwordx4 v3, s[28:31], s46 offen lds
    s_waitcnt lgkmcnt(1)
    v_mfma_f32_32x32x16_bf16 v[128:143], v[112:115], v[48:51], v[128:143]
    ds_read_b128 v[56:59], v7 offset:16384
    ds_read_b128 v[60:63], v7 offset:20480
    v_mfma_f32_32x32x16_bf16 v[144:159], v[116:119], v[48:51], v[144:159]
    s_add_u32 s47, s55, 4096
    buffer_load_dwordx4 v[80:83], v1, s[24:27], s47 offen offset:0
    s_waitcnt lgkmcnt(2)
    v_mfma_f32_32x32x16_bf16 v[160:175], v[112:115], v[52:55], v[160:175]
    v_mfma_f32_32x32x16_bf16 v[176:191], v[116:119], v[52:55], v[176:191]
    s_add_u32 s47, s55, 4096
    buffer_load_dwordx4 v[84:87], v1, s[24:27], s47 offen offset:1024
    s_waitcnt lgkmcnt(1)
    v_mfma_f32_32x32x16_bf16 v[128:143], v[120:123], v[56:59], v[128:143]
    s_waitcnt vmcnt(14)
    ds_read_b128 v[48:51], v4 offset:0
    ds_read_b128 v[52:55], v4 offset:4096
    v_mfma_f32_32x32x16_bf16 v[144:159], v[124:127], v[56:59], v[144:159]
    s_add_u32 s47, s55, 4096
    buffer_load_dwordx4 v[88:91], v1, s[24:27], s47 offen offset:2048
    s_waitcnt lgkmcnt(2)
    v_mfma_f32_32x32x16_bf16 v[160:175], v[120:123], v[60:63], v[160:175]
    v_mfma_f32_32x32x16_bf16 v[176:191], v[124:127], v[60:63], v[176:191]
    s_add_u32 s47, s55, 4096
    buffer_load_dwordx4 v[92:95], v1, s[24:27], s47 offen offset:3072
    s_waitcnt vmcnt(15) lgkmcnt(1)
    v_mfma_f32_32x32x16_bf16 v[192:207], v[64:67], v[48:51], v[192:207]
    ds_read_b128 v[56:59], v5 offset:0
    ds_read_b128 v[60:63], v5 offset:4096
    s_add_u32 s57, s52, 7
    s_and_b32 s57, s57, 7
    s_lshl_b32 s54, s57, 9
    s_lshl_b32 s57, s57, 15
    s_add_u32 s56, s57, s45
    s_add_u32 m0, s44, 16384
    s_add_u32 s46, s42, s54
    buffer_load_dwordx4 v2, s[28:31], s46 offen lds
    s_waitcnt vmcnt(15)
    v_mfma_f32_32x32x16_bf16 v[208:223], v[68:71], v[48:51], v[208:223]
    s_add_u32 m0, s44, 17408
    s_add_u32 s46, s42, s54
    s_add_u32 s46, s46, 32768
    buffer_load_dwordx4 v3, s[28:31], s46 offen lds
    s_waitcnt lgkmcnt(2)
    v_mfma_f32_32x32x16_bf16 v[224:239], v[64:67], v[52:55], v[224:239]
    s_add_u32 m0, s44, 18432
    s_add_u32 s46, s42, s54
    s_add_u32 s46, s46, 65536
    buffer_load_dwordx4 v2, s[28:31], s46 offen lds
    v_mfma_f32_32x32x16_bf16 v[240:255], v[68:71], v[52:55], v[240:255]
    s_add_u32 m0, s44, 19456
    s_add_u32 s46, s42, s54
    s_add_u32 s46, s46, 98304
    buffer_load_dwordx4 v3, s[28:31], s46 offen lds
    s_waitcnt vmcnt(17) lgkmcnt(1)
    v_mfma_f32_32x32x16_bf16 v[192:207], v[72:75], v[56:59], v[192:207]
    ds_read_b128 v[48:51], v6 offset:0
    ds_read_b128 v[52:55], v6 offset:4096
    s_add_u32 m0, s44, 20480
    s_add_u32 s46, s43, s54
    buffer_load_dwordx4 v2, s[28:31], s46 offen lds
    s_waitcnt vmcnt(17)
    v_mfma_f32_32x32x16_bf16 v[208:223], v[76:79], v[56:59], v[208:223]
    s_add_u32 m0, s44, 21504
    s_add_u32 s46, s43, s54
    s_add_u32 s46, s46, 32768
    buffer_load_dwordx4 v3, s[28:31], s46 offen lds
    s_waitcnt lgkmcnt(2)
    v_mfma_f32_32x32x16_bf16 v[224:239], v[72:75], v[60:63], v[224:239]
    s_add_u32 m0, s44, 22528
    s_add_u32 s46, s43, s54
    s_add_u32 s46, s46, 65536
    buffer_load_dwordx4 v2, s[28:31], s46 offen lds
    v_mfma_f32_32x32x16_bf16 v[240:255], v[76:79], v[60:63], v[240:255]
    s_add_u32 m0, s44, 23552
    s_add_u32 s46, s43, s54
    s_add_u32 s46, s46, 98304
    buffer_load_dwordx4 v3, s[28:31], s46 offen lds
    s_waitcnt vmcnt(11) lgkmcnt(1)
    v_mfma_f32_32x32x16_bf16 v[192:207], v[80:83], v[48:51], v[192:207]
    ds_read_b128 v[56:59], v7 offset:0
    ds_read_b128 v[60:63], v7 offset:4096
    s_waitcnt vmcnt(10)
    v_mfma_f32_32x32x16_bf16 v[208:223], v[84:87], v[48:51], v[208:223]
    s_add_u32 s47, s56, 0
    buffer_load_dwordx4 v[96:99], v1, s[24:27], s47 offen offset:0
    s_waitcnt lgkmcnt(2)
    v_mfma_f32_32x32x16_bf16 v[224:239], v[80:83], v[52:55], v[224:239]
    v_mfma_f32_32x32x16_bf16 v[240:255], v[84:87], v[52:55], v[240:255]
    s_add_u32 s47, s56, 0
    buffer_load_dwordx4 v[100:103], v1, s[24:27], s47 offen offset:1024
    s_waitcnt vmcnt(11) lgkmcnt(1)
    v_mfma_f32_32x32x16_bf16 v[192:207], v[88:91], v[56:59], v[192:207]
    ds_read_b128 v[48:51], v4 offset:8192
    ds_read_b128 v[52:55], v4 offset:12288
    s_waitcnt vmcnt(10)
    v_mfma_f32_32x32x16_bf16 v[208:223], v[92:95], v[56:59], v[208:223]
    s_add_u32 s47, s56, 0
    buffer_load_dwordx4 v[104:107], v1, s[24:27], s47 offen offset:2048
    s_waitcnt lgkmcnt(2)
    v_mfma_f32_32x32x16_bf16 v[224:239], v[88:91], v[60:63], v[224:239]
    v_mfma_f32_32x32x16_bf16 v[240:255], v[92:95], v[60:63], v[240:255]
    s_add_u32 s47, s56, 0
    buffer_load_dwordx4 v[108:111], v1, s[24:27], s47 offen offset:3072
    s_waitcnt lgkmcnt(1)
    v_mfma_f32_32x32x16_bf16 v[128:143], v[64:67], v[48:51], v[128:143]
    ds_read_b128 v[56:59], v5 offset:8192
    ds_read_b128 v[60:63], v5 offset:12288
    s_add_u32 m0, s44, 0
    s_add_u32 s46, s40, s54
    buffer_load_dwordx4 v2, s[28:31], s46 offen lds
    v_mfma_f32_32x32x16_bf16 v[144:159], v[68:71], v[48:51], v[144:159]
    s_add_u32 m0, s44, 1024
    s_add_u32 s46, s40, s54
    s_add_u32 s46, s46, 32768
    buffer_load_dwordx4 v3, s[28:31], s46 offen lds
    s_waitcnt lgkmcnt(2)
    v_mfma_f32_32x32x16_bf16 v[160:175], v[64:67], v[52:55], v[160:175]
    s_add_u32 m0, s44, 2048
    s_add_u32 s46, s40, s54
    s_add_u32 s46, s46, 65536
    buffer_load_dwordx4 v2, s[28:31], s46 offen lds
    v_mfma_f32_32x32x16_bf16 v[176:191], v[68:71], v[52:55], v[176:191]
    s_add_u32 m0, s44, 3072
    s_add_u32 s46, s40, s54
    s_add_u32 s46, s46, 98304
    buffer_load_dwordx4 v3, s[28:31], s46 offen lds
    s_waitcnt lgkmcnt(1)
    v_mfma_f32_32x32x16_bf16 v[128:143], v[72:75], v[56:59], v[128:143]
    ds_read_b128 v[48:51], v6 offset:8192
    ds_read_b128 v[52:55], v6 offset:12288
    s_add_u32 m0, s44, 4096
    s_add_u32 s46, s41, s54
    buffer_load_dwordx4 v2, s[28:31], s46 offen lds
    v_mfma_f32_32x32x16_bf16 v[144:159], v[76:79], v[56:59], v[144:159]
    s_add_u32 m0, s44, 5120
    s_add_u32 s46, s41, s54
    s_add_u32 s46, s46, 32768
    buffer_load_dwordx4 v3, s[28:31], s46 offen lds
    s_waitcnt lgkmcnt(2)
    v_mfma_f32_32x32x16_bf16 v[160:175], v[72:75], v[60:63], v[160:175]
    s_add_u32 m0, s44, 6144
    s_add_u32 s46, s41, s54
    s_add_u32 s46, s46, 65536
    buffer_load_dwordx4 v2, s[28:31], s46 offen lds
    v_mfma_f32_32x32x16_bf16 v[176:191], v[76:79], v[60:63], v[176:191]
    s_add_u32 m0, s44, 7168
    s_add_u32 s46, s41, s54
    s_add_u32 s46, s46, 98304
    buffer_load_dwordx4 v3, s[28:31], s46 offen lds
    s_waitcnt lgkmcnt(1)
    v_mfma_f32_32x32x16_bf16 v[128:143], v[80:83], v[48:51], v[128:143]
    ds_read_b128 v[56:59], v7 offset:8192
    ds_read_b128 v[60:63], v7 offset:12288
    v_mfma_f32_32x32x16_bf16 v[144:159], v[84:87], v[48:51], v[144:159]
    s_add_u32 s47, s56, 4096
    buffer_load_dwordx4 v[112:115], v1, s[24:27], s47 offen offset:0
    s_waitcnt lgkmcnt(2)
    v_mfma_f32_32x32x16_bf16 v[160:175], v[80:83], v[52:55], v[160:175]
    v_mfma_f32_32x32x16_bf16 v[176:191], v[84:87], v[52:55], v[176:191]
    s_add_u32 s47, s56, 4096
    buffer_load_dwordx4 v[116:119], v1, s[24:27], s47 offen offset:1024
    s_waitcnt lgkmcnt(1)
    v_mfma_f32_32x32x16_bf16 v[128:143], v[88:91], v[56:59], v[128:143]
    s_waitcnt vmcnt(14)
    ds_read_b128 v[48:51], v4 offset:16384
    ds_read_b128 v[52:55], v4 offset:20480
    v_mfma_f32_32x32x16_bf16 v[144:159], v[92:95], v[56:59], v[144:159]
    s_add_u32 s47, s56, 4096
    buffer_load_dwordx4 v[120:123], v1, s[24:27], s47 offen offset:2048
    s_waitcnt lgkmcnt(2)
    v_mfma_f32_32x32x16_bf16 v[160:175], v[88:91], v[60:63], v[160:175]
    v_mfma_f32_32x32x16_bf16 v[176:191], v[92:95], v[60:63], v[176:191]
    s_add_u32 s47, s56, 4096
    buffer_load_dwordx4 v[124:127], v1, s[24:27], s47 offen offset:3072
    s_waitcnt vmcnt(15) lgkmcnt(1)
    v_mfma_f32_32x32x16_bf16 v[192:207], v[96:99], v[48:51], v[192:207]
    ds_read_b128 v[56:59], v5 offset:16384
    ds_read_b128 v[60:63], v5 offset:20480
    s_waitcnt vmcnt(14)
    v_mfma_f32_32x32x16_bf16 v[208:223], v[100:103], v[48:51], v[208:223]
    s_waitcnt lgkmcnt(2)
    v_mfma_f32_32x32x16_bf16 v[224:239], v[96:99], v[52:55], v[224:239]
    s_lshl_b32 s46, s19, 2
    s_add_u32 s46, s46, s16
    s_mul_i32 s47, s46, 57344
    s_lshl_b32 s48, s20, 12
    s_add_u32 s47, s47, s48
    s_add_u32 s47, s47, 6291456
    buffer_load_dwordx4 v[16:19], v1, s[24:27], s47 offen offset:0
    buffer_load_dwordx4 v[20:23], v1, s[24:27], s47 offen offset:1024
    buffer_load_dwordx4 v[24:27], v1, s[24:27], s47 offen offset:2048
    buffer_load_dwordx4 v[28:31], v1, s[24:27], s47 offen offset:3072
    v_and_b32 v8, 31, v0
    v_lshlrev_b32 v8, 1, v8
    s_lshl_b32 s48, s46, 6
    buffer_load_ushort v9, v8, s[32:35], s48 offen
    v_mfma_f32_32x32x16_bf16 v[240:255], v[100:103], v[52:55], v[240:255]
    s_waitcnt vmcnt(18) lgkmcnt(1)
    v_mfma_f32_32x32x16_bf16 v[192:207], v[104:107], v[56:59], v[192:207]
    ds_read_b128 v[48:51], v6 offset:16384
    ds_read_b128 v[52:55], v6 offset:20480
    s_waitcnt vmcnt(17)
    v_mfma_f32_32x32x16_bf16 v[208:223], v[108:111], v[56:59], v[208:223]
    s_waitcnt lgkmcnt(2)
    v_mfma_f32_32x32x16_bf16 v[224:239], v[104:107], v[60:63], v[224:239]
    v_mfma_f32_32x32x16_bf16 v[240:255], v[108:111], v[60:63], v[240:255]
    s_waitcnt vmcnt(8) lgkmcnt(1)
    v_mfma_f32_32x32x16_bf16 v[192:207], v[112:115], v[48:51], v[192:207]
    ds_read_b128 v[56:59], v7 offset:16384
    ds_read_b128 v[60:63], v7 offset:20480
    s_waitcnt vmcnt(7)
    v_mfma_f32_32x32x16_bf16 v[208:223], v[116:119], v[48:51], v[208:223]
    s_waitcnt lgkmcnt(2)
    v_mfma_f32_32x32x16_bf16 v[224:239], v[112:115], v[52:55], v[224:239]
    v_mfma_f32_32x32x16_bf16 v[240:255], v[116:119], v[52:55], v[240:255]
    s_waitcnt vmcnt(6) lgkmcnt(1)
    v_mfma_f32_32x32x16_bf16 v[192:207], v[120:123], v[56:59], v[192:207]
    ds_read_b128 v[48:51], v4 offset:0
    ds_read_b128 v[52:55], v4 offset:4096
    s_waitcnt vmcnt(5)
    v_mfma_f32_32x32x16_bf16 v[208:223], v[124:127], v[56:59], v[208:223]
    s_waitcnt lgkmcnt(2)
    v_mfma_f32_32x32x16_bf16 v[224:239], v[120:123], v[60:63], v[224:239]
    v_mfma_f32_32x32x16_bf16 v[240:255], v[124:127], v[60:63], v[240:255]
    s_waitcnt lgkmcnt(1)
    v_mfma_f32_32x32x16_bf16 v[128:143], v[96:99], v[48:51], v[128:143]
    ds_read_b128 v[56:59], v5 offset:0
    ds_read_b128 v[60:63], v5 offset:4096
    v_mfma_f32_32x32x16_bf16 v[144:159], v[100:103], v[48:51], v[144:159]
    s_waitcnt lgkmcnt(2)
    v_mfma_f32_32x32x16_bf16 v[160:175], v[96:99], v[52:55], v[160:175]
    v_mfma_f32_32x32x16_bf16 v[176:191], v[100:103], v[52:55], v[176:191]
    s_waitcnt lgkmcnt(1)
    v_mfma_f32_32x32x16_bf16 v[128:143], v[104:107], v[56:59], v[128:143]
    ds_read_b128 v[48:51], v6 offset:0
    ds_read_b128 v[52:55], v6 offset:4096
    v_add_u32 v2, s44, v1
    ds_write_b128 v2, v[192:195] offset:8192
    v_mfma_f32_32x32x16_bf16 v[144:159], v[108:111], v[56:59], v[144:159]
    ds_write_b128 v2, v[196:199] offset:9216
    s_waitcnt lgkmcnt(4)
    v_mfma_f32_32x32x16_bf16 v[160:175], v[104:107], v[60:63], v[160:175]
    ds_write_b128 v2, v[200:203] offset:10240
    ds_write_b128 v2, v[204:207] offset:11264
    v_mfma_f32_32x32x16_bf16 v[176:191], v[108:111], v[60:63], v[176:191]
    ds_write_b128 v2, v[208:211] offset:12288
    s_waitcnt lgkmcnt(6)
    v_mfma_f32_32x32x16_bf16 v[128:143], v[112:115], v[48:51], v[128:143]
    ds_read_b128 v[56:59], v7 offset:0
    ds_read_b128 v[60:63], v7 offset:4096
    ds_write_b128 v2, v[212:215] offset:13312
    v_mfma_f32_32x32x16_bf16 v[144:159], v[116:119], v[48:51], v[144:159]
    ds_write_b128 v2, v[216:219] offset:14336
    ds_write_b128 v2, v[220:223] offset:15360
    s_waitcnt lgkmcnt(10)
    v_mfma_f32_32x32x16_bf16 v[160:175], v[112:115], v[52:55], v[160:175]
    ds_write_b128 v2, v[224:227] offset:16384
    v_mfma_f32_32x32x16_bf16 v[176:191], v[116:119], v[52:55], v[176:191]
    ds_write_b128 v2, v[228:231] offset:17408
    s_waitcnt lgkmcnt(6)
    v_mfma_f32_32x32x16_bf16 v[128:143], v[120:123], v[56:59], v[128:143]
    ds_write_b128 v2, v[232:235] offset:18432
    ds_write_b128 v2, v[236:239] offset:19456
    v_mfma_f32_32x32x16_bf16 v[144:159], v[124:127], v[56:59], v[144:159]
    ds_write_b128 v2, v[240:243] offset:20480
    s_waitcnt lgkmcnt(8)
    v_mfma_f32_32x32x16_bf16 v[160:175], v[120:123], v[60:63], v[160:175]
    ds_write_b128 v2, v[244:247] offset:21504
    v_mfma_f32_32x32x16_bf16 v[176:191], v[124:127], v[60:63], v[176:191]
    ds_write_b128 v2, v[248:251] offset:22528
    ds_write_b128 v2, v[252:255] offset:23552
    v_add_u32 v2, s44, v1
    s_nop 6
    ds_write_b128 v2, v[160:163] offset:0
    ds_write_b128 v2, v[164:167] offset:1024
    ds_write_b128 v2, v[168:171] offset:2048
    ds_write_b128 v2, v[172:175] offset:3072
    ds_write_b128 v2, v[176:179] offset:4096
    ds_write_b128 v2, v[180:183] offset:5120
    ds_write_b128 v2, v[184:187] offset:6144
    ds_write_b128 v2, v[188:191] offset:7168
    s_waitcnt lgkmcnt(0)
    v_mov_b32 v12, 151556
    v_mov_b32 v13, 1
    s_mov_b64 exec, 1
    ds_add_u32 v12, v13
    s_mov_b64 exec, -1
B_SYNC:
    ds_read_b32 v13, v12
    s_waitcnt lgkmcnt(0)
    v_readfirstlane_b32 s61, v13
    s_nop 0
    s_cmp_lt_u32 s61, 4
    s_cbranch_scc1 B_SYNC
    s_sub_u32 s47, s16, 1
    s_and_b32 s47, s47, 3
    s_mul_i32 s47, s47, 24576
    s_add_u32 s47, s47, 0
    v_add_u32 v3, s47, v1
    s_sub_u32 s47, s16, 2
    s_and_b32 s47, s47, 3
    s_mul_i32 s47, s47, 24576
    s_add_u32 s47, s47, 8192
    v_add_u32 v4, s47, v1
    s_sub_u32 s47, s16, 3
    s_and_b32 s47, s47, 3
    s_mul_i32 s47, s47, 24576
    s_add_u32 s47, s47, 16384
    v_add_u32 v5, s47, v1
    ds_read_b128 v[32:35], v3 offset:0
    ds_read_b128 v[36:39], v3 offset:1024
    ds_read_b128 v[40:43], v3 offset:2048
    ds_read_b128 v[44:47], v3 offset:3072
    ds_read_b128 v[64:67], v4 offset:0
    ds_read_b128 v[68:71], v4 offset:1024
    ds_read_b128 v[72:75], v4 offset:2048
    ds_read_b128 v[76:79], v4 offset:3072
    ds_read_b128 v[96:99], v5 offset:0
    ds_read_b128 v[100:103], v5 offset:1024
    ds_read_b128 v[104:107], v5 offset:2048
    ds_read_b128 v[108:111], v5 offset:3072
    ds_read_b128 v[48:51], v3 offset:4096
    ds_read_b128 v[52:55], v3 offset:5120
    ds_read_b128 v[56:59], v3 offset:6144
    ds_read_b128 v[60:63], v3 offset:7168
    ds_read_b128 v[80:83], v4 offset:4096
    ds_read_b128 v[84:87], v4 offset:5120
    ds_read_b128 v[88:91], v4 offset:6144
    ds_read_b128 v[92:95], v4 offset:7168
    ds_read_b128 v[112:115], v5 offset:4096
    ds_read_b128 v[116:119], v5 offset:5120
    ds_read_b128 v[120:123], v5 offset:6144
    ds_read_b128 v[124:127], v5 offset:7168
    s_mul_i32 s47, s46, 90112
    s_lshl_b32 s48, s20, 12
    s_add_u32 s47, s47, s48
    s_add_u32 s47, s47, 14712832
    s_waitcnt vmcnt(0)
    v_lshlrev_b32 v8, 16, v9
    v_mov_b32 v9, v8
    s_waitcnt lgkmcnt(15)
    v_pk_add_f32 v[128:129], v[128:129], v[32:33]
    v_pk_add_f32 v[130:131], v[130:131], v[34:35]
    s_waitcnt lgkmcnt(15)
    v_pk_add_f32 v[132:133], v[132:133], v[36:37]
    v_pk_add_f32 v[134:135], v[134:135], v[38:39]
    s_waitcnt lgkmcnt(15)
    v_pk_add_f32 v[136:137], v[136:137], v[40:41]
    v_pk_add_f32 v[138:139], v[138:139], v[42:43]
    s_waitcnt lgkmcnt(15)
    v_pk_add_f32 v[140:141], v[140:141], v[44:45]
    v_pk_add_f32 v[142:143], v[142:143], v[46:47]
    s_waitcnt lgkmcnt(15)
    v_pk_add_f32 v[64:65], v[64:65], v[96:97]
    v_pk_add_f32 v[66:67], v[66:67], v[98:99]
    s_waitcnt lgkmcnt(14)
    v_pk_add_f32 v[68:69], v[68:69], v[100:101]
    v_pk_add_f32 v[70:71], v[70:71], v[102:103]
    s_waitcnt lgkmcnt(13)
    v_pk_add_f32 v[72:73], v[72:73], v[104:105]
    v_pk_add_f32 v[74:75], v[74:75], v[106:107]
    s_waitcnt lgkmcnt(12)
    v_pk_add_f32 v[76:77], v[76:77], v[108:109]
    v_pk_add_f32 v[78:79], v[78:79], v[110:111]
    v_pk_add_f32 v[128:129], v[128:129], v[8:9]
    v_pk_add_f32 v[130:131], v[130:131], v[8:9]
    v_pk_add_f32 v[132:133], v[132:133], v[8:9]
    v_pk_add_f32 v[134:135], v[134:135], v[8:9]
    v_pk_add_f32 v[136:137], v[136:137], v[8:9]
    v_pk_add_f32 v[138:139], v[138:139], v[8:9]
    v_pk_add_f32 v[140:141], v[140:141], v[8:9]
    v_pk_add_f32 v[142:143], v[142:143], v[8:9]
    v_pk_add_f32 v[128:129], v[128:129], v[64:65]
    v_pk_add_f32 v[130:131], v[130:131], v[66:67]
    v_pk_add_f32 v[132:133], v[132:133], v[68:69]
    v_pk_add_f32 v[134:135], v[134:135], v[70:71]
    v_pk_add_f32 v[136:137], v[136:137], v[72:73]
    v_pk_add_f32 v[138:139], v[138:139], v[74:75]
    v_pk_add_f32 v[140:141], v[140:141], v[76:77]
    v_pk_add_f32 v[142:143], v[142:143], v[78:79]
    v_lshlrev_b32 v32, 16, v16
    v_and_b32 v33, 0xffff0000, v16
    v_lshlrev_b32 v34, 16, v17
    v_and_b32 v35, 0xffff0000, v17
    v_lshlrev_b32 v36, 16, v18
    v_and_b32 v37, 0xffff0000, v18
    v_lshlrev_b32 v38, 16, v19
    v_and_b32 v39, 0xffff0000, v19
    v_lshlrev_b32 v40, 16, v20
    v_and_b32 v41, 0xffff0000, v20
    v_lshlrev_b32 v42, 16, v21
    v_and_b32 v43, 0xffff0000, v21
    v_lshlrev_b32 v44, 16, v22
    v_and_b32 v45, 0xffff0000, v22
    v_lshlrev_b32 v46, 16, v23
    v_and_b32 v47, 0xffff0000, v23
    v_pk_mul_f32 v[128:129], v[128:129], v[32:33]
    v_pk_mul_f32 v[130:131], v[130:131], v[34:35]
    v_pk_mul_f32 v[132:133], v[132:133], v[36:37]
    v_pk_mul_f32 v[134:135], v[134:135], v[38:39]
    v_pk_mul_f32 v[136:137], v[136:137], v[40:41]
    v_pk_mul_f32 v[138:139], v[138:139], v[42:43]
    v_pk_mul_f32 v[140:141], v[140:141], v[44:45]
    v_pk_mul_f32 v[142:143], v[142:143], v[46:47]
    v_cvt_pk_bf16_f32 v96, v128, v129
    v_cvt_pk_bf16_f32 v97, v130, v131
    v_cvt_pk_bf16_f32 v98, v132, v133
    v_cvt_pk_bf16_f32 v99, v134, v135
    v_cvt_pk_bf16_f32 v100, v136, v137
    v_cvt_pk_bf16_f32 v101, v138, v139
    v_cvt_pk_bf16_f32 v102, v140, v141
    v_cvt_pk_bf16_f32 v103, v142, v143
    buffer_store_dwordx4 v[96:99], v1, s[24:27], s47 offen offset:0 sc1
    buffer_store_dwordx4 v[100:103], v1, s[24:27], s47 offen offset:1024 sc1
    s_waitcnt lgkmcnt(11)
    v_pk_add_f32 v[144:145], v[144:145], v[48:49]
    v_pk_add_f32 v[146:147], v[146:147], v[50:51]
    s_waitcnt lgkmcnt(10)
    v_pk_add_f32 v[148:149], v[148:149], v[52:53]
    v_pk_add_f32 v[150:151], v[150:151], v[54:55]
    s_waitcnt lgkmcnt(9)
    v_pk_add_f32 v[152:153], v[152:153], v[56:57]
    v_pk_add_f32 v[154:155], v[154:155], v[58:59]
    s_waitcnt lgkmcnt(8)
    v_pk_add_f32 v[156:157], v[156:157], v[60:61]
    v_pk_add_f32 v[158:159], v[158:159], v[62:63]
    s_waitcnt lgkmcnt(3)
    v_pk_add_f32 v[80:81], v[80:81], v[112:113]
    v_pk_add_f32 v[82:83], v[82:83], v[114:115]
    s_waitcnt lgkmcnt(2)
    v_pk_add_f32 v[84:85], v[84:85], v[116:117]
    v_pk_add_f32 v[86:87], v[86:87], v[118:119]
    s_waitcnt lgkmcnt(1)
    v_pk_add_f32 v[88:89], v[88:89], v[120:121]
    v_pk_add_f32 v[90:91], v[90:91], v[122:123]
    s_waitcnt lgkmcnt(0)
    v_pk_add_f32 v[92:93], v[92:93], v[124:125]
    v_pk_add_f32 v[94:95], v[94:95], v[126:127]
    v_pk_add_f32 v[144:145], v[144:145], v[8:9]
    v_pk_add_f32 v[146:147], v[146:147], v[8:9]
    v_pk_add_f32 v[148:149], v[148:149], v[8:9]
    v_pk_add_f32 v[150:151], v[150:151], v[8:9]
    v_pk_add_f32 v[152:153], v[152:153], v[8:9]
    v_pk_add_f32 v[154:155], v[154:155], v[8:9]
    v_pk_add_f32 v[156:157], v[156:157], v[8:9]
    v_pk_add_f32 v[158:159], v[158:159], v[8:9]
    v_pk_add_f32 v[144:145], v[144:145], v[80:81]
    v_pk_add_f32 v[146:147], v[146:147], v[82:83]
    v_pk_add_f32 v[148:149], v[148:149], v[84:85]
    v_pk_add_f32 v[150:151], v[150:151], v[86:87]
    v_pk_add_f32 v[152:153], v[152:153], v[88:89]
    v_pk_add_f32 v[154:155], v[154:155], v[90:91]
    v_pk_add_f32 v[156:157], v[156:157], v[92:93]
    v_pk_add_f32 v[158:159], v[158:159], v[94:95]
    v_lshlrev_b32 v48, 16, v24
    v_and_b32 v49, 0xffff0000, v24
    v_lshlrev_b32 v50, 16, v25
    v_and_b32 v51, 0xffff0000, v25
    v_lshlrev_b32 v52, 16, v26
    v_and_b32 v53, 0xffff0000, v26
    v_lshlrev_b32 v54, 16, v27
    v_and_b32 v55, 0xffff0000, v27
    v_lshlrev_b32 v56, 16, v28
    v_and_b32 v57, 0xffff0000, v28
    v_lshlrev_b32 v58, 16, v29
    v_and_b32 v59, 0xffff0000, v29
    v_lshlrev_b32 v60, 16, v30
    v_and_b32 v61, 0xffff0000, v30
    v_lshlrev_b32 v62, 16, v31
    v_and_b32 v63, 0xffff0000, v31
    v_pk_mul_f32 v[144:145], v[144:145], v[48:49]
    v_pk_mul_f32 v[146:147], v[146:147], v[50:51]
    v_pk_mul_f32 v[148:149], v[148:149], v[52:53]
    v_pk_mul_f32 v[150:151], v[150:151], v[54:55]
    v_pk_mul_f32 v[152:153], v[152:153], v[56:57]
    v_pk_mul_f32 v[154:155], v[154:155], v[58:59]
    v_pk_mul_f32 v[156:157], v[156:157], v[60:61]
    v_pk_mul_f32 v[158:159], v[158:159], v[62:63]
    v_cvt_pk_bf16_f32 v112, v144, v145
    v_cvt_pk_bf16_f32 v113, v146, v147
    v_cvt_pk_bf16_f32 v114, v148, v149
    v_cvt_pk_bf16_f32 v115, v150, v151
    v_cvt_pk_bf16_f32 v116, v152, v153
    v_cvt_pk_bf16_f32 v117, v154, v155
    v_cvt_pk_bf16_f32 v118, v156, v157
    v_cvt_pk_bf16_f32 v119, v158, v159
    buffer_store_dwordx4 v[112:115], v1, s[24:27], s47 offen offset:2048 sc1
    buffer_store_dwordx4 v[116:119], v1, s[24:27], s47 offen offset:3072 sc1
    v_mov_b32 v12, 151560
    v_mov_b32 v13, 1
    s_mov_b64 exec, 1
    ds_add_u32 v12, v13
    s_mov_b64 exec, -1
    s_add_u32 s62, s20, 16
    s_waitcnt vmcnt(0)
    v_readfirstlane_b32 s15, v14
    s_lshl_b32 s64, s46, 9
    s_lshl_b32 s65, s62, 4
    s_add_u32 s64, s64, s65
    s_add_u32 s64, s64, 24182784
    v_mov_b32 v12, s15
    v_mov_b32 v13, 0
    s_mov_b64 exec, 1
    buffer_store_dword v12, v13, s[24:27], s64 offen sc1
    s_mov_b64 exec, -1
    s_mov_b32 s88, s10
    s_mov_b32 s89, s11
    s_mov_b32 s90, 1835008
    s_mov_b32 s91, 0x00020000
    s_mov_b32 s92, s12
    s_mov_b32 s93, s13
    s_mov_b32 s94, 1835008
    s_mov_b32 s95, 0x00020000
    s_mul_i32 s72, s21, 37
    s_lshr_b32 s72, s72, 8
    s_mul_i32 s73, s72, 7
    s_sub_u32 s67, s21, s73
    s_lshl_b32 s73, s22, 2
    s_add_u32 s66, s73, s72
    s_mul_i32 s80, s72, 3
    s_add_u32 s80, s80, s67
    s_sub_u32 s81, s80, 11
    s_cmp_ge_u32 s80, 11
    s_cselect_b32 s80, s81, s80
    s_mul_i32 s72, s67, 180224
    s_add_u32 s68, s72, 20971520
    s_mul_i32 s72, s66, 180224
    s_add_u32 s69, s72, 14680064
    s_mul_i32 s77, s23, 11
    s_lshl_b32 s72, s77, 10
    s_add_u32 s73, s68, s72
    s_mov_b32 s70, s73
    s_add_u32 s71, s70, 90112
    buffer_load_dwordx4 v[16:19], v1, s[24:27], s70 offen offset:0
    buffer_load_dwordx4 v[20:23], v1, s[24:27], s71 offen offset:0
    buffer_load_dwordx4 v[24:27], v1, s[24:27], s70 offen offset:1024
    buffer_load_dwordx4 v[28:31], v1, s[24:27], s71 offen offset:1024
    buffer_load_dwordx4 v[32:35], v1, s[24:27], s70 offen offset:2048
    buffer_load_dwordx4 v[36:39], v1, s[24:27], s71 offen offset:2048
    buffer_load_dwordx4 v[40:43], v1, s[24:27], s70 offen offset:3072
    buffer_load_dwordx4 v[44:47], v1, s[24:27], s71 offen offset:3072
    s_add_u32 s70, s70, 4096
    s_add_u32 s71, s71, 4096
    buffer_load_dwordx4 v[48:51], v1, s[24:27], s70 offen offset:0
    buffer_load_dwordx4 v[52:55], v1, s[24:27], s71 offen offset:0
    buffer_load_dwordx4 v[56:59], v1, s[24:27], s70 offen offset:1024
    buffer_load_dwordx4 v[60:63], v1, s[24:27], s71 offen offset:1024
    buffer_load_dwordx4 v[64:67], v1, s[24:27], s70 offen offset:2048
    buffer_load_dwordx4 v[68:71], v1, s[24:27], s71 offen offset:2048
    buffer_load_dwordx4 v[72:75], v1, s[24:27], s70 offen offset:3072
    buffer_load_dwordx4 v[76:79], v1, s[24:27], s71 offen offset:3072
    s_add_u32 s70, s70, 4096
    s_add_u32 s71, s71, 4096
    buffer_load_dwordx4 v[80:83], v1, s[24:27], s70 offen offset:0
    buffer_load_dwordx4 v[84:87], v1, s[24:27], s71 offen offset:0
    buffer_load_dwordx4 v[88:91], v1, s[24:27], s70 offen offset:1024
    buffer_load_dwordx4 v[92:95], v1, s[24:27], s71 offen offset:1024
    buffer_load_dwordx4 v[96:99], v1, s[24:27], s70 offen offset:2048
    buffer_load_dwordx4 v[100:103], v1, s[24:27], s71 offen offset:2048
    s_cmp_lg_u32 s23, 7
    s_cbranch_scc1 K2_FH
    s_lshl_b32 s72, s66, 10
    s_add_u32 s72, s72, 24182784
    v_lshlrev_b32 v3, 4, v0
    s_mov_b32 s74, 0x3fffffff
    s_mov_b32 s75, 0x3fffffff
    s_mov_b32 s76, 0
K2_GPOLL:
    buffer_load_dword v12, v3, s[24:27], s72 offen sc1
    s_waitcnt vmcnt(0)
    v_cmp_ne_u32 vcc, s15, v12
    s_nop 0
    s_and_b64 s[78:79], vcc, s[74:75]
    s_cmp_eq_u64 s[78:79], 0
    s_cbranch_scc1 K2_GPOLL_OK
    s_add_u32 s76, s76, 1
    s_cmp_lt_u32 s76, 0x40000
    s_cbranch_scc1 K2_GPOLL
K2_GPOLL_OK:
    s_branch K2_FH
K2_FH:
    s_barrier
    s_mul_i32 s77, s23, 11
    s_lshl_b32 s72, s77, 10
    s_add_u32 s73, s69, s72
    s_mov_b32 s70, s73
    s_add_u32 s71, s70, 90112
    buffer_load_dwordx4 v[104:107], v1, s[24:27], s70 offen offset:0 sc1
    buffer_load_dwordx4 v[108:111], v1, s[24:27], s71 offen offset:0 sc1
    buffer_load_dwordx4 v[112:115], v1, s[24:27], s70 offen offset:1024 sc1
    buffer_load_dwordx4 v[116:119], v1, s[24:27], s71 offen offset:1024 sc1
    buffer_load_dwordx4 v[120:123], v1, s[24:27], s70 offen offset:2048 sc1
    buffer_load_dwordx4 v[124:127], v1, s[24:27], s71 offen offset:2048 sc1
    buffer_load_dwordx4 v[128:131], v1, s[24:27], s70 offen offset:3072 sc1
    buffer_load_dwordx4 v[132:135], v1, s[24:27], s71 offen offset:3072 sc1
    s_add_u32 s70, s70, 4096
    s_add_u32 s71, s71, 4096
    buffer_load_dwordx4 v[136:139], v1, s[24:27], s70 offen offset:0 sc1
    buffer_load_dwordx4 v[140:143], v1, s[24:27], s71 offen offset:0 sc1
    buffer_load_dwordx4 v[144:147], v1, s[24:27], s70 offen offset:1024 sc1
    buffer_load_dwordx4 v[148:151], v1, s[24:27], s71 offen offset:1024 sc1
    buffer_load_dwordx4 v[152:155], v1, s[24:27], s70 offen offset:2048 sc1
    buffer_load_dwordx4 v[156:159], v1, s[24:27], s71 offen offset:2048 sc1
    buffer_load_dwordx4 v[160:163], v1, s[24:27], s70 offen offset:3072 sc1
    buffer_load_dwordx4 v[164:167], v1, s[24:27], s71 offen offset:3072 sc1
    s_add_u32 s70, s70, 4096
    s_add_u32 s71, s71, 4096
    buffer_load_dwordx4 v[168:171], v1, s[24:27], s70 offen offset:0 sc1
    buffer_load_dwordx4 v[172:175], v1, s[24:27], s71 offen offset:0 sc1
    buffer_load_dwordx4 v[176:179], v1, s[24:27], s70 offen offset:1024 sc1
    buffer_load_dwordx4 v[180:183], v1, s[24:27], s71 offen offset:1024 sc1
    buffer_load_dwordx4 v[184:187], v1, s[24:27], s70 offen offset:2048 sc1
    buffer_load_dwordx4 v[188:191], v1, s[24:27], s71 offen offset:2048 sc1
    v_lshrrev_b32 v3, 3, v0
    s_lshl_b32 s72, s66, 6
    s_lshl_b32 s73, s23, 3
    s_add_u32 s72, s72, s73
    v_add_u32 v3, s72, v3
    v_mul_u32_u24 v3, 896, v3
    v_and_b32 v2, 7, v0
    v_lshlrev_b32 v2, 4, v2
    s_lshl_b32 s73, s67, 7
    v_add3_u32 v2, v3, v2, s73
    buffer_load_dwordx4 v[4:7], v2, s[88:91], 0 offen
    v_and_b32 v8, 31, v0
    v_mul_u32_u24 v8, 272, v8
    v_lshrrev_b32 v9, 5, v0
    v_lshlrev_b32 v9, 4, v9
    s_mul_i32 s72, s23, 17408
    v_add3_u32 v8, v8, v9, s72
    v_lshrrev_b32 v12, 3, v0
    s_lshl_b32 s72, s23, 3
    v_add_u32 v12, s72, v12
    v_mul_u32_u24 v12, 272, v12
    v_and_b32 v13, 7, v0
    v_lshlrev_b32 v13, 5, v13
    v_add_u32 v12, v12, v13
    v_add_u32 v13, 69632, v12
    s_waitcnt vmcnt(22)
    v_mfma_f32_32x32x16_bf16 v[192:207], v[16:19], v[104:107], 0
    v_mfma_f32_32x32x16_bf16 v[208:223], v[20:23], v[104:107], 0
    s_waitcnt vmcnt(21)
    v_mfma_f32_32x32x16_bf16 v[224:239], v[16:19], v[108:111], 0
    v_mfma_f32_32x32x16_bf16 v[240:255], v[20:23], v[108:111], 0
    s_waitcnt vmcnt(20)
    v_mfma_f32_32x32x16_bf16 v[192:207], v[24:27], v[112:115], v[192:207]
    v_mfma_f32_32x32x16_bf16 v[208:223], v[28:31], v[112:115], v[208:223]
    s_waitcnt vmcnt(19)
    v_mfma_f32_32x32x16_bf16 v[224:239], v[24:27], v[116:119], v[224:239]
    v_mfma_f32_32x32x16_bf16 v[240:255], v[28:31], v[116:119], v[240:255]
    s_waitcnt vmcnt(18)
    v_mfma_f32_32x32x16_bf16 v[192:207], v[32:35], v[120:123], v[192:207]
    v_mfma_f32_32x32x16_bf16 v[208:223], v[36:39], v[120:123], v[208:223]
    s_waitcnt vmcnt(17)
    v_mfma_f32_32x32x16_bf16 v[224:239], v[32:35], v[124:127], v[224:239]
    v_mfma_f32_32x32x16_bf16 v[240:255], v[36:39], v[124:127], v[240:255]
    s_waitcnt vmcnt(16)
    v_mfma_f32_32x32x16_bf16 v[192:207], v[40:43], v[128:131], v[192:207]
    v_mfma_f32_32x32x16_bf16 v[208:223], v[44:47], v[128:131], v[208:223]
    s_waitcnt vmcnt(15)
    v_mfma_f32_32x32x16_bf16 v[224:239], v[40:43], v[132:135], v[224:239]
    v_mfma_f32_32x32x16_bf16 v[240:255], v[44:47], v[132:135], v[240:255]
    s_waitcnt vmcnt(14)
    v_mfma_f32_32x32x16_bf16 v[192:207], v[48:51], v[136:139], v[192:207]
    v_mfma_f32_32x32x16_bf16 v[208:223], v[52:55], v[136:139], v[208:223]
    s_waitcnt vmcnt(13)
    v_mfma_f32_32x32x16_bf16 v[224:239], v[48:51], v[140:143], v[224:239]
    v_mfma_f32_32x32x16_bf16 v[240:255], v[52:55], v[140:143], v[240:255]
    s_waitcnt vmcnt(12)
    v_mfma_f32_32x32x16_bf16 v[192:207], v[56:59], v[144:147], v[192:207]
    v_mfma_f32_32x32x16_bf16 v[208:223], v[60:63], v[144:147], v[208:223]
    s_waitcnt vmcnt(11)
    v_mfma_f32_32x32x16_bf16 v[224:239], v[56:59], v[148:151], v[224:239]
    v_mfma_f32_32x32x16_bf16 v[240:255], v[60:63], v[148:151], v[240:255]
    s_waitcnt vmcnt(10)
    v_mfma_f32_32x32x16_bf16 v[192:207], v[64:67], v[152:155], v[192:207]
    v_mfma_f32_32x32x16_bf16 v[208:223], v[68:71], v[152:155], v[208:223]
    s_waitcnt vmcnt(9)
    v_mfma_f32_32x32x16_bf16 v[224:239], v[64:67], v[156:159], v[224:239]
    v_mfma_f32_32x32x16_bf16 v[240:255], v[68:71], v[156:159], v[240:255]
    s_waitcnt vmcnt(8)
    v_mfma_f32_32x32x16_bf16 v[192:207], v[72:75], v[160:163], v[192:207]
    v_mfma_f32_32x32x16_bf16 v[208:223], v[76:79], v[160:163], v[208:223]
    s_waitcnt vmcnt(7)
    v_mfma_f32_32x32x16_bf16 v[224:239], v[72:75], v[164:167], v[224:239]
    v_mfma_f32_32x32x16_bf16 v[240:255], v[76:79], v[164:167], v[240:255]
    s_waitcnt vmcnt(6)
    v_mfma_f32_32x32x16_bf16 v[192:207], v[80:83], v[168:171], v[192:207]
    v_mfma_f32_32x32x16_bf16 v[208:223], v[84:87], v[168:171], v[208:223]
    s_waitcnt vmcnt(5)
    v_mfma_f32_32x32x16_bf16 v[224:239], v[80:83], v[172:175], v[224:239]
    v_mfma_f32_32x32x16_bf16 v[240:255], v[84:87], v[172:175], v[240:255]
    s_waitcnt vmcnt(4)
    v_mfma_f32_32x32x16_bf16 v[192:207], v[88:91], v[176:179], v[192:207]
    v_mfma_f32_32x32x16_bf16 v[208:223], v[92:95], v[176:179], v[208:223]
    s_waitcnt vmcnt(3)
    v_mfma_f32_32x32x16_bf16 v[224:239], v[88:91], v[180:183], v[224:239]
    v_mfma_f32_32x32x16_bf16 v[240:255], v[92:95], v[180:183], v[240:255]
    s_waitcnt vmcnt(2)
    v_mfma_f32_32x32x16_bf16 v[192:207], v[96:99], v[184:187], v[192:207]
    v_mfma_f32_32x32x16_bf16 v[208:223], v[100:103], v[184:187], v[208:223]
    s_waitcnt vmcnt(1)
    v_mfma_f32_32x32x16_bf16 v[224:239], v[96:99], v[188:191], v[224:239]
    v_mfma_f32_32x32x16_bf16 v[240:255], v[100:103], v[188:191], v[240:255]
    s_nop 7
    ds_write_b128 v8, v[192:195] offset:0
    ds_write_b128 v8, v[196:199] offset:32
    ds_write_b128 v8, v[200:203] offset:64
    ds_write_b128 v8, v[204:207] offset:96
    ds_write_b128 v8, v[208:211] offset:128
    ds_write_b128 v8, v[212:215] offset:160
    ds_write_b128 v8, v[216:219] offset:192
    ds_write_b128 v8, v[220:223] offset:224
    ds_write_b128 v8, v[224:227] offset:8704
    ds_write_b128 v8, v[228:231] offset:8736
    ds_write_b128 v8, v[232:235] offset:8768
    ds_write_b128 v8, v[236:239] offset:8800
    ds_write_b128 v8, v[240:243] offset:8832
    ds_write_b128 v8, v[244:247] offset:8864
    ds_write_b128 v8, v[248:251] offset:8896
    ds_write_b128 v8, v[252:255] offset:8928
    s_waitcnt lgkmcnt(0)
    s_barrier
    ds_read_b128 v[16:19], v12 offset:0
    ds_read_b128 v[20:23], v12 offset:16
    ds_read_b128 v[24:27], v12 offset:17408
    ds_read_b128 v[28:31], v12 offset:17424
    ds_read_b128 v[32:35], v12 offset:34816
    ds_read_b128 v[36:39], v12 offset:34832
    ds_read_b128 v[40:43], v12 offset:52224
    ds_read_b128 v[44:47], v12 offset:52240
    ds_read_b128 v[48:51], v13 offset:0
    ds_read_b128 v[52:55], v13 offset:16
    ds_read_b128 v[56:59], v13 offset:17408
    ds_read_b128 v[60:63], v13 offset:17424
    ds_read_b128 v[64:67], v13 offset:34816
    ds_read_b128 v[68:71], v13 offset:34832
    ds_read_b128 v[72:75], v13 offset:52224
    ds_read_b128 v[76:79], v13 offset:52240
    s_waitcnt lgkmcnt(13)
    v_pk_add_f32 v[16:17], v[16:17], v[24:25]
    v_pk_add_f32 v[18:19], v[18:19], v[26:27]
    s_waitcnt lgkmcnt(12)
    v_pk_add_f32 v[20:21], v[20:21], v[28:29]
    v_pk_add_f32 v[22:23], v[22:23], v[30:31]
    s_waitcnt lgkmcnt(9)
    v_pk_add_f32 v[32:33], v[32:33], v[40:41]
    v_pk_add_f32 v[34:35], v[34:35], v[42:43]
    s_waitcnt lgkmcnt(8)
    v_pk_add_f32 v[36:37], v[36:37], v[44:45]
    v_pk_add_f32 v[38:39], v[38:39], v[46:47]
    s_waitcnt lgkmcnt(5)
    v_pk_add_f32 v[48:49], v[48:49], v[56:57]
    v_pk_add_f32 v[50:51], v[50:51], v[58:59]
    s_waitcnt lgkmcnt(4)
    v_pk_add_f32 v[52:53], v[52:53], v[60:61]
    v_pk_add_f32 v[54:55], v[54:55], v[62:63]
    s_waitcnt lgkmcnt(1)
    v_pk_add_f32 v[64:65], v[64:65], v[72:73]
    v_pk_add_f32 v[66:67], v[66:67], v[74:75]
    s_waitcnt lgkmcnt(0)
    v_pk_add_f32 v[68:69], v[68:69], v[76:77]
    v_pk_add_f32 v[70:71], v[70:71], v[78:79]
    v_pk_add_f32 v[16:17], v[16:17], v[32:33]
    v_pk_add_f32 v[18:19], v[18:19], v[34:35]
    v_pk_add_f32 v[20:21], v[20:21], v[36:37]
    v_pk_add_f32 v[22:23], v[22:23], v[38:39]
    v_pk_add_f32 v[48:49], v[48:49], v[64:65]
    v_pk_add_f32 v[50:51], v[50:51], v[66:67]
    v_pk_add_f32 v[52:53], v[52:53], v[68:69]
    v_pk_add_f32 v[54:55], v[54:55], v[70:71]
    v_pk_add_f32 v[16:17], v[16:17], v[48:49]
    v_pk_add_f32 v[18:19], v[18:19], v[50:51]
    v_pk_add_f32 v[20:21], v[20:21], v[52:53]
    v_pk_add_f32 v[22:23], v[22:23], v[54:55]
    s_waitcnt vmcnt(0)
    v_lshlrev_b32 v10, 16, v4
    v_and_b32 v11, 0xffff0000, v4
    v_add_f32 v16, v16, v10
    v_add_f32 v17, v17, v11
    v_lshlrev_b32 v10, 16, v5
    v_and_b32 v11, 0xffff0000, v5
    v_add_f32 v18, v18, v10
    v_add_f32 v19, v19, v11
    v_lshlrev_b32 v10, 16, v6
    v_and_b32 v11, 0xffff0000, v6
    v_add_f32 v20, v20, v10
    v_add_f32 v21, v21, v11
    v_lshlrev_b32 v10, 16, v7
    v_and_b32 v11, 0xffff0000, v7
    v_add_f32 v22, v22, v10
    v_add_f32 v23, v23, v11
    v_cvt_pk_bf16_f32 v24, v16, v17
    v_cvt_pk_bf16_f32 v25, v18, v19
    v_cvt_pk_bf16_f32 v26, v20, v21
    v_cvt_pk_bf16_f32 v27, v22, v23
    buffer_store_dwordx4 v[24:27], v2, s[92:95], 0 offen sc1
    s_branch K2_END
K2_AEXIT:
    s_branch K2_END
K2_WPF:
    s_waitcnt lgkmcnt(0)
    s_mov_b32 s24, s4
    s_mov_b32 s25, s5
    s_mov_b32 s26, 25165824
    s_mov_b32 s27, 0x00020000
    s_mov_b32 s63, 24117248
    v_mov_b32 v14, 0
    buffer_load_dword v14, v14, s[24:27], s63 offen sc1
    v_mov_b32 v12, 151552
    v_mov_b32 v13, 0
    ds_write_b32 v12, v13
    ds_write_b32 v12, v13 offset:4
    ds_write_b32 v12, v13 offset:8
    ds_write_b32 v12, v13 offset:16
    ds_write_b32 v12, v13 offset:20
    ds_write_b32 v12, v13 offset:24
    ds_write_b32 v12, v13 offset:28
    s_waitcnt lgkmcnt(0)
    s_barrier
    v_mov_b32 v12, 151552
K2_WPFW:
    ds_read_b32 v13, v12
    s_waitcnt lgkmcnt(0)
    v_readfirstlane_b32 s61, v13
    s_nop 0
    s_cmp_lt_u32 s61, 1
    s_cbranch_scc1 K2_WPFW
    s_sub_u32 s61, s21, 28
    s_lshl_b32 s61, s61, 2
    s_add_u32 s61, s61, s16
    s_mul_i32 s61, s61, 78848
    s_add_u32 s61, s61, 20971520
    v_lshlrev_b32 v12, 7, v0
    buffer_load_dword v13, v12, s[24:27], s61 offen
    s_add_u32 s61, s61, 8192
    s_waitcnt vmcnt(0)
    buffer_load_dword v13, v12, s[24:27], s61 offen
    s_add_u32 s61, s61, 8192
    s_waitcnt vmcnt(0)
    buffer_load_dword v13, v12, s[24:27], s61 offen
    s_add_u32 s61, s61, 8192
    s_waitcnt vmcnt(0)
    buffer_load_dword v13, v12, s[24:27], s61 offen
    s_add_u32 s61, s61, 8192
    s_waitcnt vmcnt(0)
    buffer_load_dword v13, v12, s[24:27], s61 offen
    s_add_u32 s61, s61, 8192
    s_waitcnt vmcnt(0)
    buffer_load_dword v13, v12, s[24:27], s61 offen
    s_add_u32 s61, s61, 8192
    s_waitcnt vmcnt(0)
    buffer_load_dword v13, v12, s[24:27], s61 offen
    s_add_u32 s61, s61, 8192
    s_waitcnt vmcnt(0)
    buffer_load_dword v13, v12, s[24:27], s61 offen
    s_add_u32 s61, s61, 8192
    s_waitcnt vmcnt(0)
    buffer_load_dword v13, v12, s[24:27], s61 offen
    s_add_u32 s61, s61, 8192
    s_waitcnt vmcnt(0)
    buffer_load_dword v13, v12, s[24:27], s61 offen
K2_END:
    s_endpgm
CODE_END:
    s_endpgm
.section .rodata,"a"
.p2align 6
.amdhsa_kernel k1_kernel
  .amdhsa_next_free_vgpr 256
  .amdhsa_next_free_sgpr 102
  .amdhsa_accum_offset 256
  .amdhsa_group_segment_fixed_size 0
  .amdhsa_kernarg_size 88
  .amdhsa_user_sgpr_count 2
  .amdhsa_user_sgpr_kernarg_segment_ptr 1
  .amdhsa_system_sgpr_workgroup_id_x 1
  .amdhsa_float_denorm_mode_32 3
.end_amdhsa_kernel
.p2align 6
.amdhsa_kernel k2_kernel
  .amdhsa_next_free_vgpr 256
  .amdhsa_next_free_sgpr 102
  .amdhsa_accum_offset 256
  .amdhsa_group_segment_fixed_size 0
  .amdhsa_kernarg_size 88
  .amdhsa_user_sgpr_count 2
  .amdhsa_user_sgpr_kernarg_segment_ptr 1
  .amdhsa_system_sgpr_workgroup_id_x 1
  .amdhsa_float_denorm_mode_32 3
.end_amdhsa_kernel
```
